```python
import torch

def _softmax(x, axis=-1):
    return torch.softmax(x, dim=axis)
def _gelu(x):
    return torch.nn.functional.gelu(x, approximate="tanh")
def _silu(x):
    return torch.nn.functional.silu(x)
def _sigmoid(x):
    return torch.sigmoid(x)
def _layernorm(x, axis=-1, eps=1e-5):
    m = x.mean(dim=axis, keepdim=True)
    v = x.var(dim=axis, keepdim=True, unbiased=False)
    return (x - m) / torch.sqrt(v + eps)
def _scatter_add(tgt, idx, src, axis=0):
    return tgt.clone().index_add_(axis, idx, src)
def _segment_sum(src, seg, n):
    out = torch.zeros((n,) + src.shape[1:], dtype=src.dtype)
    return out.index_add_(0, seg, src)
def _pad(x, pw):
    flat = tuple(v for pair in reversed(pw) for v in pair)
    return torch.nn.functional.pad(x, flat)

kernel_name = 'sequential_preLN__linear_kernel_hedgehog__mixer_s_mlp__prompt'

def setup_inputs():

    _w = (lambda a: (lambda t: t.to(torch.bfloat16) if t.is_floating_point() else t)(torch.as_tensor(a)))
    def _A_setup():
        B, S, D, H = 1, 2048, 448, 16
        Dh = D // H
        return {
            "x": _w((lambda *s: torch.randn(*s, dtype=torch.bfloat16) * 0.05)(B, S, D)),
            "wqkv": _w((lambda *s: torch.randn(*s, dtype=torch.bfloat16) * 0.2)(D, 3 * D)),
            "w_phi": _w((lambda *s: torch.randn(*s, dtype=torch.bfloat16) * 0.2)(H, Dh, Dh) * (Dh ** -0.5)),
            "wo": _w((lambda *s: torch.randn(*s, dtype=torch.bfloat16) * 0.05)(D, D)),
        }
    _A_in = _A_setup()

    def _B_setup():
        B, S, D, F = 1, 2048, 448, 1792
        return {
            "x":  _w((lambda *s: torch.randn(*s, dtype=torch.bfloat16) * 0.05)(B, S, D)),
            "w1": _w((lambda *s: torch.randn(*s, dtype=torch.bfloat16) * 3.2)(D, D) * (D ** -0.5)),
            "w2": _w((lambda *s: torch.randn(*s, dtype=torch.bfloat16) * 3.2)(D, D) * (D ** -0.5)),
            "w3": _w((lambda *s: torch.randn(*s, dtype=torch.bfloat16) * 3.2)(D, F) * (D ** -0.5)),
            "w4": _w((lambda *s: torch.randn(*s, dtype=torch.bfloat16) * 3.2)(F, D) * (F ** -0.5)),
        }
    _B_in = _B_setup()

    return {
        "A_x": _A_in["x"],
        "A_wqkv": _A_in["wqkv"],
        "A_w_phi": _A_in["w_phi"],
        "A_wo": _A_in["wo"],
        "B_x": _B_in["x"],
        "B_w1": _B_in["w1"],
        "B_w2": _B_in["w2"],
        "B_w3": _B_in["w3"],
        "B_w4": _B_in["w4"],
    }

def reference(A_x, A_wqkv, A_w_phi, A_wo, B_x, B_w1, B_w2, B_w3, B_w4):
    def _A_ref(x, wqkv, w_phi, wo):
        B, S, D = x.shape
        H = 16; Dh = D // H
        qkv = (lambda x, *d: x.permute(*d))((x @ wqkv).reshape(B, S, 3, H, Dh), 2, 0, 3, 1, 4)
        q, k, v = qkv[0], qkv[1], qkv[2]
        pq = torch.einsum("bhsd,hdf->bhsf", q, w_phi)
        pk = torch.einsum("bhsd,hdf->bhsf", k, w_phi)
        phi_q = torch.concatenate([_softmax(pq, axis=-1), _softmax(-pq, axis=-1)], axis=-1)
        phi_k = torch.concatenate([_softmax(pk, axis=-1), _softmax(-pk, axis=-1)], axis=-1)
        kv = torch.einsum("bhsf,bhsd->bhfd", phi_k, v)
        z  = torch.einsum("bhsf->bhf", phi_k)
        num = torch.einsum("bhqf,bhfd->bhqd", phi_q, kv)
        den = torch.einsum("bhqf,bhf->bhq", phi_q, z)[..., None] + 1e-6
        o = num / den
        return (lambda x, *d: x.permute(*d))(o, 0, 2, 1, 3).reshape(B, S, D) @ wo

    def _B_ref(x, w1, w2, w3, w4):
        B, S, D = x.shape
        h = _gelu(_layernorm(x, axis=-1) @ w1)
        c = D // 4
        g0 = _pad(h[:, :, 0*c:1*c], ((0, 0), (1, 0), (0, 0)))[:, :S, :]
        g1 = _pad(h[:, :, 1*c:2*c], ((0, 0), (0, 1), (0, 0)))[:, 1:, :]
        g2 = _pad(h[:, :, 2*c:3*c], ((0, 0), (2, 0), (0, 0)))[:, :S, :]
        g3 = _pad(h[:, :, 3*c:   ], ((0, 0), (0, 2), (0, 0)))[:, 2:, :]
        hs = torch.concatenate([g0, g1, g2, g3], axis=-1) @ w2
        x1 = x + hs
        h2 = _gelu(_layernorm(x1, axis=-1) @ w3) @ w4
        return x1 + h2

    x = A_x
    h = x + _A_ref(_layernorm(x, axis=-1), A_wqkv, A_w_phi, A_wo)
    h2 = h + _B_ref(_layernorm(h, axis=-1), B_w1, B_w2, B_w3, B_w4)
    return h2
```

```asm
; @launch grid=(256,1,1) block=(512,1,1) lds=163840
.amdgcn_target "amdgcn-amd-amdhsa--gfx950"
.text
.globl sequential_preLN__linear_kernel_hedgehog__mixer_s_mlp__prompt_kernel
.p2align 8
.type sequential_preLN__linear_kernel_hedgehog__mixer_s_mlp__prompt_kernel,@function
sequential_preLN__linear_kernel_hedgehog__mixer_s_mlp__prompt_kernel:
  s_load_dwordx4 s[16:19], s[0:1], 0
  s_cmp_ge_u32 s2, 256
  s_cbranch_scc1 Lend
  s_load_dwordx4 s[36:39], s[0:1], 80
  s_load_dwordx8 s[20:27], s[0:1], 16
  s_load_dwordx8 s[28:35], s[0:1], 48
  v_lshrrev_b32 v5, 6, v0
  v_and_b32 v1, 63, v0
  s_and_b32 s12, s2, 7
  s_lshr_b32 s13, s2, 3
  v_readfirstlane_b32 s8, v5
  s_lshl_b32 s3, s12, 5
  s_or_b32 s3, s3, s13
  s_cmp_lg_u32 s8, 7
  s_cbranch_scc1 Lnopf
  s_getpc_b64 s[90:91]
Lpc:
  s_add_u32 s90, s90, sequential_preLN__linear_kernel_hedgehog__mixer_s_mlp__prompt_kernel-Lpc
  s_addc_u32 s91, s91, -1
  s_lshl_b32 s12, s13, 11
  v_and_b32 v15, 15, v1
  v_lshlrev_b32 v15, 7, v15
  v_add_u32 v15, s12, v15
  v_min_u32 v15, Lcodeend-sequential_preLN__linear_kernel_hedgehog__mixer_s_mlp__prompt_kernel, v15
  global_load_dword v251, v15, s[90:91]
Lnopf:
  s_and_b32 s84, s8, 3
  s_lshr_b32 s4, s3, 4
  s_and_b32 s5, s3, 15
  v_and_b32 v2, 15, v1
  v_lshrrev_b32 v3, 4, v1
  s_and_b32 s12, s4, 1
  s_mul_i32 s12, s12, 3
  s_add_u32 s12, s12, s5
  s_mul_i32 s13, s12, 37
  s_lshr_b32 s13, s13, 8
  s_mul_i32 s13, s13, 7
  s_sub_u32 s12, s12, s13
  s_lshl_b32 s92, s12, 7
  s_mov_b32 s96, s92
  v_lshrrev_b32 v9, 2, v1
  v_mul_u32_u24 v9, 2688, v9
  v_lshrrev_b32 v10, 5, v1
  v_lshlrev_b32 v10, 1, v10
  v_and_b32 v11, 3, v1
  v_xor_b32 v10, v10, v11
  v_lshl_add_u32 v9, v10, 4, v9
  s_mul_i32 s12, s5, 56
  s_andn2_b32 s12, s12, 15
  s_mul_i32 s13, s84, 43008
  s_add_u32 s12, s12, s13
  v_add_u32 v9, s12, v9
  s_lshl_b32 s12, s4, 7
  s_lshl_b32 s13, s8, 4
  s_add_u32 s12, s12, s13
  v_lshrrev_b32 v10, 3, v1
  v_add_u32 v10, s12, v10
  v_mul_u32_u24 v10, 896, v10
  v_and_b32 v11, 7, v1
  v_xor_b32 v11, v11, v3
  v_lshl_add_u32 v10, v11, 4, v10
  v_xor_b32 v11, 64, v10
  v_add_u32 v11, 6144, v11
  s_lshl_b32 s95, s84, 10
  s_lshl_b32 s97, s84, 13
  s_add_u32 s97, s97, 114688
  s_mul_i32 s98, s84, 14336
  s_add_u32 s98, s98, 57344
  s_cmp_ge_u32 s8, 4
  s_cselect_b32 s94, s98, s97
  v_lshlrev_b32 v4, 4, v1
  v_mov_b32 v13, 0
  s_lshr_b32 s6, s3, 3
  s_and_b32 s7, s3, 7
  s_and_b32 s12, s84, 1
  s_lshl_b32 s12, s12, 3
  v_lshrrev_b32 v15, 3, v1
  v_add_u32 v15, s12, v15
  v_mul_u32_u24 v48, 56, v15
  v_and_b32 v48, -16, v48
  v_bfe_u32 v16, v1, 2, 1
  v_mul_u32_u24 v16, 2688, v16
  v_add_u32 v48, v48, v16
  v_and_b32 v16, 3, v1
  v_lshl_add_u32 v48, v16, 4, v48
  s_mul_i32 s12, s3, 5376
  s_add_u32 s13, s12, 1792
  s_cmp_lt_u32 s84, 2
  s_cselect_b32 s12, s13, s12
  s_cselect_b32 s13, 0, 458752
  s_lshl_b32 s14, s3, 7
  s_add_u32 s13, s13, s14
  s_add_u32 s13, s13, 1114112
  s_cmp_lt_u32 s3, 224
  s_cselect_b32 s13, s13, 2147418112
  v_add_u32 v48, s12, v48
  v_mul_u32_u24 v49, 28672, v15
  v_and_b32 v16, 7, v1
  v_lshl_add_u32 v49, v16, 4, v49
  v_add_u32 v49, s13, v49
  s_waitcnt lgkmcnt(0)
  s_load_dword s9, s[38:39], 0
  s_mov_b32 s40, s16
  s_and_b32 s41, s17, 0xffff
  s_mov_b32 s42, 1835008
  s_mov_b32 s43, 0x20000
  s_mov_b32 s44, s18
  s_and_b32 s45, s19, 0xffff
  s_mov_b32 s46, 1204224
  s_mov_b32 s47, 0x20000
  s_add_u32 m0, s94, 0
  s_nop 0
  buffer_load_dwordx4 v10, s[40:43], s96 offen lds
  buffer_load_dwordx4 v11, s[40:43], s96 offen offset:1024 lds
  s_add_u32 s96, s96, 128
  s_cmp_eq_u32 s96, 896
  s_cselect_b32 s96, 0, s96
  s_mov_b32 s76, s38
  s_and_b32 s77, s39, 0xffff
  s_mov_b32 s78, 268435456
  s_mov_b32 s79, 0x20000
  s_cmp_ge_u32 s8, 4
  s_cbranch_scc1 LB0
  v_mov_b32 v180, -1
  v_mov_b32 v181, -1
  v_mov_b32 v182, -1
  v_mov_b32 v183, -1
  s_add_u32 m0, s94, 2048
  s_nop 0
  buffer_load_dwordx4 v10, s[40:43], s96 offen lds
  buffer_load_dwordx4 v11, s[40:43], s96 offen offset:1024 lds
  s_add_u32 s96, s96, 128
  s_cmp_eq_u32 s96, 896
  s_cselect_b32 s96, 0, s96
  s_cmp_lt_u32 s8, 2
  s_cbranch_scc1 Lrphi
  s_cmp_eq_u32 s8, 2
  s_cbranch_scc1 Lrnon
  s_add_u32 s12, s6, 1
  s_and_b32 s12, s12, 31
  s_mul_i32 s12, s12, 688128
  s_add_u32 s12, s12, 2154496
  s_sub_u32 s13, s6, 1
  s_and_b32 s13, s13, 31
  s_mul_i32 s13, s13, 688128
  s_add_u32 s13, s13, 2226176
  s_cmp_eq_u32 s7, 7
  s_cselect_b32 s12, 2147418112, s12
  s_cselect_b32 s13, 2147418112, s13
  s_cmp_eq_u32 s8, 3
  s_cselect_b32 s12, s12, 2147418112
  s_cselect_b32 s13, s13, 2147418112
  v_mov_b32 v45, s12
  v_mov_b32 v46, s13
  v_cmp_eq_u32 vcc, 0, v3
  s_nop 1
  v_cndmask_b32 v44, v46, v45, vcc
  v_mov_b32 v45, 2147418112
  v_cmp_gt_u32 vcc, 2, v3
  s_nop 1
  v_cndmask_b32 v44, v45, v44, vcc
  v_and_b32 v45, 7, v1
  s_lshl_b32 s14, s7, 7
  v_add_u32 v45, s14, v45
  v_lshl_add_u32 v44, v45, 4, v44
  v_bfe_u32 v45, v1, 3, 1
  v_lshl_add_u32 v44, v45, 10, v44
  s_cmp_eq_u32 s6, 31
  s_cselect_b32 s14, 0xffff, 0
  s_cmp_eq_u32 s6, 0
  s_cselect_b32 s15, 0xffff0000, 0
  s_or_b32 vcc_lo, s14, s15
  s_mov_b32 vcc_hi, 0
  s_nop 1
  v_cndmask_b32 v48, -1, v13, vcc
  v_cndmask_b32 v49, -1, v13, vcc
  v_cndmask_b32 v50, -1, v13, vcc
  v_cndmask_b32 v51, -1, v13, vcc
  buffer_store_dwordx4 v[48:51], v44, s[76:79], 0 offen sc1
  s_branch Lcom
Lrphi:
  s_mov_b32 s48, s20
  s_and_b32 s49, s21, 0xffff
  s_mov_b32 s50, 25088
  s_mov_b32 s51, 0x20000
  s_mul_i32 s14, s5, 1568
  s_add_u32 s14, s14, s95
  s_add_u32 m0, s95, 161792
  s_nop 0
  buffer_load_dwordx4 v4, s[48:51], s14 offen lds
  s_branch Lcom
Lrnon:
  s_lshl_b32 s12, s5, 12
  s_lshl_b32 s13, s4, 8
  s_add_u32 s12, s12, s13
  s_add_u32 s12, s12, 2031616
  v_lshlrev_b32 v15, 4, v2
  buffer_store_dwordx4 v[180:183], v15, s[76:79], s12 offen sc1
  s_branch Lcom
LB0:
  v_add_u32 v9, 896, v9
  buffer_load_dwordx4 v[52:55], v48, s[44:47], 0 offen
  s_add_u32 m0, s95, 0
  s_mul_i32 s93, s92, 1344
  buffer_load_dwordx4 v9, s[44:47], s93 offen offset:0 lds
  s_add_u32 s92, s92, 128
  s_cmp_eq_u32 s92, 896
  s_cselect_b32 s92, 0, s92
  s_add_u32 m0, s95, 4096
  s_mul_i32 s93, s92, 1344
  buffer_load_dwordx4 v9, s[44:47], s93 offen offset:0 lds
  s_add_u32 s92, s92, 128
  s_cmp_eq_u32 s92, 896
  s_cselect_b32 s92, 0, s92
Lcom:
  s_and_b32 s81, s3, 1
  v_mov_b32 v32, 0x3f803f80
  v_mov_b32 v33, 0x3f803f80
  v_mov_b32 v34, 0x3f803f80
  v_mov_b32 v35, 0x3f803f80
  v_bfe_u32 v28, v1, 2, 2
  v_and_b32 v29, 3, v1
  v_lshl_add_u32 v15, v3, 3, v28
  v_lshlrev_b32 v15, 6, v15
  v_lshl_add_u32 v15, v29, 3, v15
  v_and_b32 v16, 1, v3
  v_lshl_add_u32 v5, v16, 5, v15
  v_xor_b32 v6, 32, v5
  v_lshrrev_b32 v15, 1, v2
  v_xor_b32 v15, v15, v3
  v_lshlrev_b32 v15, 4, v15
  v_lshl_add_u32 v15, v2, 7, v15
  v_add_u32 v12, s97, v15
  v_xor_b32 v21, 64, v12
  v_add_u32 v44, s98, v15
  v_xor_b32 v45, 64, v44
  s_mov_b32 s52, s22
  s_and_b32 s53, s23, 0xffff
  s_mov_b32 s54, 401408
  s_mov_b32 s55, 0x20000
  s_mov_b32 s56, s26
  s_and_b32 s57, s27, 0xffff
  s_mov_b32 s58, 401408
  s_mov_b32 s59, 0x20000
  s_mov_b32 s60, s28
  s_and_b32 s61, s29, 0xffff
  s_mov_b32 s62, 401408
  s_mov_b32 s63, 0x20000
  s_mov_b32 s64, s30
  s_and_b32 s65, s31, 0xffff
  s_mov_b32 s66, 1605632
  s_mov_b32 s67, 0x20000
  s_mov_b32 s68, s32
  s_and_b32 s69, s33, 0xffff
  s_mov_b32 s70, 1605632
  s_mov_b32 s71, 0x20000
  s_mov_b32 s72, s34
  s_and_b32 s73, s35, 0xffff
  s_mov_b32 s74, 1835008
  s_mov_b32 s75, 0x20000
  s_mul_i32 s80, s6, 688128
  s_add_u32 s80, s80, 2097152
  s_mov_b32 s11, 0x8000
  s_mov_b32 s82, 0x3b124925
  s_mov_b32 s83, 0x3fb8aa3b
  v_lshl_add_u32 v15, v3, 2, v28
  s_lshl_b32 s12, s81, 2
  v_subrev_u32 v15, s12, v15
  v_mul_i32_i24 v15, 56, v15
  v_add_u32 v15, 161792, v15
  v_lshl_add_u32 v17, v29, 3, v15
  v_add_u32 v16, 4, v29
  v_min_u32 v16, 6, v16
  v_lshl_add_u32 v18, v16, 3, v15
  v_add_u32 v19, 896, v17
  v_add_u32 v20, 896, v18
  v_cmp_ne_u32 vcc, 3, v3
  s_nop 1
  v_cndmask_b32 v22, 0, 1.0, vcc
  v_mul_u32_u24 v16, 224, v2
  v_xor_b32 v15, v28, v3
  v_lshl_add_u32 v15, v15, 3, v16
  s_mul_i32 s12, s84, 3584
  s_add_u32 s12, s12, 147456
  v_add_u32 v23, s12, v15
  v_add_u32 v46, s98, v15
  s_add_u32 s12, s12, 192
  v_add_u32 v28, s12, v16
  v_lshrrev_b32 v15, 2, v1
  v_mul_u32_u24 v15, 224, v15
  v_xor_b32 v16, v29, v3
  v_lshl_add_u32 v15, v16, 3, v15
  s_lshr_b32 s12, s84, 1
  s_lshl_b32 s12, s12, 6
  s_add_u32 s12, s12, 147456
  v_add_u32 v24, s12, v15
  s_and_b32 s12, s84, 1
  s_lshl_b32 s12, s12, 5
  s_add_u32 s12, s12, 147584
  v_add_u32 v25, s12, v15
  v_subrev_u32 v26, 90112, v24
  v_subrev_u32 v27, 90112, v25
  s_lshr_b32 s12, s8, 2
  v_cmp_ge_u32 vcc, s12, v3
  v_mov_b32 v15, 0xbb124925
  s_nop 0
  v_cndmask_b32 v29, 0, v15, vcc
  v_lshlrev_b32 v15, 2, v3
  v_sub_u32 v15, v2, v15
  v_cmp_eq_u32 vcc, 0, v15
  s_nop 1
  v_cndmask_b32 v252, 0, 1.0, vcc
  v_cmp_eq_u32 vcc, 1, v15
  s_nop 1
  v_cndmask_b32 v253, 0, 1.0, vcc
  v_cmp_eq_u32 vcc, 2, v15
  s_nop 1
  v_cndmask_b32 v254, 0, 1.0, vcc
  v_cmp_eq_u32 vcc, 3, v15
  s_nop 1
  v_cndmask_b32 v255, 0, 1.0, vcc
  v_mov_b32 v210, 0
  v_mov_b32 v211, 0
  v_mov_b32 v214, 0
  v_mov_b32 v215, 0
  v_mov_b32 v218, 0
  v_mov_b32 v219, 0
  v_mov_b32 v222, 0
  v_mov_b32 v223, 0
  v_mov_b32 v226, 0
  v_mov_b32 v227, 0
  s_cmp_eq_u32 s81, 1
  s_cselect_b32 s88, 0xffff, 0
  s_mov_b32 s89, 0
  s_cselect_b32 s91, 0, 0xffff0000
  s_mov_b32 s90, 0
  s_cmp_ge_u32 s8, 4
  s_cbranch_scc1 LB
  s_lshl_b32 s12, s7, 2
  s_add_u32 s12, s12, s84
  s_mul_i32 s13, s12, 1792
  s_mul_i32 s14, s12, 384
  s_min_u32 s14, s14, 8832
  s_add_u32 s14, s14, 200704
  v_min_u32 v15, 13, v2
  v_lshlrev_b32 v15, 7, v15
  v_add_u32 v15, s13, v15
  v_and_b32 v16, 1, v3
  v_mul_u32_u24 v16, 71680, v16
  v_add_u32 v15, v15, v16
  v_min_u32 v16, 2, v2
  v_lshlrev_b32 v16, 7, v16
  v_add_u32 v16, s14, v16
  v_and_b32 v14, 1, v3
  v_mul_u32_u24 v14, 71680, v14
  v_sub_u32 v15, v15, v14
  v_mov_b32 v0, v16
  v_add_u32 v14, 272384, v15
  v_cmp_eq_u32 vcc, 0, v3
  s_nop 1
  v_cndmask_b32 v0, v0, v14, vcc
  v_and_b32 v47, 3, v1
  v_mul_u32_u24 v47, 224, v47
  v_add_u32 v47, 154816, v47
  v_and_b32 v15, 4, v1
  v_add_u32 v47, v47, v15
  s_mov_b32 s0, 0xf0f0f0f0
  s_mov_b32 s1, 0xf0f0f0f0
  s_lshl_b32 s12, s3, 2
  s_add_u32 s12, s12, s84
  s_lshl_b32 s13, s12, 9
  s_mul_i32 s14, s12, 1664
  v_lshlrev_b32 v15, 7, v1
  v_add_u32 v30, s13, v15
  v_add_u32 v9, s14, v15
  v_mov_b32 v16, 2147418112
  v_cmp_gt_u32 vcc, 4, v1
  s_nop 1
  v_cndmask_b32 v30, v16, v30, vcc
  v_cmp_gt_u32 vcc, 13, v1
  s_nop 1
  v_cndmask_b32 v9, v16, v9, vcc
  s_lshl_b32 s12, s5, 16
  s_lshl_b32 s13, s4, 8
  s_add_u32 s12, s12, s13
  s_add_u32 s12, s12, 65536
  v_lshlrev_b32 v15, 4, v2
  v_lshl_add_u32 v50, v3, 12, v15
  v_add_u32 v50, s12, v50
  s_lshl_b32 s12, s5, 12
  s_add_u32 s12, s12, s13
  s_add_u32 s12, s12, 2031616
  v_lshl_add_u32 v51, v3, 3, v15
  v_add_u32 v51, s12, v51
  v_cmp_gt_u32 vcc, 32, v1
  s_nop 1
  v_cndmask_b32 v51, v16, v51, vcc
  v_and_b32 v15, 1, v2
  v_lshlrev_b32 v15, 4, v15
  v_mov_b32 v16, 0x3f80
  v_lshlrev_b32 v15, v15, v16
  v_lshrrev_b32 v16, 1, v2
  v_cmp_eq_u32 vcc, 0, v16
  s_nop 1
  v_cndmask_b32 v252, 0, v15, vcc
  v_cmp_eq_u32 vcc, 1, v16
  s_nop 1
  v_cndmask_b32 v253, 0, v15, vcc
  v_cmp_eq_u32 vcc, 2, v16
  s_nop 1
  v_cndmask_b32 v254, 0, v15, vcc
  v_cmp_eq_u32 vcc, 3, v16
  s_nop 1
  v_cndmask_b32 v255, 0, v15, vcc
  s_lshl_b32 s12, s5, 4
  s_or_b32 s12, s12, s4
  s_lshl_b32 s12, s12, 12
  s_add_u32 s12, s12, s95
  s_add_u32 s12, s12, 65536
  v_add_u32 v31, s12, v4
  s_lshl_b32 s12, s4, 4
  v_add_u32 v15, s12, v2
  v_lshlrev_b32 v16, 4, v2
  v_add_u32 v16, s5, v16
  v_cmp_eq_u32 vcc, 1, v3
  s_nop 1
  v_cndmask_b32 v15, v15, v16, vcc
  v_and_b32 v16, 8, v2
  v_lshlrev_b32 v16, 1, v16
  v_and_b32 v8, 7, v2
  v_add_u32 v16, v16, v8
  s_lshl_b32 s12, s6, 3
  s_sub_u32 s12, s12, 8
  v_add_u32 v16, s12, v16
  v_and_b32 v16, 255, v16
  v_cmp_eq_u32 vcc, 2, v3
  s_nop 1
  v_cndmask_b32 v15, v15, v16, vcc
  v_lshlrev_b32 v8, 6, v15
  v_add_u32 v8, 4096, v8
  s_waitcnt lgkmcnt(0)
  s_add_u32 s9, s9, 0x9E3779B9
  s_andn2_b32 s9, s9, 15
  s_getreg_b32 s10, hwreg(HW_REG_XCC_ID)
  s_and_b32 s10, s10, 15
  s_or_b32 s10, s10, s9
  s_add_u32 m0, s94, 4096
  s_nop 0
  buffer_load_dwordx4 v10, s[40:43], s96 offen lds
  buffer_load_dwordx4 v11, s[40:43], s96 offen offset:1024 lds
  s_add_u32 s96, s96, 128
  s_cmp_eq_u32 s96, 896
  s_cselect_b32 s96, 0, s96
  s_setprio 2
  s_waitcnt vmcnt(5)
  s_barrier
  ds_read_b128 v[76:79], v12 offset:0
  ds_read_b128 v[164:167], v44 offset:0
  ds_read_b64_tr_b16 v[132:133], v5 offset:0
  ds_read_b64_tr_b16 v[134:135], v5 offset:256
  ds_read_b64_tr_b16 v[136:137], v6 offset:0
  ds_read_b64_tr_b16 v[138:139], v6 offset:256
  buffer_store_dwordx4 v[180:183], v31, s[76:79], 0 offen sc1
  ds_read_b128 v[80:83], v21 offset:0
  ds_read_b128 v[168:171], v45 offset:0
  s_waitcnt lgkmcnt(7)
  v_mfma_f32_16x16x32_bf16 v[68:71], v[32:35], v[76:79], 0
  ds_read_b64_tr_b16 v[140:141], v5 offset:2048
  s_waitcnt lgkmcnt(7)
  v_mfma_f32_16x16x32_bf16 v[72:75], v[32:35], v[164:167], 0
  ds_read_b64_tr_b16 v[142:143], v5 offset:2304
  s_waitcnt lgkmcnt(6)
  v_mfma_f32_16x16x32_bf16 v[196:199], v[32:35], v[132:135], 0
  s_waitcnt lgkmcnt(4)
  v_mfma_f32_16x16x32_bf16 v[200:203], v[32:35], v[136:139], 0
  ds_read_b64_tr_b16 v[144:145], v6 offset:2048
  v_mfma_f32_16x16x32_bf16 v[52:55], v[132:135], v[76:79], 0
  v_mfma_f32_16x16x32_bf16 v[60:63], v[132:135], v[164:167], 0
  ds_read_b64_tr_b16 v[146:147], v6 offset:2304
  v_mfma_f32_16x16x32_bf16 v[56:59], v[136:139], v[76:79], 0
  v_mfma_f32_16x16x32_bf16 v[64:67], v[136:139], v[164:167], 0
  s_add_u32 m0, s94, 6144
  s_nop 0
  buffer_load_dwordx4 v10, s[40:43], s96 offen lds
  buffer_load_dwordx4 v11, s[40:43], s96 offen offset:1024 lds
  s_add_u32 s96, s96, 128
  s_cmp_eq_u32 s96, 896
  s_cselect_b32 s96, 0, s96
  s_waitcnt lgkmcnt(5)
  s_waitcnt vmcnt(6)
  s_barrier
  ds_read_b128 v[84:87], v12 offset:2048
  ds_read_b128 v[172:175], v44 offset:2048
  v_mfma_f32_16x16x32_bf16 v[68:71], v[32:35], v[80:83], v[68:71]
  ds_read_b64_tr_b16 v[148:149], v5 offset:4096
  s_waitcnt lgkmcnt(7)
  v_mfma_f32_16x16x32_bf16 v[72:75], v[32:35], v[168:171], v[72:75]
  ds_read_b64_tr_b16 v[150:151], v5 offset:4352
  s_waitcnt lgkmcnt(6)
  v_mfma_f32_16x16x32_bf16 v[196:199], v[32:35], v[140:143], v[196:199]
  s_waitcnt lgkmcnt(4)
  v_mfma_f32_16x16x32_bf16 v[200:203], v[32:35], v[144:147], v[200:203]
  ds_read_b64_tr_b16 v[152:153], v6 offset:4096
  v_mfma_f32_16x16x32_bf16 v[52:55], v[140:143], v[80:83], v[52:55]
  v_mfma_f32_16x16x32_bf16 v[60:63], v[140:143], v[168:171], v[60:63]
  ds_read_b64_tr_b16 v[154:155], v6 offset:4352
  v_mfma_f32_16x16x32_bf16 v[56:59], v[144:147], v[80:83], v[56:59]
  v_mfma_f32_16x16x32_bf16 v[64:67], v[144:147], v[168:171], v[64:67]
  ds_read_b128 v[88:91], v21 offset:2048
  ds_read_b128 v[164:167], v45 offset:2048
  s_waitcnt lgkmcnt(7)
  v_mfma_f32_16x16x32_bf16 v[68:71], v[32:35], v[84:87], v[68:71]
  ds_read_b64_tr_b16 v[156:157], v5 offset:6144
  s_waitcnt lgkmcnt(7)
  v_mfma_f32_16x16x32_bf16 v[72:75], v[32:35], v[172:175], v[72:75]
  ds_read_b64_tr_b16 v[158:159], v5 offset:6400
  s_waitcnt lgkmcnt(6)
  v_mfma_f32_16x16x32_bf16 v[196:199], v[32:35], v[148:151], v[196:199]
  s_waitcnt lgkmcnt(4)
  v_mfma_f32_16x16x32_bf16 v[200:203], v[32:35], v[152:155], v[200:203]
  ds_read_b64_tr_b16 v[160:161], v6 offset:6144
  v_mfma_f32_16x16x32_bf16 v[52:55], v[148:151], v[84:87], v[52:55]
  v_mfma_f32_16x16x32_bf16 v[60:63], v[148:151], v[172:175], v[60:63]
  ds_read_b64_tr_b16 v[162:163], v6 offset:6400
  v_mfma_f32_16x16x32_bf16 v[56:59], v[152:155], v[84:87], v[56:59]
  v_mfma_f32_16x16x32_bf16 v[64:67], v[152:155], v[172:175], v[64:67]
  s_add_u32 m0, s94, 0
  s_nop 0
  buffer_load_dwordx4 v10, s[40:43], s96 offen lds
  buffer_load_dwordx4 v11, s[40:43], s96 offen offset:1024 lds
  s_add_u32 s96, s96, 128
  s_cmp_eq_u32 s96, 896
  s_cselect_b32 s96, 0, s96
  s_waitcnt lgkmcnt(5)
  s_waitcnt vmcnt(5)
  s_barrier
  ds_read_b128 v[92:95], v12 offset:4096
  ds_read_b128 v[168:171], v44 offset:4096
  v_mfma_f32_16x16x32_bf16 v[68:71], v[32:35], v[88:91], v[68:71]
  ds_read_b64_tr_b16 v[132:133], v5 offset:8192
  s_waitcnt lgkmcnt(7)
  v_mfma_f32_16x16x32_bf16 v[72:75], v[32:35], v[164:167], v[72:75]
  ds_read_b64_tr_b16 v[134:135], v5 offset:8448
  s_waitcnt lgkmcnt(6)
  v_mfma_f32_16x16x32_bf16 v[196:199], v[32:35], v[156:159], v[196:199]
  s_waitcnt lgkmcnt(4)
  v_mfma_f32_16x16x32_bf16 v[200:203], v[32:35], v[160:163], v[200:203]
  ds_read_b64_tr_b16 v[136:137], v6 offset:8192
  v_mfma_f32_16x16x32_bf16 v[52:55], v[156:159], v[88:91], v[52:55]
  v_mfma_f32_16x16x32_bf16 v[60:63], v[156:159], v[164:167], v[60:63]
  ds_read_b64_tr_b16 v[138:139], v6 offset:8448
  v_mfma_f32_16x16x32_bf16 v[56:59], v[160:163], v[88:91], v[56:59]
  v_mfma_f32_16x16x32_bf16 v[64:67], v[160:163], v[164:167], v[64:67]
  ds_read_b128 v[96:99], v21 offset:4096
  ds_read_b128 v[172:175], v45 offset:4096
  s_waitcnt lgkmcnt(7)
  v_mfma_f32_16x16x32_bf16 v[68:71], v[32:35], v[92:95], v[68:71]
  ds_read_b64_tr_b16 v[140:141], v5 offset:10240
  s_waitcnt lgkmcnt(7)
  v_mfma_f32_16x16x32_bf16 v[72:75], v[32:35], v[168:171], v[72:75]
  ds_read_b64_tr_b16 v[142:143], v5 offset:10496
  s_waitcnt lgkmcnt(6)
  v_mfma_f32_16x16x32_bf16 v[196:199], v[32:35], v[132:135], v[196:199]
  s_waitcnt lgkmcnt(4)
  v_mfma_f32_16x16x32_bf16 v[200:203], v[32:35], v[136:139], v[200:203]
  ds_read_b64_tr_b16 v[144:145], v6 offset:10240
  v_mfma_f32_16x16x32_bf16 v[52:55], v[132:135], v[92:95], v[52:55]
  v_mfma_f32_16x16x32_bf16 v[60:63], v[132:135], v[168:171], v[60:63]
  ds_read_b64_tr_b16 v[146:147], v6 offset:10496
  v_mfma_f32_16x16x32_bf16 v[56:59], v[136:139], v[92:95], v[56:59]
  v_mfma_f32_16x16x32_bf16 v[64:67], v[136:139], v[168:171], v[64:67]
  s_add_u32 m0, s94, 2048
  s_nop 0
  buffer_load_dwordx4 v10, s[40:43], s96 offen lds
  buffer_load_dwordx4 v11, s[40:43], s96 offen offset:1024 lds
  s_add_u32 s96, s96, 128
  s_cmp_eq_u32 s96, 896
  s_cselect_b32 s96, 0, s96
  s_waitcnt lgkmcnt(5)
  s_waitcnt vmcnt(4)
  s_barrier
  ds_read_b128 v[100:103], v12 offset:6144
  ds_read_b128 v[164:167], v44 offset:6144
  v_mfma_f32_16x16x32_bf16 v[68:71], v[32:35], v[96:99], v[68:71]
  ds_read_b64_tr_b16 v[148:149], v5 offset:12288
  s_waitcnt lgkmcnt(7)
  v_mfma_f32_16x16x32_bf16 v[72:75], v[32:35], v[172:175], v[72:75]
  ds_read_b64_tr_b16 v[150:151], v5 offset:12544
  s_waitcnt lgkmcnt(6)
  v_mfma_f32_16x16x32_bf16 v[196:199], v[32:35], v[140:143], v[196:199]
  s_waitcnt lgkmcnt(4)
  v_mfma_f32_16x16x32_bf16 v[200:203], v[32:35], v[144:147], v[200:203]
  ds_read_b64_tr_b16 v[152:153], v6 offset:12288
  v_mfma_f32_16x16x32_bf16 v[52:55], v[140:143], v[96:99], v[52:55]
  v_mfma_f32_16x16x32_bf16 v[60:63], v[140:143], v[172:175], v[60:63]
  ds_read_b64_tr_b16 v[154:155], v6 offset:12544
  v_mfma_f32_16x16x32_bf16 v[56:59], v[144:147], v[96:99], v[56:59]
  v_mfma_f32_16x16x32_bf16 v[64:67], v[144:147], v[172:175], v[64:67]
  ds_read_b128 v[104:107], v21 offset:6144
  ds_read_b128 v[168:171], v45 offset:6144
  s_waitcnt lgkmcnt(7)
  v_mfma_f32_16x16x32_bf16 v[68:71], v[32:35], v[100:103], v[68:71]
  ds_read_b64_tr_b16 v[156:157], v5 offset:14336
  s_waitcnt lgkmcnt(7)
  v_mfma_f32_16x16x32_bf16 v[72:75], v[32:35], v[164:167], v[72:75]
  ds_read_b64_tr_b16 v[158:159], v5 offset:14592
  s_waitcnt lgkmcnt(6)
  v_mfma_f32_16x16x32_bf16 v[196:199], v[32:35], v[148:151], v[196:199]
  s_waitcnt lgkmcnt(4)
  v_mfma_f32_16x16x32_bf16 v[200:203], v[32:35], v[152:155], v[200:203]
  ds_read_b64_tr_b16 v[160:161], v6 offset:14336
  v_mfma_f32_16x16x32_bf16 v[52:55], v[148:151], v[100:103], v[52:55]
  v_mfma_f32_16x16x32_bf16 v[60:63], v[148:151], v[164:167], v[60:63]
  ds_read_b64_tr_b16 v[162:163], v6 offset:14592
  v_mfma_f32_16x16x32_bf16 v[56:59], v[152:155], v[100:103], v[56:59]
  v_mfma_f32_16x16x32_bf16 v[64:67], v[152:155], v[164:167], v[64:67]
  s_add_u32 m0, s94, 4096
  s_nop 0
  buffer_load_dwordx4 v10, s[40:43], s96 offen lds
  buffer_load_dwordx4 v11, s[40:43], s96 offen offset:1024 lds
  s_add_u32 s96, s96, 128
  s_cmp_eq_u32 s96, 896
  s_cselect_b32 s96, 0, s96
  s_waitcnt lgkmcnt(5)
  s_waitcnt vmcnt(4)
  s_barrier
  ds_read_b128 v[108:111], v12 offset:0
  ds_read_b128 v[172:175], v44 offset:8192
  v_mfma_f32_16x16x32_bf16 v[68:71], v[32:35], v[104:107], v[68:71]
  ds_read_b64_tr_b16 v[132:133], v5 offset:16384
  s_waitcnt lgkmcnt(7)
  v_mfma_f32_16x16x32_bf16 v[72:75], v[32:35], v[168:171], v[72:75]
  ds_read_b64_tr_b16 v[134:135], v5 offset:16640
  s_waitcnt lgkmcnt(6)
  v_mfma_f32_16x16x32_bf16 v[196:199], v[32:35], v[156:159], v[196:199]
  s_waitcnt lgkmcnt(4)
  v_mfma_f32_16x16x32_bf16 v[200:203], v[32:35], v[160:163], v[200:203]
  ds_read_b64_tr_b16 v[136:137], v6 offset:16384
  v_mfma_f32_16x16x32_bf16 v[52:55], v[156:159], v[104:107], v[52:55]
  v_mfma_f32_16x16x32_bf16 v[60:63], v[156:159], v[168:171], v[60:63]
  ds_read_b64_tr_b16 v[138:139], v6 offset:16640
  v_mfma_f32_16x16x32_bf16 v[56:59], v[160:163], v[104:107], v[56:59]
  v_mfma_f32_16x16x32_bf16 v[64:67], v[160:163], v[168:171], v[64:67]
  s_and_b32 s12, s3, 31
  s_lshl_b32 s12, s12, 2
  s_add_u32 s12, s12, s84
  s_mul_i32 s13, s12, 25
  v_add_u32 v176, s13, v1
  v_lshlrev_b32 v176, 7, v176
  s_mul_i32 s13, s12, 24
  v_add_u32 v15, s13, v1
  v_lshrrev_b32 v177, 1, v15
  v_lshlrev_b32 v177, 9, v177
  v_and_b32 v15, 1, v15
  v_lshl_add_u32 v177, v15, 7, v177
  v_mov_b32 v16, 2147418112
  v_cmp_gt_u32 vcc, 25, v1
  s_nop 1
  v_cndmask_b32 v176, v16, v176, vcc
  v_cmp_gt_u32 vcc, 24, v1
  s_nop 1
  v_cndmask_b32 v177, v16, v177, vcc
  ds_read_b128 v[112:115], v21 offset:0
  ds_read_b128 v[164:167], v45 offset:8192
  s_waitcnt lgkmcnt(7)
  v_mfma_f32_16x16x32_bf16 v[68:71], v[32:35], v[108:111], v[68:71]
  ds_read_b64_tr_b16 v[140:141], v5 offset:18432
  s_waitcnt lgkmcnt(7)
  v_mfma_f32_16x16x32_bf16 v[72:75], v[32:35], v[172:175], v[72:75]
  ds_read_b64_tr_b16 v[142:143], v5 offset:18688
  s_waitcnt lgkmcnt(6)
  v_mfma_f32_16x16x32_bf16 v[196:199], v[32:35], v[132:135], v[196:199]
  s_waitcnt lgkmcnt(4)
  v_mfma_f32_16x16x32_bf16 v[200:203], v[32:35], v[136:139], v[200:203]
  ds_read_b64_tr_b16 v[144:145], v6 offset:18432
  v_mfma_f32_16x16x32_bf16 v[52:55], v[132:135], v[108:111], v[52:55]
  v_mfma_f32_16x16x32_bf16 v[60:63], v[132:135], v[172:175], v[60:63]
  ds_read_b64_tr_b16 v[146:147], v6 offset:18688
  v_mfma_f32_16x16x32_bf16 v[56:59], v[136:139], v[108:111], v[56:59]
  v_mfma_f32_16x16x32_bf16 v[64:67], v[136:139], v[172:175], v[64:67]
  ds_read_b64_tr_b16 v[36:37], v17
  ds_read_b64_tr_b16 v[38:39], v19
  ds_read_b64_tr_b16 v[40:41], v18
  ds_read_b64_tr_b16 v[42:43], v20
  s_waitcnt lgkmcnt(9)
  s_waitcnt vmcnt(2)
  s_barrier
  ds_read_b128 v[116:119], v12 offset:2048
  ds_read_b128 v[168:171], v44 offset:10240
  v_mfma_f32_16x16x32_bf16 v[68:71], v[32:35], v[112:115], v[68:71]
  ds_read_b64_tr_b16 v[148:149], v5 offset:20480
  s_waitcnt lgkmcnt(11)
  v_mfma_f32_16x16x32_bf16 v[72:75], v[32:35], v[164:167], v[72:75]
  ds_read_b64_tr_b16 v[150:151], v5 offset:20736
  s_waitcnt lgkmcnt(10)
  v_mfma_f32_16x16x32_bf16 v[196:199], v[32:35], v[140:143], v[196:199]
  s_waitcnt lgkmcnt(8)
  v_mfma_f32_16x16x32_bf16 v[200:203], v[32:35], v[144:147], v[200:203]
  ds_read_b64_tr_b16 v[152:153], v6 offset:20480
  v_mfma_f32_16x16x32_bf16 v[52:55], v[140:143], v[112:115], v[52:55]
  v_mfma_f32_16x16x32_bf16 v[60:63], v[140:143], v[164:167], v[60:63]
  ds_read_b64_tr_b16 v[154:155], v6 offset:20736
  v_mfma_f32_16x16x32_bf16 v[56:59], v[144:147], v[112:115], v[56:59]
  v_mfma_f32_16x16x32_bf16 v[64:67], v[144:147], v[164:167], v[64:67]
  ds_read_b128 v[120:123], v21 offset:2048
  ds_read_b128 v[172:175], v45 offset:10240
  s_waitcnt lgkmcnt(7)
  v_mfma_f32_16x16x32_bf16 v[68:71], v[32:35], v[116:119], v[68:71]
  ds_read_b64_tr_b16 v[156:157], v5 offset:22528
  s_waitcnt lgkmcnt(7)
  v_mfma_f32_16x16x32_bf16 v[72:75], v[32:35], v[168:171], v[72:75]
  ds_read_b64_tr_b16 v[158:159], v5 offset:22784
  s_waitcnt lgkmcnt(6)
  v_mfma_f32_16x16x32_bf16 v[196:199], v[32:35], v[148:151], v[196:199]
  s_waitcnt lgkmcnt(4)
  v_mfma_f32_16x16x32_bf16 v[200:203], v[32:35], v[152:155], v[200:203]
  ds_read_b64_tr_b16 v[160:161], v6 offset:22528
  v_mfma_f32_16x16x32_bf16 v[52:55], v[148:151], v[116:119], v[52:55]
  v_mfma_f32_16x16x32_bf16 v[60:63], v[148:151], v[168:171], v[60:63]
  ds_read_b64_tr_b16 v[162:163], v6 offset:22784
  v_mfma_f32_16x16x32_bf16 v[56:59], v[152:155], v[116:119], v[56:59]
  v_mfma_f32_16x16x32_bf16 v[64:67], v[152:155], v[168:171], v[64:67]
  v_cndmask_b32 v36, v36, v13, s[88:89]
  v_cndmask_b32 v37, v37, v13, s[88:89]
  v_cndmask_b32 v40, v40, v13, s[88:89]
  v_cndmask_b32 v41, v41, v13, s[88:89]
  v_cndmask_b32 v38, v38, v13, s[90:91]
  v_cndmask_b32 v39, v39, v13, s[90:91]
  v_cndmask_b32 v42, v42, v13, s[90:91]
  v_cndmask_b32 v43, v43, v13, s[90:91]
  s_waitcnt lgkmcnt(5)
  s_waitcnt vmcnt(0)
  s_barrier
  ds_read_b128 v[124:127], v12 offset:4096
  ds_read_b128 v[164:167], v44 offset:12288
  v_mfma_f32_16x16x32_bf16 v[68:71], v[32:35], v[120:123], v[68:71]
  ds_read_b64_tr_b16 v[132:133], v5 offset:24576
  s_waitcnt lgkmcnt(7)
  v_mfma_f32_16x16x32_bf16 v[72:75], v[32:35], v[172:175], v[72:75]
  ds_read_b64_tr_b16 v[134:135], v5 offset:24832
  s_waitcnt lgkmcnt(6)
  v_mfma_f32_16x16x32_bf16 v[196:199], v[32:35], v[156:159], v[196:199]
  s_waitcnt lgkmcnt(4)
  v_mfma_f32_16x16x32_bf16 v[200:203], v[32:35], v[160:163], v[200:203]
  ds_read_b64_tr_b16 v[136:137], v6 offset:24576
  v_mfma_f32_16x16x32_bf16 v[52:55], v[156:159], v[120:123], v[52:55]
  v_mfma_f32_16x16x32_bf16 v[60:63], v[156:159], v[172:175], v[60:63]
  ds_read_b64_tr_b16 v[138:139], v6 offset:24832
  v_mfma_f32_16x16x32_bf16 v[56:59], v[160:163], v[120:123], v[56:59]
  v_mfma_f32_16x16x32_bf16 v[64:67], v[160:163], v[172:175], v[64:67]
  v_lshrrev_b32 v11, 3, v1
  s_lshl_b32 s12, s84, 3
  v_add_u32 v11, s12, v11
  v_mul_u32_u24 v11, 896, v11
  v_bfe_u32 v15, v1, 4, 1
  v_lshlrev_b32 v15, 1, v15
  s_and_b32 s12, s84, 1
  s_lshl_b32 s12, s12, 2
  v_and_b32 v16, 7, v1
  v_xor_b32 v15, v15, v16
  v_xor_b32 v15, s12, v15
  v_lshl_add_u32 v11, v15, 4, v11
  s_lshl_b32 s12, s7, 7
  s_cmp_eq_u32 s7, 7
  s_cselect_b32 s12, 2147418112, s12
  v_add_u32 v11, s12, v11
  s_mul_i32 s12, s84, 224
  s_add_u32 s12, s12, 154816
  v_mov_b32 v17, s12
  ds_read_b128 v[128:131], v21 offset:4096
  ds_read_b128 v[168:171], v45 offset:12288
  s_waitcnt lgkmcnt(7)
  v_mfma_f32_16x16x32_bf16 v[68:71], v[32:35], v[124:127], v[68:71]
  ds_read_b64_tr_b16 v[140:141], v5 offset:26624
  s_waitcnt lgkmcnt(7)
  v_mfma_f32_16x16x32_bf16 v[72:75], v[32:35], v[164:167], v[72:75]
  ds_read_b64_tr_b16 v[142:143], v5 offset:26880
  s_waitcnt lgkmcnt(6)
  v_mfma_f32_16x16x32_bf16 v[196:199], v[32:35], v[132:135], v[196:199]
  s_waitcnt lgkmcnt(4)
  v_mfma_f32_16x16x32_bf16 v[200:203], v[32:35], v[136:139], v[200:203]
  ds_read_b64_tr_b16 v[144:145], v6 offset:26624
  v_mfma_f32_16x16x32_bf16 v[52:55], v[132:135], v[124:127], v[52:55]
  v_mfma_f32_16x16x32_bf16 v[60:63], v[132:135], v[164:167], v[60:63]
  ds_read_b64_tr_b16 v[146:147], v6 offset:26880
  v_mfma_f32_16x16x32_bf16 v[56:59], v[136:139], v[124:127], v[56:59]
  v_mfma_f32_16x16x32_bf16 v[64:67], v[136:139], v[164:167], v[64:67]
  buffer_load_dword v7, v30, s[52:55], 0 offen
  buffer_load_dword v7, v30, s[56:59], 0 offen
  buffer_load_dword v7, v30, s[60:63], 0 offen
  s_waitcnt lgkmcnt(5)
  v_mfma_f32_16x16x32_bf16 v[68:71], v[32:35], v[128:131], v[68:71]
  s_waitcnt lgkmcnt(4)
  v_mfma_f32_16x16x32_bf16 v[72:75], v[32:35], v[168:171], v[72:75]
  s_waitcnt lgkmcnt(2)
  v_mfma_f32_16x16x32_bf16 v[196:199], v[32:35], v[140:143], v[196:199]
  s_waitcnt lgkmcnt(0)
  v_mfma_f32_16x16x32_bf16 v[200:203], v[32:35], v[144:147], v[200:203]
  v_mfma_f32_16x16x32_bf16 v[52:55], v[140:143], v[128:131], v[52:55]
  v_mfma_f32_16x16x32_bf16 v[60:63], v[140:143], v[168:171], v[60:63]
  v_mfma_f32_16x16x32_bf16 v[56:59], v[144:147], v[128:131], v[56:59]
  v_mfma_f32_16x16x32_bf16 v[64:67], v[144:147], v[168:171], v[64:67]
  buffer_load_dword v7, v9, s[64:67], 0 offen
  v_mov_b32 v16, 16
  ds_write_b32 v17, v16 offset:4
  v_mov_b32 v44, v176
  v_mov_b32 v45, v177
  s_setprio 0
  v_mul_f32 v228, v68, v29
  v_mul_f32 v230, v72, v29
  v_cvt_pk_bf16_f32 v224, v228, v228
  v_cvt_pk_bf16_f32 v216, v230, v230
  v_cvt_pk_bf16_f32 v209, v196, v196
  v_cvt_pk_bf16_f32 v213, v200, v200
  v_and_b32 v229, 0xffff0000, v224
  v_and_b32 v231, 0xffff0000, v216
  v_and_b32 v197, 0xffff0000, v209
  v_and_b32 v201, 0xffff0000, v213
  v_sub_f32 v229, v228, v229
  v_sub_f32 v231, v230, v231
  v_sub_f32 v197, v196, v197
  v_sub_f32 v201, v200, v201
  v_cvt_pk_bf16_f32 v225, v229, 0
  v_cvt_pk_bf16_f32 v217, v231, 0
  v_cvt_pk_bf16_f32 v208, v196, v197
  v_cvt_pk_bf16_f32 v212, v200, v201
  s_nop 0
  v_mfma_f32_16x16x32_bf16 v[52:55], v[208:211], v[224:227], v[52:55]
  v_mfma_f32_16x16x32_bf16 v[56:59], v[212:215], v[224:227], v[56:59]
  v_mfma_f32_16x16x32_bf16 v[60:63], v[208:211], v[216:219], v[60:63]
  v_mfma_f32_16x16x32_bf16 v[64:67], v[212:215], v[216:219], v[64:67]
  s_nop 4
  v_cvt_pk_bf16_f32 v204, v52, v53
  v_cvt_pk_bf16_f32 v205, v54, v55
  v_cvt_pk_bf16_f32 v206, v56, v57
  v_cvt_pk_bf16_f32 v207, v58, v59
  s_nop 1
  v_mfma_f32_16x16x32_bf16 v[52:55], v[36:39], v[204:207], 0
  v_mfma_f32_16x16x32_bf16 v[56:59], v[40:43], v[204:207], 0
  v_cvt_pk_bf16_f32 v220, v60, v61
  v_cvt_pk_bf16_f32 v221, v62, v63
  v_cvt_pk_bf16_f32 v222, v64, v65
  v_cvt_pk_bf16_f32 v223, v66, v67
  s_nop 1
  v_mfma_f32_16x16x32_bf16 v[60:63], v[36:39], v[220:223], 0
  v_mfma_f32_16x16x32_bf16 v[64:67], v[40:43], v[220:223], 0
  ds_read_b64 v[48:49], v28 offset:8
  v_max3_f32 v228, v52, v53, v54
  s_nop 4
  v_max3_f32 v172, v60, v61, v62
  v_max3_f32 v229, -v52, -v53, -v54
  v_max3_f32 v173, -v60, -v61, -v62
  v_max3_f32 v228, v228, v55, v56
  v_max3_f32 v172, v172, v63, v64
  v_max3_f32 v229, v229, -v55, -v56
  v_max3_f32 v173, v173, -v63, -v64
  v_max3_f32 v228, v228, v57, v58
  v_max3_f32 v172, v172, v65, v66
  v_max3_f32 v229, v229, -v57, -v58
  v_max3_f32 v173, v173, -v65, -v66
  v_max_f32 v228, v228, v59
  v_max_f32 v172, v172, v67
  v_max_f32_e64 v229, v229, -v59
  v_max_f32_e64 v173, v173, -v67
  s_nop 0
  v_permlane32_swap_b32 v228, v229
  v_permlane32_swap_b32 v172, v173
  v_max_f32 v228, v228, v229
  v_max_f32 v172, v172, v173
  v_mov_b32 v230, v228
  v_mov_b32 v174, v172
  s_nop 0
  v_permlane16_swap_b32 v228, v230
  v_permlane16_swap_b32 v172, v174
  v_max_f32 v228, v228, v230
  v_max_f32 v172, v172, v174
  v_mov_b32 v229, v228
  v_mov_b32 v173, v172
  s_nop 0
  v_permlane32_swap_b32 v228, v229
  v_permlane32_swap_b32 v172, v173
  s_waitcnt lgkmcnt(0)
  v_cmp_eq_u32 vcc, 0, v49
  s_nop 0
  s_cbranch_vccnz Llrsc_2
Lldsc_1:
  v_mul_f32_e64 v228, -v228, v48
  v_mul_f32_e64 v172, -v172, v49
  v_mul_f32_e64 v229, -v229, v48
  v_mul_f32_e64 v173, -v173, v49
  v_fma_f32 v232, v52, v48, v228
  v_fma_f32 v176, v60, v49, v172
  v_fma_f32 v240, -v52, v48, v229
  v_fma_f32 v184, -v60, v49, v173
  v_fma_f32 v233, v53, v48, v228
  v_fma_f32 v177, v61, v49, v172
  v_fma_f32 v241, -v53, v48, v229
  v_fma_f32 v185, -v61, v49, v173
  v_fma_f32 v234, v54, v48, v228
  v_fma_f32 v178, v62, v49, v172
  v_fma_f32 v242, -v54, v48, v229
  v_fma_f32 v186, -v62, v49, v173
  v_fma_f32 v235, v55, v48, v228
  v_fma_f32 v179, v63, v49, v172
  v_fma_f32 v243, -v55, v48, v229
  v_fma_f32 v187, -v63, v49, v173
  v_fma_f32 v236, v56, v48, v228
  v_fma_f32 v180, v64, v49, v172
  v_fma_f32 v244, -v56, v48, v229
  v_fma_f32 v188, -v64, v49, v173
  v_fma_f32 v237, v57, v48, v228
  v_fma_f32 v181, v65, v49, v172
  v_fma_f32 v245, -v57, v48, v229
  v_fma_f32 v189, -v65, v49, v173
  v_fma_f32 v238, v58, v48, v228
  v_fma_f32 v182, v66, v49, v172
  v_fma_f32 v246, -v58, v48, v229
  v_fma_f32 v190, -v66, v49, v173
  v_fma_f32 v239, v59, v48, v228
  v_fma_f32 v183, v67, v49, v172
  v_fma_f32 v247, -v59, v48, v229
  v_fma_f32 v191, -v67, v49, v173
  v_exp_f32 v232, v232
  v_exp_f32 v176, v176
  v_exp_f32 v233, v233
  v_exp_f32 v177, v177
  v_exp_f32 v234, v234
  v_exp_f32 v178, v178
  v_exp_f32 v235, v235
  v_exp_f32 v179, v179
  v_exp_f32 v236, v236
  v_exp_f32 v180, v180
  v_exp_f32 v237, v237
  v_exp_f32 v181, v181
  v_exp_f32 v238, v238
  v_exp_f32 v182, v182
  v_exp_f32 v239, v239
  v_exp_f32 v183, v183
  v_exp_f32 v240, v240
  v_exp_f32 v184, v184
  v_exp_f32 v241, v241
  v_exp_f32 v185, v185
  v_exp_f32 v242, v242
  v_exp_f32 v186, v186
  v_exp_f32 v243, v243
  v_exp_f32 v187, v187
  v_exp_f32 v244, v244
  v_exp_f32 v188, v188
  v_exp_f32 v245, v245
  v_exp_f32 v189, v189
  buffer_load_dword v14, v8, s[76:79], 0 offen sc1
  v_exp_f32 v246, v246
  v_exp_f32 v190, v190
  v_exp_f32 v247, v247
  v_exp_f32 v191, v191
  v_add_f32 v248, v232, v233
  v_add_f32 v192, v176, v177
  v_add_f32 v250, v236, v237
  v_add_f32 v194, v180, v181
  v_add_f32 v249, v240, v241
  v_add_f32 v193, v184, v185
  v_add_f32 v251, v244, v245
  v_add_f32 v195, v188, v189
  v_add_f32 v248, v248, v234
  v_add_f32 v192, v192, v178
  v_add_f32 v250, v250, v238
  v_add_f32 v194, v194, v182
  buffer_load_dword v12, v0, s[76:79], s80 offen sc1
  v_add_f32 v249, v249, v242
  v_add_f32 v193, v193, v186
  v_add_f32 v251, v251, v246
  v_add_f32 v195, v195, v190
  v_add_f32 v248, v248, v235
  v_add_f32 v192, v192, v179
  v_add_f32 v250, v250, v239
  v_add_f32 v194, v194, v183
  v_add_f32 v249, v249, v243
  v_add_f32 v193, v193, v187
  v_add_f32 v251, v251, v247
  v_add_f32 v195, v195, v191
  v_fma_f32 v228, v250, v22, v248
  v_fma_f32 v172, v194, v22, v192
  v_fma_f32 v229, v251, v22, v249
  v_fma_f32 v173, v195, v22, v193
  buffer_load_dword v12, v44, s[52:55], 0 offen
  v_permlane32_swap_b32 v228, v229
  v_permlane32_swap_b32 v172, v173
  v_add_f32 v228, v228, v229
  v_add_f32 v172, v172, v173
  v_mov_b32 v230, v228
  v_mov_b32 v174, v172
  s_nop 0
  v_permlane16_swap_b32 v228, v230
  v_permlane16_swap_b32 v172, v174
  v_add_f32 v228, v228, v230
  v_add_f32 v172, v172, v174
  v_mov_b32 v229, v228
  v_mov_b32 v173, v172
  s_nop 0
  v_permlane32_swap_b32 v228, v229
  v_permlane32_swap_b32 v172, v173
  v_rcp_f32 v228, v228
  v_rcp_f32 v172, v172
  v_rcp_f32 v229, v229
  v_rcp_f32 v173, v173
  v_mul_f32 v248, v228, v22
  v_mul_f32 v192, v172, v22
  v_mul_f32 v249, v229, v22
  v_mul_f32 v193, v173, v22
  v_mul_f32 v232, v232, v228
  v_mul_f32 v176, v176, v172
  v_mul_f32 v240, v240, v229
  v_mul_f32 v184, v184, v173
  v_mul_f32 v233, v233, v228
  v_mul_f32 v177, v177, v172
  v_mul_f32 v241, v241, v229
  v_mul_f32 v185, v185, v173
  v_mul_f32 v234, v234, v228
  v_mul_f32 v178, v178, v172
  v_mul_f32 v242, v242, v229
  v_mul_f32 v186, v186, v173
  v_mul_f32 v235, v235, v228
  v_mul_f32 v179, v179, v172
  v_mul_f32 v243, v243, v229
  v_mul_f32 v187, v187, v173
  v_mul_f32 v236, v236, v248
  v_mul_f32 v180, v180, v192
  v_mul_f32 v244, v244, v249
  v_mul_f32 v188, v188, v193
  v_mul_f32 v237, v237, v248
  v_mul_f32 v181, v181, v192
  v_mul_f32 v245, v245, v249
  v_mul_f32 v189, v189, v193
  v_mul_f32 v238, v238, v248
  v_mul_f32 v182, v182, v192
  v_mul_f32 v246, v246, v249
  v_mul_f32 v190, v190, v193
  v_mul_f32 v239, v239, v248
  v_mul_f32 v183, v183, v192
  v_mul_f32 v247, v247, v249
  v_mul_f32 v191, v191, v193
  v_cvt_pk_bf16_f32 v132, v232, v233
  v_cvt_pk_bf16_f32 v140, v176, v177
  v_cvt_pk_bf16_f32 v133, v234, v235
  v_cvt_pk_bf16_f32 v141, v178, v179
  v_cvt_pk_bf16_f32 v134, v236, v237
  v_cvt_pk_bf16_f32 v142, v180, v181
  v_cvt_pk_bf16_f32 v135, v238, v239
  v_cvt_pk_bf16_f32 v143, v182, v183
  v_cvt_pk_bf16_f32 v136, v240, v241
  v_cvt_pk_bf16_f32 v144, v184, v185
  v_cvt_pk_bf16_f32 v137, v242, v243
  v_cvt_pk_bf16_f32 v145, v186, v187
  v_cvt_pk_bf16_f32 v138, v244, v245
  v_cvt_pk_bf16_f32 v146, v188, v189
  v_cvt_pk_bf16_f32 v139, v246, v247
  v_cvt_pk_bf16_f32 v147, v190, v191
  ds_write_b64 v23, v[132:133] offset:0
  ds_write_b64 v46, v[140:141] offset:0
  ds_write_b64 v23, v[134:135] offset:32
  ds_write_b64 v46, v[142:143] offset:32
  ds_write_b64 v23, v[136:137] offset:64
  ds_write_b64 v46, v[144:145] offset:64
  ds_write_b64 v23, v[138:139] offset:96
  ds_write_b64 v46, v[146:147] offset:96
  v_mov_b32 v16, 32
  ds_write_b32 v17, v16 offset:4
  ds_read_b32 v15, v47
  v_cndmask_b32 v16, 3, 32, s[0:1]
  s_waitcnt lgkmcnt(0)
  v_cmp_gt_u32 vcc, v16, v15
  s_nop 0
  s_cbranch_vccnz Llrf3_4
Lldf3_3:
  s_setprio 3
  ds_read_b64_tr_b16 v[132:133], v25 offset:0
  ds_read_b64_tr_b16 v[134:135], v25 offset:3584
  ds_read_b64_tr_b16 v[148:149], v24 offset:0
  ds_read_b64_tr_b16 v[150:151], v24 offset:3584
  ds_read_b64_tr_b16 v[164:165], v24 offset:32
  ds_read_b64_tr_b16 v[166:167], v24 offset:3616
  ds_read_b64_tr_b16 v[136:137], v25 offset:7168
  ds_read_b64_tr_b16 v[138:139], v25 offset:10752
  ds_read_b64_tr_b16 v[152:153], v24 offset:7168
  ds_read_b64_tr_b16 v[154:155], v24 offset:10752
  ds_read_b64_tr_b16 v[168:169], v24 offset:7200
  ds_read_b64_tr_b16 v[170:171], v24 offset:10784
  s_waitcnt lgkmcnt(8)
  v_mfma_f32_16x16x32_bf16 v[52:55], v[148:151], v[132:135], 0
  s_waitcnt lgkmcnt(6)
  v_mfma_f32_16x16x32_bf16 v[56:59], v[164:167], v[132:135], 0
  ds_read_b64_tr_b16 v[140:141], v27 offset:0
  ds_read_b64_tr_b16 v[142:143], v27 offset:14336
  ds_read_b64_tr_b16 v[156:157], v26 offset:0
  ds_read_b64_tr_b16 v[158:159], v26 offset:14336
  ds_read_b64_tr_b16 v[172:173], v26 offset:32
  ds_read_b64_tr_b16 v[174:175], v26 offset:14368
  s_waitcnt lgkmcnt(8)
  v_mfma_f32_16x16x32_bf16 v[52:55], v[152:155], v[136:139], v[52:55]
  s_waitcnt lgkmcnt(6)
  v_mfma_f32_16x16x32_bf16 v[56:59], v[168:171], v[136:139], v[56:59]
  ds_read_b64_tr_b16 v[144:145], v27 offset:28672
  ds_read_b64_tr_b16 v[146:147], v27 offset:43008
  ds_read_b64_tr_b16 v[160:161], v26 offset:28672
  ds_read_b64_tr_b16 v[162:163], v26 offset:43008
  ds_read_b64_tr_b16 v[176:177], v26 offset:28704
  ds_read_b64_tr_b16 v[178:179], v26 offset:43040
  s_waitcnt lgkmcnt(8)
  v_mfma_f32_16x16x32_bf16 v[52:55], v[156:159], v[140:143], v[52:55]
  s_waitcnt lgkmcnt(6)
  v_mfma_f32_16x16x32_bf16 v[56:59], v[172:175], v[140:143], v[56:59]
  s_waitcnt lgkmcnt(2)
  v_mfma_f32_16x16x32_bf16 v[52:55], v[160:163], v[144:147], v[52:55]
  s_waitcnt lgkmcnt(0)
  v_mfma_f32_16x16x32_bf16 v[56:59], v[176:179], v[144:147], v[56:59]
  v_mov_b32 v16, 48
  ds_write_b32 v17, v16 offset:4
  s_mov_b32 s96, 0
  s_mov_b32 s97, 16384
  s_mov_b32 s98, 32768
  s_mov_b32 s99, 49152
  v_cvt_pk_bf16_f32 v60, v52, v53
  v_cvt_pk_bf16_f32 v61, v54, v55
  v_cvt_pk_bf16_f32 v62, v56, v57
  v_cvt_pk_bf16_f32 v63, v58, v59
  buffer_store_dwordx4 v[60:63], v31, s[76:79], 0 offen sc1
  ds_read_b32 v15, v47
  s_waitcnt vmcnt(3)
  v_and_b32 v16, -16, v14
  v_cmp_ne_u32 vcc, s9, v16
  s_nop 0
  s_cbranch_vccnz Lprhello_6
Lpdhello_5:
  v_cmp_ne_u32 vcc, s10, v14
  s_nop 0
  s_and_b32 s10, vcc_lo, 0xffff
  s_cmp_lg_u32 s8, 0
  s_cbranch_scc1 Lns1_7
  v_mov_b32 v5, 0
  buffer_load_dwordx4 v[76:79], v50, s[76:79], s96 offen sc1
  buffer_load_dwordx4 v[80:83], v50, s[76:79], s97 offen sc1
  buffer_load_dwordx4 v[84:87], v50, s[76:79], s98 offen sc1
  buffer_load_dwordx4 v[88:91], v50, s[76:79], s99 offen sc1
  v_add_u32 v5, 1, v5
  ds_write_b32 v17, v5 offset:16
  v_cndmask_b32 v16, 3, 48, s[0:1]
  s_waitcnt lgkmcnt(1)
  v_cmp_gt_u32 vcc, v16, v15
  s_nop 0
  s_cbranch_vccnz Llrf3_10
Lldf3_9:
  v_mov_b32 v7, s10
  v_mov_b32 v16, 162816
  ds_write_b32 v16, v7
  v_mov_b32 v16, 159744
  v_lshl_add_u32 v16, v2, 2, v16
  ds_write_b32 v16, v13
  s_lshl_b32 s12, s5, 12
  s_add_u32 s12, s12, 2031616
  v_add_u32 v6, 155648, v4
  s_mov_b32 s92, s12
  s_lshl_b32 s12, s6, 6
  s_lshl_b32 s13, s8, 4
  s_add_u32 s12, s12, s13
  v_add_u32 v15, s12, v2
  v_mul_u32_u24 v15, 896, v15
  s_lshl_b32 s12, s7, 7
  v_lshl_add_u32 v15, v3, 3, v15
  buffer_load_dwordx2 v[52:53], v15, s[40:43], s12 offen offset:0
  buffer_load_dwordx2 v[54:55], v15, s[40:43], s12 offen offset:32
  buffer_load_dwordx2 v[56:57], v15, s[40:43], s12 offen offset:64
  buffer_load_dwordx2 v[58:59], v15, s[40:43], s12 offen offset:96
  v_and_b32 v15, 1, v3
  v_lshrrev_b32 v16, 1, v3
  v_lshl_add_u32 v26, v15, 1, v16
  v_mov_b32 v20, 2147418112
  v_cmp_eq_u32 vcc, 0, v1
  s_nop 1
  v_cndmask_b32 v21, v20, v13, vcc
  v_mov_b32 v27, s9
  s_waitcnt vmcnt(7)
  v_mfma_f32_16x16x32_bf16 v[144:147], v[252:255], v[76:79], 0
  s_waitcnt vmcnt(6)
  v_mfma_f32_16x16x32_bf16 v[144:147], v[252:255], v[80:83], v[144:147]
  s_waitcnt vmcnt(5)
  v_mfma_f32_16x16x32_bf16 v[144:147], v[252:255], v[84:87], v[144:147]
  s_waitcnt vmcnt(4)
  v_mfma_f32_16x16x32_bf16 v[144:147], v[252:255], v[88:91], v[144:147]
  s_nop 7
  v_cmp_u_f32 vcc, v144, v144
  s_nop 0
  s_cbranch_vccnz Lprs1_12
Lpds1_11:
  v_cvt_pk_bf16_f32 v152, v144, v145
  v_cvt_pk_bf16_f32 v153, v146, v147
  buffer_store_dwordx2 v[152:153], v51, s[76:79], 0 offen sc1
  buffer_load_dwordx4 v[76:79], v4, s[76:79], s92 offen offset:0 sc1
  buffer_load_dwordx4 v[80:83], v4, s[76:79], s92 offen offset:1024 sc1
  buffer_load_dwordx4 v[84:87], v4, s[76:79], s92 offen offset:2048 sc1
  buffer_load_dwordx4 v[88:91], v4, s[76:79], s92 offen offset:3072 sc1
  v_add_u32 v5, 1, v5
  ds_write_b32 v17, v5 offset:16
  v_bfe_u32 v15, v1, 2, 2
  v_lshl_add_u32 v16, v3, 3, v15
  v_lshlrev_b32 v16, 7, v16
  v_and_b32 v14, 3, v1
  v_lshl_add_u32 v16, v14, 3, v16
  v_lshrrev_b32 v15, 1, v15
  v_and_b32 v14, 1, v3
  v_lshl_add_u32 v15, v14, 1, v15
  v_lshl_add_u32 v39, v15, 5, v16
  s_and_b32 s13, s8, 2
  s_and_b32 s14, s8, 1
  s_mul_i32 s12, s13, 14336
  s_add_u32 s12, s12, s80
  v_add_u32 v28, s12, v4
  s_mul_i32 s86, s14, 21504
  s_mul_i32 s87, s14, 7168
  s_sub_u32 s87, 14336, s87
  s_lshl_b32 s12, s13, 6
  s_lshl_b32 s14, s14, 5
  s_add_u32 s12, s12, s14
  s_add_u32 s12, s12, s80
  s_add_u32 s12, s12, 200704
  v_and_b32 v15, 8, v1
  v_lshlrev_b32 v15, 3, v15
  v_and_b32 v16, 7, v1
  v_lshl_add_u32 v15, v16, 2, v15
  v_add_u32 v254, s12, v15
  s_mul_i32 s12, s8, 14336
  s_add_u32 s12, s12, s80
  s_lshl_b32 s13, s7, 11
  s_add_u32 s12, s12, s13
  v_lshlrev_b32 v46, 8, v26
  v_lshl_add_u32 v46, v2, 4, v46
  v_add_u32 v29, s12, v46
  s_lshl_b32 s12, s8, 3
  s_add_u32 s12, s12, s7
  s_lshl_b32 s12, s12, 8
  s_add_u32 s12, s12, s80
  s_add_u32 s12, s12, 201728
  v_add_u32 v9, s12, v4
  v_cmp_eq_u32 vcc, 0, v3
  s_nop 1
  v_cndmask_b32 v9, v20, v9, vcc
  s_lshl_b32 s12, s84, 11
  s_add_u32 s12, s12, s80
  s_add_u32 s12, s12, 201728
  v_add_u32 v30, s12, v4
  v_add_u32 v31, 1024, v30
  v_cmp_eq_u32 vcc, 3, v3
  s_nop 1
  v_cndmask_b32 v31, v31, v30, vcc
  v_mov_b32 v42, 0
  v_mov_b32 v43, 0
  s_add_u32 s12, s80, 745472
  s_cmp_eq_u32 s6, 31
  s_cselect_b32 s12, 2147418112, s12
  s_sub_u32 s13, s80, 559104
  s_cmp_eq_u32 s6, 0
  s_cselect_b32 s13, 2147418112, s13
  s_cmp_eq_u32 s8, 3
  s_cselect_b32 s12, s12, s13
  s_cselect_b32 s14, 0xc000c000, 0
  s_cmp_eq_u32 s8, 0
  s_cselect_b32 s14, 0x00030003, s14
  s_mov_b32 s15, s14
  s_lshl_b32 s13, s7, 11
  s_add_u32 s12, s12, s13
  v_and_b32 v15, 1, v2
  v_lshl_add_u32 v15, v26, 1, v15
  v_lshlrev_b32 v15, 4, v15
  v_add_u32 v15, s12, v15
  v_cndmask_b32 v252, v20, v15, s[14:15]
  s_and_b32 s14, s8, 1
  s_lshl_b32 s15, s14, 1
  s_sub_u32 s13, s15, 1
  v_and_b32 v44, 1, v3
  v_add_u32 v44, s15, v44
  v_lshrrev_b32 v45, 1, v3
  v_sub_u32 v15, v44, v3
  v_mul_u32_u24 v16, 28, v45
  v_add_u32 v15, v15, v16
  v_add_u32 v15, 12, v15
  v_lshl_add_u32 v40, v15, 10, v39
  s_lshl_b32 s14, s14, 12
  s_add_u32 s14, s14, s80
  v_mov_b32 v16, s14
  v_lshl_add_u32 v16, v3, 8, v16
  v_mul_i32_i24 v48, -14, v3
  s_xor_b32 s12, s8, 1
  s_lshl_b32 s12, s12, 4
  s_add_u32 s12, s12, 16
  s_add_u32 s12, s12, s13
  v_add_u32 v14, s12, v2
  v_lshrrev_b32 v244, 4, v14
  v_mul_u32_u24 v244, 14336, v244
  v_add_u32 v15, -16, v14
  v_cmp_lt_u32 vcc, 63, v15
  v_and_b32 v15, 1, v14
  v_and_b32 v14, 15, v14
  v_add_u32 v15, v15, v48
  v_cndmask_b32 v14, v14, v15, vcc
  v_lshl_add_u32 v244, v14, 4, v244
  v_add_u32 v244, v244, v16
  s_xor_b32 s12, s8, 0
  s_lshl_b32 s12, s12, 4
  s_add_u32 s12, s12, 16
  s_add_u32 s12, s12, s13
  v_add_u32 v14, s12, v2
  v_lshrrev_b32 v247, 4, v14
  v_mul_u32_u24 v247, 14336, v247
  v_add_u32 v15, -16, v14
  v_cmp_lt_u32 vcc, 63, v15
  v_and_b32 v15, 1, v14
  v_and_b32 v14, 15, v14
  v_add_u32 v15, v15, v48
  v_cndmask_b32 v14, v14, v15, vcc
  v_lshl_add_u32 v247, v14, 4, v247
  v_add_u32 v247, v247, v16
  s_xor_b32 s12, s8, 1
  s_lshl_b32 s12, s12, 4
  s_add_u32 s12, s12, 16
  s_add_u32 s12, s12, s13
  s_add_u32 s12, s12, s13
  v_add_u32 v14, s12, v2
  v_lshrrev_b32 v245, 4, v14
  v_mul_u32_u24 v245, 14336, v245
  v_add_u32 v15, -16, v14
  v_cmp_lt_u32 vcc, 63, v15
  v_and_b32 v15, 1, v14
  v_and_b32 v14, 15, v14
  v_add_u32 v15, v15, v48
  v_cndmask_b32 v14, v14, v15, vcc
  v_lshl_add_u32 v245, v14, 4, v245
  v_add_u32 v245, v245, v16
  s_xor_b32 s12, s8, 0
  s_lshl_b32 s12, s12, 4
  s_add_u32 s12, s12, 16
  s_add_u32 s12, s12, s13
  s_add_u32 s12, s12, s13
  v_add_u32 v14, s12, v2
  v_lshrrev_b32 v248, 4, v14
  v_mul_u32_u24 v248, 14336, v248
  v_add_u32 v15, -16, v14
  v_cmp_lt_u32 vcc, 63, v15
  v_and_b32 v15, 1, v14
  v_and_b32 v14, 15, v14
  v_add_u32 v15, v15, v48
  v_cndmask_b32 v14, v14, v15, vcc
  v_lshl_add_u32 v248, v14, 4, v248
  v_add_u32 v248, v248, v16
  v_mul_u32_u24 v16, 7168, v45
  v_add_u32 v16, s80, v16
  v_add_u32 v16, 3072, v16
  v_add_u32 v45, 1, v45
  v_mul_i32_i24 v45, s13, v45
  v_lshl_add_u32 v16, v44, 8, v16
  v_mul_i32_i24 v48, -14, v44
  s_xor_b32 s12, s8, 1
  s_lshl_b32 s12, s12, 4
  s_add_u32 s12, s12, 16
  v_add3_u32 v14, s12, v2, v45
  v_lshrrev_b32 v246, 4, v14
  v_mul_u32_u24 v246, 14336, v246
  v_add_u32 v15, -16, v14
  v_cmp_lt_u32 vcc, 63, v15
  v_and_b32 v15, 1, v14
  v_and_b32 v14, 15, v14
  v_add_u32 v15, v15, v48
  v_cndmask_b32 v14, v14, v15, vcc
  v_lshl_add_u32 v246, v14, 4, v246
  v_add_u32 v246, v246, v16
  s_xor_b32 s12, s8, 0
  s_lshl_b32 s12, s12, 4
  s_add_u32 s12, s12, 16
  v_add3_u32 v14, s12, v2, v45
  v_lshrrev_b32 v249, 4, v14
  v_mul_u32_u24 v249, 14336, v249
  v_add_u32 v15, -16, v14
  v_cmp_lt_u32 vcc, 63, v15
  v_and_b32 v15, 1, v14
  v_and_b32 v14, 15, v14
  v_add_u32 v15, v15, v48
  v_cndmask_b32 v14, v14, v15, vcc
  v_lshl_add_u32 v249, v14, 4, v249
  v_add_u32 v249, v249, v16
  s_lshl_b32 s12, s8, 5
  s_lshl_b32 s14, s7, 2
  s_add_u32 s12, s12, s14
  s_add_u32 s14, s80, 200960
  s_add_u32 s12, s12, s14
  v_add_u32 v18, s12, v21
  s_and_b32 s12, s8, 2
  s_lshl_b32 s12, s12, 5
  s_mul_i32 s13, s15, 6
  s_add_u32 s12, s12, s13
  s_add_u32 s12, s12, s14
  v_and_b32 v15, 4, v1
  v_lshlrev_b32 v15, 3, v15
  v_and_b32 v16, 3, v1
  v_lshl_add_u32 v15, v16, 2, v15
  v_add_u32 v255, s12, v15
  s_mov_b32 s12, 0x66665321
  s_cmp_eq_u32 s15, 0
  s_cselect_b32 s12, 0x55554310, s12
  v_and_b32 v16, 7, v1
  v_lshlrev_b32 v16, 2, v16
  v_lshrrev_b32 v16, v16, s12
  v_and_b32 v16, 7, v16
  v_lshlrev_b32 v16, 2, v16
  v_lshrrev_b32 v15, 3, v1
  v_min_u32 v15, 2, v15
  v_add_u32 v15, s8, v15
  v_add_u32 v15, -1, v15
  v_med3_i32 v15, v15, 0, 3
  v_lshl_add_u32 v15, v15, 5, v16
  v_add_u32 v250, s14, v15
  s_mov_b32 s12, 2147418112
  s_cmp_eq_u32 s8, 0
  s_cselect_b32 s12, 57344, s12
  s_cmp_eq_u32 s8, 3
  s_cselect_b32 s12, 132096, s12
  s_add_u32 s12, s12, s80
  v_and_b32 v15, 3, v1
  v_bfe_u32 v16, v1, 2, 1
  v_mul_u32_u24 v16, 7, v16
  v_add_u32 v15, v15, v16
  v_lshlrev_b32 v15, 10, v15
  v_add_u32 v19, s12, v15
  s_lshl_b32 s12, s8, 2
  s_add_u32 s12, s12, 159744
  v_mov_b32 v251, s12
  v_and_b32 v253, 7, v1
  v_lshlrev_b32 v253, 2, v253
  v_add_u32 v253, 159744, v253
  s_waitcnt vmcnt(8)
  v_lshlrev_b32 v60, 16, v52
  v_and_b32 v61, 0xffff0000, v52
  v_lshlrev_b32 v62, 16, v53
  v_and_b32 v63, 0xffff0000, v53
  s_waitcnt vmcnt(7)
  v_lshlrev_b32 v64, 16, v54
  v_and_b32 v65, 0xffff0000, v54
  v_lshlrev_b32 v66, 16, v55
  v_and_b32 v67, 0xffff0000, v55
  s_waitcnt vmcnt(6)
  v_lshlrev_b32 v68, 16, v56
  v_and_b32 v69, 0xffff0000, v56
  v_lshlrev_b32 v70, 16, v57
  v_and_b32 v71, 0xffff0000, v57
  s_waitcnt vmcnt(5)
  v_lshlrev_b32 v72, 16, v58
  v_and_b32 v73, 0xffff0000, v58
  v_lshlrev_b32 v74, 16, v59
  v_and_b32 v75, 0xffff0000, v59
  s_waitcnt vmcnt(2)
  v_max3_u32 v144, v76, v78, v80
  s_waitcnt vmcnt(1)
  v_max3_u32 v145, v82, v84, v86
  s_waitcnt vmcnt(0)
  v_max3_u32 v144, v144, v88, v90
  v_max_u32 v144, v144, v145
  v_cmp_eq_u32 vcc, -1, v144
  s_nop 0
  s_cbranch_vccnz Lprs2_14
Lpds2_13:
  ds_write_b128 v6, v[76:79] offset:0
  ds_write_b128 v6, v[80:83] offset:1024
  ds_write_b128 v6, v[84:87] offset:2048
  ds_write_b128 v6, v[88:91] offset:3072
  v_mov_b32 v16, 60
  ds_write_b32 v17, v16 offset:4
  s_setprio 0
  s_branch Lkj_8
Lns1_7:
  s_setprio 0
  s_and_b32 s12, s84, 1
  s_lshl_b32 s12, s12, 6
  v_xor_b32 v10, s12, v11
  s_mul_i32 s12, s84, 7168
  v_subrev_u32 v10, s12, v10
  v_cndmask_b32 v16, 3, 48, s[0:1]
  s_waitcnt lgkmcnt(0)
  v_cmp_gt_u32 vcc, v16, v15
  s_nop 0
  s_cbranch_vccnz Llrf3_16
Lldf3_15:
  v_mov_b32 v5, 154816
  s_add_u32 m0, s95, 0
  s_mov_b32 s93, 0
  buffer_load_dwordx4 v11, s[52:55], s93 offen lds
  s_lshl_b32 s12, s84, 2
  s_lshr_b32 s12, 8448, s12
  s_and_b32 s12, s12, 15
  s_mul_i32 s93, s12, 28672
  s_lshl_b32 s12, s12, 12
  s_add_u32 m0, s12, 0
  s_nop 0
  buffer_load_dwordx4 v10, s[52:55], s93 offen lds
  s_add_u32 m0, s95, 4096
  s_mov_b32 s93, 28672
  buffer_load_dwordx4 v11, s[52:55], s93 offen lds
  s_add_u32 m0, s95, 8192
  s_mov_b32 s93, 57344
  buffer_load_dwordx4 v11, s[52:55], s93 offen lds
  s_add_u32 m0, s95, 12288
  s_mov_b32 s93, 86016
  buffer_load_dwordx4 v11, s[52:55], s93 offen lds
  s_lshl_b32 s12, s84, 2
  s_lshr_b32 s12, 21552, s12
  s_and_b32 s12, s12, 15
  s_mul_i32 s93, s12, 28672
  s_lshl_b32 s12, s12, 12
  s_add_u32 m0, s12, 0
  s_nop 0
  buffer_load_dwordx4 v10, s[52:55], s93 offen lds
  s_add_u32 m0, s95, 16384
  s_mov_b32 s93, 114688
  buffer_load_dwordx4 v11, s[52:55], s93 offen lds
  s_add_u32 m0, s95, 20480
  s_mov_b32 s93, 143360
  buffer_load_dwordx4 v11, s[52:55], s93 offen lds
  s_add_u32 m0, s95, 24576
  s_mov_b32 s93, 172032
  buffer_load_dwordx4 v11, s[52:55], s93 offen lds
  s_lshl_b32 s12, s84, 2
  s_lshr_b32 s12, 34656, s12
  s_and_b32 s12, s12, 15
  s_mul_i32 s93, s12, 28672
  s_lshl_b32 s12, s12, 12
  s_add_u32 m0, s12, 0
  s_nop 0
  buffer_load_dwordx4 v10, s[52:55], s93 offen lds
  s_add_u32 m0, s95, 28672
  s_mov_b32 s93, 200704
  buffer_load_dwordx4 v11, s[52:55], s93 offen lds
  s_add_u32 m0, s95, 32768
  s_mov_b32 s93, 229376
  buffer_load_dwordx4 v11, s[52:55], s93 offen lds
  s_add_u32 m0, s95, 36864
  s_mov_b32 s93, 258048
  buffer_load_dwordx4 v11, s[52:55], s93 offen lds
  s_lshl_b32 s12, s84, 2
  s_lshr_b32 s12, 47760, s12
  s_and_b32 s12, s12, 15
  s_mul_i32 s93, s12, 28672
  s_lshl_b32 s12, s12, 12
  s_add_u32 m0, s12, 0
  s_nop 0
  buffer_load_dwordx4 v10, s[52:55], s93 offen lds
  s_add_u32 m0, s95, 40960
  s_mov_b32 s93, 286720
  buffer_load_dwordx4 v11, s[52:55], s93 offen lds
  s_add_u32 m0, s95, 45056
  s_mov_b32 s93, 315392
  buffer_load_dwordx4 v11, s[52:55], s93 offen lds
  s_add_u32 m0, s95, 49152
  s_mov_b32 s93, 344064
  buffer_load_dwordx4 v11, s[52:55], s93 offen lds
  s_lshl_b32 s12, s84, 2
  s_lshr_b32 s12, 56768, s12
  s_and_b32 s12, s12, 15
  s_mul_i32 s93, s12, 28672
  s_lshl_b32 s12, s12, 12
  s_add_u32 m0, s12, 0
  s_nop 0
  buffer_load_dwordx4 v10, s[52:55], s93 offen lds
  s_add_u32 m0, s95, 53248
  s_mov_b32 s93, 372736
  buffer_load_dwordx4 v11, s[52:55], s93 offen lds
  s_add_u32 m0, s95, 61440
  s_mov_b32 s93, 28672
  buffer_load_dwordx4 v11, s[56:59], s93 offen lds
  s_lshl_b32 s12, s84, 2
  s_lshr_b32 s12, 21008, s12
  s_and_b32 s12, s12, 15
  s_mul_i32 s93, s12, 28672
  s_lshl_b32 s12, s12, 12
  s_add_u32 m0, s12, 57344
  s_nop 0
  buffer_load_dwordx4 v10, s[56:59], s93 offen lds
  s_add_u32 m0, s95, 65536
  s_mov_b32 s93, 57344
  buffer_load_dwordx4 v11, s[56:59], s93 offen lds
  s_add_u32 m0, s95, 77824
  s_mov_b32 s93, 143360
  buffer_load_dwordx4 v11, s[56:59], s93 offen lds
  s_add_u32 m0, s95, 81920
  s_mov_b32 s93, 172032
  buffer_load_dwordx4 v11, s[56:59], s93 offen lds
  s_lshl_b32 s12, s84, 2
  s_lshr_b32 s12, 39008, s12
  s_and_b32 s12, s12, 15
  s_mul_i32 s93, s12, 28672
  s_lshl_b32 s12, s12, 12
  s_add_u32 m0, s12, 57344
  s_nop 0
  buffer_load_dwordx4 v10, s[56:59], s93 offen lds
  s_add_u32 m0, s95, 90112
  s_mov_b32 s93, 229376
  buffer_load_dwordx4 v11, s[56:59], s93 offen lds
  s_add_u32 m0, s95, 94208
  s_mov_b32 s93, 258048
  buffer_load_dwordx4 v11, s[56:59], s93 offen lds
  s_add_u32 m0, s95, 106496
  s_mov_b32 s93, 344064
  buffer_load_dwordx4 v11, s[56:59], s93 offen lds
  s_lshl_b32 s12, s84, 2
  s_lshr_b32 s12, 3520, s12
  s_and_b32 s12, s12, 15
  s_mul_i32 s93, s12, 28672
  s_lshl_b32 s12, s12, 12
  s_add_u32 m0, s12, 57344
  s_nop 0
  buffer_load_dwordx4 v10, s[56:59], s93 offen lds
  s_add_u32 m0, s95, 110592
  s_mov_b32 s93, 372736
  buffer_load_dwordx4 v11, s[56:59], s93 offen lds
  s_add_u32 m0, s95, 57344
  s_mov_b32 s93, 0
  buffer_load_dwordx4 v11, s[56:59], s93 offen lds
  s_add_u32 m0, s95, 69632
  s_mov_b32 s93, 86016
  buffer_load_dwordx4 v11, s[56:59], s93 offen lds
  s_lshl_b32 s12, s84, 2
  s_lshr_b32 s12, 29744, s12
  s_and_b32 s12, s12, 15
  s_mul_i32 s93, s12, 28672
  s_lshl_b32 s12, s12, 12
  s_add_u32 m0, s12, 57344
  s_nop 0
  buffer_load_dwordx4 v10, s[56:59], s93 offen lds
  s_add_u32 m0, s95, 73728
  s_mov_b32 s93, 114688
  buffer_load_dwordx4 v11, s[56:59], s93 offen lds
  s_add_u32 m0, s95, 86016
  s_mov_b32 s93, 200704
  buffer_load_dwordx4 v11, s[56:59], s93 offen lds
  s_lshl_b32 s12, s6, 6
  s_lshl_b32 s13, s8, 4
  s_add_u32 s12, s12, s13
  v_add_u32 v15, s12, v2
  v_mul_u32_u24 v15, 896, v15
  s_lshl_b32 s12, s7, 7
  v_lshl_add_u32 v15, v3, 3, v15
  buffer_load_dwordx2 v[52:53], v15, s[40:43], s12 offen offset:0
  buffer_load_dwordx2 v[54:55], v15, s[40:43], s12 offen offset:32
  buffer_load_dwordx2 v[56:57], v15, s[40:43], s12 offen offset:64
  buffer_load_dwordx2 v[58:59], v15, s[40:43], s12 offen offset:96
  v_and_b32 v15, 1, v3
  v_lshrrev_b32 v16, 1, v3
  v_lshl_add_u32 v26, v15, 1, v16
  v_mov_b32 v20, 2147418112
  v_cmp_eq_u32 vcc, 0, v1
  s_nop 1
  v_cndmask_b32 v21, v20, v13, vcc
  v_mov_b32 v27, s9
  s_lshl_b32 s12, s7, 9
  s_lshr_b32 s13, s84, 1
  s_lshl_b32 s13, s13, 7
  s_add_u32 s12, s12, s13
  s_and_b32 s13, s84, 1
  s_mul_i32 s13, s13, 28672
  s_add_u32 s12, s12, s13
  s_cmp_eq_u32 s7, 7
  s_cselect_b32 s12, 2147418112, s12
  v_lshrrev_b32 v15, 3, v1
  v_mul_u32_u24 v6, 3584, v15
  v_bfe_u32 v15, v1, 4, 1
  v_lshlrev_b32 v15, 2, v15
  v_and_b32 v16, 7, v1
  v_xor_b32 v15, v15, v16
  v_lshl_add_u32 v6, v15, 4, v6
  v_add_u32 v6, s12, v6
  s_lshr_b32 s12, s84, 1
  s_lshl_b32 s12, s12, 7
  s_and_b32 s13, s84, 1
  s_mul_i32 s13, s13, 28672
  s_add_u32 s12, s12, s13
  v_subrev_u32 v7, s12, v6
  v_bfe_u32 v15, v1, 2, 2
  v_lshl_add_u32 v16, v3, 3, v15
  v_lshlrev_b32 v16, 7, v16
  v_and_b32 v14, 3, v1
  v_lshl_add_u32 v16, v14, 3, v16
  v_lshrrev_b32 v15, 1, v15
  v_and_b32 v14, 1, v3
  v_lshl_add_u32 v15, v14, 1, v15
  v_lshl_add_u32 v39, v15, 5, v16
  s_and_b32 s13, s8, 2
  s_and_b32 s14, s8, 1
  s_mul_i32 s12, s13, 14336
  s_add_u32 s12, s12, s80
  v_add_u32 v28, s12, v4
  s_mul_i32 s86, s14, 21504
  s_mul_i32 s87, s14, 7168
  s_sub_u32 s87, 14336, s87
  s_lshl_b32 s12, s13, 6
  s_lshl_b32 s14, s14, 5
  s_add_u32 s12, s12, s14
  s_add_u32 s12, s12, s80
  s_add_u32 s12, s12, 200704
  v_and_b32 v15, 8, v1
  v_lshlrev_b32 v15, 3, v15
  v_and_b32 v16, 7, v1
  v_lshl_add_u32 v15, v16, 2, v15
  v_add_u32 v254, s12, v15
  s_mul_i32 s12, s8, 14336
  s_add_u32 s12, s12, s80
  s_lshl_b32 s13, s7, 11
  s_add_u32 s12, s12, s13
  v_lshlrev_b32 v46, 8, v26
  v_lshl_add_u32 v46, v2, 4, v46
  v_add_u32 v29, s12, v46
  s_lshl_b32 s12, s8, 3
  s_add_u32 s12, s12, s7
  s_lshl_b32 s12, s12, 8
  s_add_u32 s12, s12, s80
  s_add_u32 s12, s12, 201728
  v_add_u32 v9, s12, v4
  v_cmp_eq_u32 vcc, 0, v3
  s_nop 1
  v_cndmask_b32 v9, v20, v9, vcc
  s_lshl_b32 s12, s84, 11
  s_add_u32 s12, s12, s80
  s_add_u32 s12, s12, 201728
  v_add_u32 v30, s12, v4
  v_add_u32 v31, 1024, v30
  v_cmp_eq_u32 vcc, 3, v3
  s_nop 1
  v_cndmask_b32 v31, v31, v30, vcc
  v_mov_b32 v42, 0
  v_mov_b32 v43, 0
  s_add_u32 s12, s80, 745472
  s_cmp_eq_u32 s6, 31
  s_cselect_b32 s12, 2147418112, s12
  s_sub_u32 s13, s80, 559104
  s_cmp_eq_u32 s6, 0
  s_cselect_b32 s13, 2147418112, s13
  s_cmp_eq_u32 s8, 3
  s_cselect_b32 s12, s12, s13
  s_cselect_b32 s14, 0xc000c000, 0
  s_cmp_eq_u32 s8, 0
  s_cselect_b32 s14, 0x00030003, s14
  s_mov_b32 s15, s14
  s_lshl_b32 s13, s7, 11
  s_add_u32 s12, s12, s13
  v_and_b32 v15, 1, v2
  v_lshl_add_u32 v15, v26, 1, v15
  v_lshlrev_b32 v15, 4, v15
  v_add_u32 v15, s12, v15
  v_cndmask_b32 v252, v20, v15, s[14:15]
  s_and_b32 s14, s8, 1
  s_lshl_b32 s15, s14, 1
  s_sub_u32 s13, s15, 1
  v_and_b32 v44, 1, v3
  v_add_u32 v44, s15, v44
  v_lshrrev_b32 v45, 1, v3
  v_sub_u32 v15, v44, v3
  v_mul_u32_u24 v16, 28, v45
  v_add_u32 v15, v15, v16
  v_add_u32 v15, 12, v15
  v_lshl_add_u32 v40, v15, 10, v39
  s_lshl_b32 s14, s14, 12
  s_add_u32 s14, s14, s80
  v_mov_b32 v16, s14
  v_lshl_add_u32 v16, v3, 8, v16
  v_mul_i32_i24 v48, -14, v3
  s_xor_b32 s12, s8, 1
  s_lshl_b32 s12, s12, 4
  s_add_u32 s12, s12, 16
  s_add_u32 s12, s12, s13
  v_add_u32 v14, s12, v2
  v_lshrrev_b32 v244, 4, v14
  v_mul_u32_u24 v244, 14336, v244
  v_add_u32 v15, -16, v14
  v_cmp_lt_u32 vcc, 63, v15
  v_and_b32 v15, 1, v14
  v_and_b32 v14, 15, v14
  v_add_u32 v15, v15, v48
  v_cndmask_b32 v14, v14, v15, vcc
  v_lshl_add_u32 v244, v14, 4, v244
  v_add_u32 v244, v244, v16
  s_xor_b32 s12, s8, 0
  s_lshl_b32 s12, s12, 4
  s_add_u32 s12, s12, 16
  s_add_u32 s12, s12, s13
  v_add_u32 v14, s12, v2
  v_lshrrev_b32 v247, 4, v14
  v_mul_u32_u24 v247, 14336, v247
  v_add_u32 v15, -16, v14
  v_cmp_lt_u32 vcc, 63, v15
  v_and_b32 v15, 1, v14
  v_and_b32 v14, 15, v14
  v_add_u32 v15, v15, v48
  v_cndmask_b32 v14, v14, v15, vcc
  v_lshl_add_u32 v247, v14, 4, v247
  v_add_u32 v247, v247, v16
  s_xor_b32 s12, s8, 1
  s_lshl_b32 s12, s12, 4
  s_add_u32 s12, s12, 16
  s_add_u32 s12, s12, s13
  s_add_u32 s12, s12, s13
  v_add_u32 v14, s12, v2
  v_lshrrev_b32 v245, 4, v14
  v_mul_u32_u24 v245, 14336, v245
  v_add_u32 v15, -16, v14
  v_cmp_lt_u32 vcc, 63, v15
  v_and_b32 v15, 1, v14
  v_and_b32 v14, 15, v14
  v_add_u32 v15, v15, v48
  v_cndmask_b32 v14, v14, v15, vcc
  v_lshl_add_u32 v245, v14, 4, v245
  v_add_u32 v245, v245, v16
  s_xor_b32 s12, s8, 0
  s_lshl_b32 s12, s12, 4
  s_add_u32 s12, s12, 16
  s_add_u32 s12, s12, s13
  s_add_u32 s12, s12, s13
  v_add_u32 v14, s12, v2
  v_lshrrev_b32 v248, 4, v14
  v_mul_u32_u24 v248, 14336, v248
  v_add_u32 v15, -16, v14
  v_cmp_lt_u32 vcc, 63, v15
  v_and_b32 v15, 1, v14
  v_and_b32 v14, 15, v14
  v_add_u32 v15, v15, v48
  v_cndmask_b32 v14, v14, v15, vcc
  v_lshl_add_u32 v248, v14, 4, v248
  v_add_u32 v248, v248, v16
  v_mul_u32_u24 v16, 7168, v45
  v_add_u32 v16, s80, v16
  v_add_u32 v16, 3072, v16
  v_add_u32 v45, 1, v45
  v_mul_i32_i24 v45, s13, v45
  v_lshl_add_u32 v16, v44, 8, v16
  v_mul_i32_i24 v48, -14, v44
  s_xor_b32 s12, s8, 1
  s_lshl_b32 s12, s12, 4
  s_add_u32 s12, s12, 16
  v_add3_u32 v14, s12, v2, v45
  v_lshrrev_b32 v246, 4, v14
  v_mul_u32_u24 v246, 14336, v246
  v_add_u32 v15, -16, v14
  v_cmp_lt_u32 vcc, 63, v15
  v_and_b32 v15, 1, v14
  v_and_b32 v14, 15, v14
  v_add_u32 v15, v15, v48
  v_cndmask_b32 v14, v14, v15, vcc
  v_lshl_add_u32 v246, v14, 4, v246
  v_add_u32 v246, v246, v16
  s_xor_b32 s12, s8, 0
  s_lshl_b32 s12, s12, 4
  s_add_u32 s12, s12, 16
  v_add3_u32 v14, s12, v2, v45
  v_lshrrev_b32 v249, 4, v14
  v_mul_u32_u24 v249, 14336, v249
  v_add_u32 v15, -16, v14
  v_cmp_lt_u32 vcc, 63, v15
  v_and_b32 v15, 1, v14
  v_and_b32 v14, 15, v14
  v_add_u32 v15, v15, v48
  v_cndmask_b32 v14, v14, v15, vcc
  v_lshl_add_u32 v249, v14, 4, v249
  v_add_u32 v249, v249, v16
  s_lshl_b32 s12, s8, 5
  s_lshl_b32 s14, s7, 2
  s_add_u32 s12, s12, s14
  s_add_u32 s14, s80, 200960
  s_add_u32 s12, s12, s14
  v_add_u32 v18, s12, v21
  s_and_b32 s12, s8, 2
  s_lshl_b32 s12, s12, 5
  s_mul_i32 s13, s15, 6
  s_add_u32 s12, s12, s13
  s_add_u32 s12, s12, s14
  v_and_b32 v15, 4, v1
  v_lshlrev_b32 v15, 3, v15
  v_and_b32 v16, 3, v1
  v_lshl_add_u32 v15, v16, 2, v15
  v_add_u32 v255, s12, v15
  s_mov_b32 s12, 0x66665321
  s_cmp_eq_u32 s15, 0
  s_cselect_b32 s12, 0x55554310, s12
  v_and_b32 v16, 7, v1
  v_lshlrev_b32 v16, 2, v16
  v_lshrrev_b32 v16, v16, s12
  v_and_b32 v16, 7, v16
  v_lshlrev_b32 v16, 2, v16
  v_lshrrev_b32 v15, 3, v1
  v_min_u32 v15, 2, v15
  v_add_u32 v15, s8, v15
  v_add_u32 v15, -1, v15
  v_med3_i32 v15, v15, 0, 3
  v_lshl_add_u32 v15, v15, 5, v16
  v_add_u32 v250, s14, v15
  s_mov_b32 s12, 2147418112
  s_cmp_eq_u32 s8, 0
  s_cselect_b32 s12, 57344, s12
  s_cmp_eq_u32 s8, 3
  s_cselect_b32 s12, 132096, s12
  s_add_u32 s12, s12, s80
  v_and_b32 v15, 3, v1
  v_bfe_u32 v16, v1, 2, 1
  v_mul_u32_u24 v16, 7, v16
  v_add_u32 v15, v15, v16
  v_lshlrev_b32 v15, 10, v15
  v_add_u32 v19, s12, v15
  s_lshl_b32 s12, s8, 2
  s_add_u32 s12, s12, 159744
  v_mov_b32 v251, s12
  v_and_b32 v253, 7, v1
  v_lshlrev_b32 v253, 2, v253
  v_add_u32 v253, 159744, v253
  s_waitcnt vmcnt(20)
  v_mov_b32 v16, 56
  ds_write_b32 v17, v16 offset:4
  s_add_u32 m0, s95, 98304
  s_mov_b32 s93, 286720
  buffer_load_dwordx4 v11, s[56:59], s93 offen lds
  ds_read_b32 v15, v47
  s_lshl_b32 s12, s84, 2
  s_lshr_b32 s12, 48032, s12
  s_and_b32 s12, s12, 15
  s_mul_i32 s93, s12, 28672
  s_lshl_b32 s12, s12, 12
  s_add_u32 m0, s12, 57344
  s_nop 0
  buffer_load_dwordx4 v10, s[56:59], s93 offen lds
  s_add_u32 m0, s95, 102400
  s_mov_b32 s93, 315392
  buffer_load_dwordx4 v11, s[56:59], s93 offen lds
  s_waitcnt lgkmcnt(0)
  ds_read_b32 v15, v47
  s_waitcnt lgkmcnt(0)
  v_cmp_gt_u32 vcc, 6, v15
  s_nop 0
  s_cbranch_vccnz Llrf6_18
Lldf6_17:
  s_add_u32 m0, s95, 114688
  s_mov_b32 s13, 0
  buffer_load_dwordx4 v6, s[64:67], s13 offen lds
  s_add_u32 m0, s95, 118784
  s_mov_b32 s13, 57344
  buffer_load_dwordx4 v6, s[64:67], s13 offen lds
  s_add_u32 s12, s84, -1
  s_mul_i32 s93, s12, 57344
  s_lshl_b32 s12, s12, 12
  s_add_u32 m0, s12, 114688
  s_nop 0
  buffer_load_dwordx4 v7, s[64:67], s93 offen lds
  s_add_u32 m0, s95, 122880
  s_mov_b32 s13, 114688
  buffer_load_dwordx4 v6, s[64:67], s13 offen lds
  s_add_u32 m0, s95, 126976
  s_mov_b32 s13, 172032
  buffer_load_dwordx4 v6, s[64:67], s13 offen lds
  s_add_u32 m0, s95, 131072
  s_mov_b32 s13, 229376
  buffer_load_dwordx4 v6, s[64:67], s13 offen lds
  s_add_u32 s12, s84, 2
  s_mul_i32 s93, s12, 57344
  s_lshl_b32 s12, s12, 12
  s_add_u32 m0, s12, 114688
  s_nop 0
  buffer_load_dwordx4 v7, s[64:67], s93 offen lds
  s_add_u32 m0, s95, 135168
  s_mov_b32 s13, 286720
  buffer_load_dwordx4 v6, s[64:67], s13 offen lds
  s_add_u32 m0, s95, 139264
  s_mov_b32 s13, 344064
  buffer_load_dwordx4 v6, s[64:67], s13 offen lds
  s_add_u32 m0, s95, 143360
  s_mov_b32 s13, 401408
  buffer_load_dwordx4 v6, s[64:67], s13 offen lds
  s_add_u32 s12, s84, 5
  s_mul_i32 s93, s12, 57344
  s_lshl_b32 s12, s12, 12
  s_add_u32 m0, s12, 114688
  s_nop 0
  buffer_load_dwordx4 v7, s[64:67], s93 offen lds
  s_add_u32 m0, s95, 147456
  s_mov_b32 s13, 458752
  buffer_load_dwordx4 v6, s[64:67], s13 offen lds
  v_mov_b32 v76, -1
  v_mov_b32 v77, -1
  v_mov_b32 v78, -1
  v_mov_b32 v79, -1
  s_lshl_b32 s13, s7, 11
  s_add_u32 s13, s13, s80
  s_cmp_eq_u32 s7, 7
  s_cselect_b32 s13, 2147418112, s13
  s_mul_i32 s12, s8, 14336
  s_add_u32 s12, s12, s13
  s_and_b32 s14, s8, 1
  s_lshl_b32 s14, s14, 10
  s_add_u32 s13, s13, s14
  v_add_u32 v15, s12, v4
  v_add_u32 v16, s13, v4
  s_mov_b32 s12, 215040
  s_mov_b32 s13, 71680
  s_mov_b32 s14, 0
  s_cmp_lg_u32 s10, 0
  s_cbranch_scc1 Lslow_19
  buffer_store_dwordx4 v[76:79], v15, s[76:79], s12 offen
  buffer_store_dwordx4 v[76:79], v15, s[76:79], s12 offen offset:1024
  buffer_store_dwordx4 v[76:79], v16, s[76:79], s12 offen
  buffer_store_dwordx4 v[76:79], v15, s[76:79], s13 offen
  buffer_store_dwordx4 v[76:79], v15, s[76:79], s13 offen offset:1024
  buffer_store_dwordx4 v[76:79], v16, s[76:79], s13 offen
  buffer_store_dwordx4 v[76:79], v15, s[76:79], s14 offen
  buffer_store_dwordx4 v[76:79], v15, s[76:79], s14 offen offset:1024
  buffer_store_dwordx4 v[76:79], v16, s[76:79], s14 offen
Lback_20:
  s_waitcnt vmcnt(27)
  v_lshlrev_b32 v60, 16, v52
  v_and_b32 v61, 0xffff0000, v52
  v_lshlrev_b32 v62, 16, v53
  v_and_b32 v63, 0xffff0000, v53
  s_waitcnt vmcnt(26)
  v_lshlrev_b32 v64, 16, v54
  v_and_b32 v65, 0xffff0000, v54
  v_lshlrev_b32 v66, 16, v55
  v_and_b32 v67, 0xffff0000, v55
  s_waitcnt vmcnt(25)
  v_lshlrev_b32 v68, 16, v56
  v_and_b32 v69, 0xffff0000, v56
  v_lshlrev_b32 v70, 16, v57
  v_and_b32 v71, 0xffff0000, v57
  s_waitcnt vmcnt(24)
  v_lshlrev_b32 v72, 16, v58
  v_and_b32 v73, 0xffff0000, v58
  v_lshlrev_b32 v74, 16, v59
  v_and_b32 v75, 0xffff0000, v59
Lkj_8:
  s_nop 1
  s_cmp_eq_u32 s7, 7
  s_cbranch_scc1 Lj7b
  s_add_u32 s92, s87, 272384
  s_add_u32 s93, s87, 276480
  s_add_u32 s94, s86, 272384
  s_add_u32 s95, s86, 276480
  s_mov_b32 s96, 215040
  ds_read_b32 v15, v47
  v_cndmask_b32 v16, 0, 56, s[0:1]
  s_waitcnt lgkmcnt(0)
  v_cmp_gt_u32 vcc, v16, v15
  s_nop 0
  s_cbranch_vccnz Llrf0_22
Lldf0_21:
  s_and_b32 s12, s8, 1
  s_mul_i32 s12, s12, 28672
  s_add_u32 s12, s12, 0
  v_add_u32 v5, s12, v39
  v_xor_b32 v6, 32, v5
  v_xor_b32 v7, 64, v5
  v_xor_b32 v8, 96, v5
  ds_read_b64_tr_b16 v[132:133], v5 offset:0
  ds_read_b64_tr_b16 v[134:135], v5 offset:512
  ds_read_b64_tr_b16 v[136:137], v6 offset:0
  ds_read_b64_tr_b16 v[138:139], v6 offset:512
  ds_read_b64_tr_b16 v[140:141], v7 offset:0
  ds_read_b64_tr_b16 v[142:143], v7 offset:512
  ds_read_b64_tr_b16 v[144:145], v8 offset:0
  ds_read_b64_tr_b16 v[146:147], v8 offset:512
  ds_read_b64_tr_b16 v[148:149], v5 offset:4096
  ds_read_b64_tr_b16 v[150:151], v5 offset:4608
  ds_read_b64_tr_b16 v[152:153], v6 offset:4096
  ds_read_b64_tr_b16 v[154:155], v6 offset:4608
  ds_read_b64_tr_b16 v[156:157], v7 offset:4096
  ds_read_b64_tr_b16 v[158:159], v7 offset:4608
  ds_read_b64_tr_b16 v[160:161], v8 offset:4096
  ds_read_b64_tr_b16 v[162:163], v8 offset:4608
  ds_read_b64_tr_b16 v[164:165], v5 offset:8192
  ds_read_b64_tr_b16 v[166:167], v5 offset:8704
  ds_read_b64_tr_b16 v[168:169], v6 offset:8192
  ds_read_b64_tr_b16 v[170:171], v6 offset:8704
  ds_read_b64_tr_b16 v[172:173], v7 offset:8192
  ds_read_b64_tr_b16 v[174:175], v7 offset:8704
  ds_read_b64_tr_b16 v[176:177], v8 offset:8192
  ds_read_b64_tr_b16 v[178:179], v8 offset:8704
  ds_read_b64_tr_b16 v[180:181], v5 offset:12288
  ds_read_b64_tr_b16 v[182:183], v5 offset:12800
  ds_read_b64_tr_b16 v[184:185], v6 offset:12288
  ds_read_b64_tr_b16 v[186:187], v6 offset:12800
  ds_read_b64_tr_b16 v[188:189], v7 offset:12288
  ds_read_b64_tr_b16 v[190:191], v7 offset:12800
  ds_read_b64_tr_b16 v[192:193], v8 offset:12288
  ds_read_b64_tr_b16 v[194:195], v8 offset:12800
  ds_read_b64_tr_b16 v[196:197], v5 offset:16384
  ds_read_b64_tr_b16 v[198:199], v5 offset:16896
  ds_read_b64_tr_b16 v[200:201], v6 offset:16384
  ds_read_b64_tr_b16 v[202:203], v6 offset:16896
  ds_read_b64_tr_b16 v[204:205], v7 offset:16384
  ds_read_b64_tr_b16 v[206:207], v7 offset:16896
  ds_read_b64_tr_b16 v[208:209], v8 offset:16384
  ds_read_b64_tr_b16 v[210:211], v8 offset:16896
  ds_read_b64_tr_b16 v[212:213], v5 offset:20480
  ds_read_b64_tr_b16 v[214:215], v5 offset:20992
  ds_read_b64_tr_b16 v[216:217], v6 offset:20480
  ds_read_b64_tr_b16 v[218:219], v6 offset:20992
  ds_read_b64_tr_b16 v[220:221], v7 offset:20480
  ds_read_b64_tr_b16 v[222:223], v7 offset:20992
  ds_read_b64_tr_b16 v[224:225], v8 offset:20480
  ds_read_b64_tr_b16 v[226:227], v8 offset:20992
  ds_read_b64_tr_b16 v[228:229], v5 offset:24576
  ds_read_b64_tr_b16 v[230:231], v5 offset:25088
  ds_read_b64_tr_b16 v[232:233], v6 offset:24576
  ds_read_b64_tr_b16 v[234:235], v6 offset:25088
  ds_read_b64_tr_b16 v[236:237], v7 offset:24576
  ds_read_b64_tr_b16 v[238:239], v7 offset:25088
  ds_read_b64_tr_b16 v[240:241], v8 offset:24576
  ds_read_b64_tr_b16 v[242:243], v8 offset:25088
  s_lshl_b32 s12, s8, 12
  s_add_u32 s12, s12, 40960
  v_add_u32 v5, s12, v4
  v_xor_b32 v6, 4096, v5
  v_xor_b32 v7, 4, v251
  s_mul_i32 s12, s84, 224
  s_add_u32 s12, s12, 154816
  v_mov_b32 v17, s12
  s_waitcnt vmcnt(0)
  v_mov_b32 v16, 60
  ds_write_b32 v17, v16 offset:4
  v_mov_b32 v23, 1
  ds_write_b32 v251, v23
Lpollo_23:
  buffer_load_dword v16, v254, s[76:79], 0 offen sc1
  s_waitcnt vmcnt(0)
  v_cmp_ne_u32 vcc, s9, v16
  s_nop 0
  s_cbranch_vccz Lpdo_24
  s_sub_u32 s11, s11, 1
  s_cbranch_scc0 Lpollo_23
  s_mov_b32 s11, 0
Lpdo_24:
  s_setprio 1
  buffer_load_dwordx4 v[76:79], v28, s[76:79], s92 offen offset:0 sc1
  buffer_load_dwordx4 v[80:83], v28, s[76:79], s92 offen offset:1024 sc1
  buffer_load_dwordx4 v[84:87], v28, s[76:79], s92 offen offset:2048 sc1
  buffer_load_dwordx4 v[88:91], v28, s[76:79], s92 offen offset:3072 sc1
  buffer_load_dwordx4 v[92:95], v28, s[76:79], s93 offen offset:0 sc1
  buffer_load_dwordx4 v[96:99], v28, s[76:79], s93 offen offset:1024 sc1
  buffer_load_dwordx4 v[100:103], v28, s[76:79], s93 offen offset:2048 sc1
  s_waitcnt vmcnt(6) lgkmcnt(15)
  v_mfma_f32_16x16x32_bf16 v[116:119], v[132:135], v[76:79], 0
  s_waitcnt lgkmcnt(15)
  v_mfma_f32_16x16x32_bf16 v[120:123], v[136:139], v[76:79], 0
  buffer_load_dwordx4 v[104:107], v28, s[76:79], s94 offen offset:0 sc1
  s_waitcnt lgkmcnt(15)
  v_mfma_f32_16x16x32_bf16 v[124:127], v[140:143], v[76:79], 0
  buffer_load_dwordx4 v[108:111], v28, s[76:79], s94 offen offset:1024 sc1
  v_mov_b32 v23, 2
  ds_write_b32 v251, v23
  s_waitcnt lgkmcnt(15)
  v_mfma_f32_16x16x32_bf16 v[128:131], v[144:147], v[76:79], 0
  buffer_load_dwordx4 v[112:115], v28, s[76:79], s94 offen offset:2048 sc1
  s_waitcnt vmcnt(8) lgkmcnt(15)
  v_mfma_f32_16x16x32_bf16 v[116:119], v[148:151], v[80:83], v[116:119]
  s_waitcnt lgkmcnt(15)
  v_mfma_f32_16x16x32_bf16 v[120:123], v[152:155], v[80:83], v[120:123]
  s_waitcnt lgkmcnt(15)
  v_mfma_f32_16x16x32_bf16 v[124:127], v[156:159], v[80:83], v[124:127]
  s_waitcnt lgkmcnt(15)
  v_mfma_f32_16x16x32_bf16 v[128:131], v[160:163], v[80:83], v[128:131]
  buffer_load_dwordx4 v[76:79], v28, s[76:79], s94 offen offset:3072 sc1
  s_waitcnt vmcnt(8) lgkmcnt(15)
  v_mfma_f32_16x16x32_bf16 v[116:119], v[164:167], v[84:87], v[116:119]
  s_waitcnt lgkmcnt(15)
  v_mfma_f32_16x16x32_bf16 v[120:123], v[168:171], v[84:87], v[120:123]
  s_waitcnt lgkmcnt(15)
  v_mfma_f32_16x16x32_bf16 v[124:127], v[172:175], v[84:87], v[124:127]
  s_waitcnt lgkmcnt(15)
  v_mfma_f32_16x16x32_bf16 v[128:131], v[176:179], v[84:87], v[128:131]
  buffer_load_dwordx4 v[80:83], v28, s[76:79], s95 offen offset:0 sc1
  s_waitcnt vmcnt(8) lgkmcnt(15)
  v_mfma_f32_16x16x32_bf16 v[116:119], v[180:183], v[88:91], v[116:119]
  s_waitcnt lgkmcnt(15)
  v_mfma_f32_16x16x32_bf16 v[120:123], v[184:187], v[88:91], v[120:123]
  s_waitcnt lgkmcnt(15)
  v_mfma_f32_16x16x32_bf16 v[124:127], v[188:191], v[88:91], v[124:127]
  s_waitcnt lgkmcnt(15)
  v_mfma_f32_16x16x32_bf16 v[128:131], v[192:195], v[88:91], v[128:131]
  buffer_load_dwordx4 v[84:87], v28, s[76:79], s95 offen offset:1024 sc1
  s_waitcnt vmcnt(8) lgkmcnt(15)
  v_mfma_f32_16x16x32_bf16 v[116:119], v[196:199], v[92:95], v[116:119]
  s_waitcnt lgkmcnt(15)
  v_mfma_f32_16x16x32_bf16 v[120:123], v[200:203], v[92:95], v[120:123]
  s_waitcnt lgkmcnt(15)
  v_mfma_f32_16x16x32_bf16 v[124:127], v[204:207], v[92:95], v[124:127]
  s_waitcnt lgkmcnt(15)
  v_mfma_f32_16x16x32_bf16 v[128:131], v[208:211], v[92:95], v[128:131]
  buffer_load_dwordx4 v[88:91], v28, s[76:79], s95 offen offset:2048 sc1
  ds_read_b32 v24, v253
  s_waitcnt vmcnt(8) lgkmcnt(15)
  v_mfma_f32_16x16x32_bf16 v[116:119], v[212:215], v[96:99], v[116:119]
  s_waitcnt lgkmcnt(15)
  v_mfma_f32_16x16x32_bf16 v[120:123], v[216:219], v[96:99], v[120:123]
  s_waitcnt lgkmcnt(14)
  v_mfma_f32_16x16x32_bf16 v[124:127], v[220:223], v[96:99], v[124:127]
  s_waitcnt lgkmcnt(12)
  v_mfma_f32_16x16x32_bf16 v[128:131], v[224:227], v[96:99], v[128:131]
  s_waitcnt vmcnt(7) lgkmcnt(10)
  v_mfma_f32_16x16x32_bf16 v[116:119], v[228:231], v[100:103], v[116:119]
  s_waitcnt lgkmcnt(8)
  v_mfma_f32_16x16x32_bf16 v[120:123], v[232:235], v[100:103], v[120:123]
  s_waitcnt lgkmcnt(6)
  v_mfma_f32_16x16x32_bf16 v[124:127], v[236:239], v[100:103], v[124:127]
  s_waitcnt lgkmcnt(4)
  v_mfma_f32_16x16x32_bf16 v[128:131], v[240:243], v[100:103], v[128:131]
  v_cndmask_b32 v25, 1, 0, s[0:1]
  s_waitcnt lgkmcnt(0)
  v_cmp_gt_u32 vcc, v25, v24
  s_nop 0
  s_cbranch_vccnz Llrg_26
Lldg_25:
  s_waitcnt vmcnt(6)
  v_mfma_f32_16x16x32_bf16 v[60:63], v[132:135], v[104:107], v[60:63]
  v_mfma_f32_16x16x32_bf16 v[64:67], v[136:139], v[104:107], v[64:67]
  v_mfma_f32_16x16x32_bf16 v[68:71], v[140:143], v[104:107], v[68:71]
  v_mfma_f32_16x16x32_bf16 v[72:75], v[144:147], v[104:107], v[72:75]
  ds_write_b128 v5, v[116:119] offset:0
  ds_write_b128 v5, v[120:123] offset:1024
  ds_write_b128 v5, v[124:127] offset:2048
  ds_write_b128 v5, v[128:131] offset:3072
  v_mov_b32 v23, 1
  ds_write_b32 v251, v23 offset:32
  s_waitcnt vmcnt(5)
  v_mfma_f32_16x16x32_bf16 v[60:63], v[148:151], v[108:111], v[60:63]
  v_mfma_f32_16x16x32_bf16 v[64:67], v[152:155], v[108:111], v[64:67]
  v_mfma_f32_16x16x32_bf16 v[68:71], v[156:159], v[108:111], v[68:71]
  v_mfma_f32_16x16x32_bf16 v[72:75], v[160:163], v[108:111], v[72:75]
  s_waitcnt vmcnt(4)
  v_mfma_f32_16x16x32_bf16 v[60:63], v[164:167], v[112:115], v[60:63]
  v_mfma_f32_16x16x32_bf16 v[64:67], v[168:171], v[112:115], v[64:67]
  v_mfma_f32_16x16x32_bf16 v[68:71], v[172:175], v[112:115], v[68:71]
  v_mfma_f32_16x16x32_bf16 v[72:75], v[176:179], v[112:115], v[72:75]
  s_waitcnt vmcnt(3)
  v_mfma_f32_16x16x32_bf16 v[60:63], v[180:183], v[76:79], v[60:63]
  v_mfma_f32_16x16x32_bf16 v[64:67], v[184:187], v[76:79], v[64:67]
  v_mfma_f32_16x16x32_bf16 v[68:71], v[188:191], v[76:79], v[68:71]
  v_mfma_f32_16x16x32_bf16 v[72:75], v[192:195], v[76:79], v[72:75]
  ds_read_b32 v24, v7 offset:32
  ds_read_b128 v[116:119], v6 offset:0
  ds_read_b128 v[120:123], v6 offset:1024
  ds_read_b128 v[124:127], v6 offset:2048
  ds_read_b128 v[128:131], v6 offset:3072
  s_waitcnt vmcnt(2)
  v_mfma_f32_16x16x32_bf16 v[60:63], v[196:199], v[80:83], v[60:63]
  v_mfma_f32_16x16x32_bf16 v[64:67], v[200:203], v[80:83], v[64:67]
  v_mfma_f32_16x16x32_bf16 v[68:71], v[204:207], v[80:83], v[68:71]
  v_mfma_f32_16x16x32_bf16 v[72:75], v[208:211], v[80:83], v[72:75]
  s_waitcnt vmcnt(1)
  v_mfma_f32_16x16x32_bf16 v[60:63], v[212:215], v[84:87], v[60:63]
  v_mfma_f32_16x16x32_bf16 v[64:67], v[216:219], v[84:87], v[64:67]
  v_mfma_f32_16x16x32_bf16 v[68:71], v[220:223], v[84:87], v[68:71]
  v_mfma_f32_16x16x32_bf16 v[72:75], v[224:227], v[84:87], v[72:75]
  s_waitcnt lgkmcnt(4)
  v_cmp_gt_u32 vcc, 1, v24
  s_nop 0
  s_cbranch_vccnz Llrx_28
Lldx_27:
  s_waitcnt vmcnt(0)
  v_mfma_f32_16x16x32_bf16 v[60:63], v[228:231], v[88:91], v[60:63]
  v_mfma_f32_16x16x32_bf16 v[64:67], v[232:235], v[88:91], v[64:67]
  v_mfma_f32_16x16x32_bf16 v[68:71], v[236:239], v[88:91], v[68:71]
  v_mfma_f32_16x16x32_bf16 v[72:75], v[240:243], v[88:91], v[72:75]
  s_waitcnt lgkmcnt(3)
  s_nop 3
  v_pk_add_f32 v[60:61], v[60:61], v[116:117]
  v_pk_add_f32 v[62:63], v[62:63], v[118:119]
  s_waitcnt lgkmcnt(2)
  v_pk_add_f32 v[64:65], v[64:65], v[120:121]
  v_pk_add_f32 v[66:67], v[66:67], v[122:123]
  s_waitcnt lgkmcnt(1)
  v_pk_add_f32 v[68:69], v[68:69], v[124:125]
  v_pk_add_f32 v[70:71], v[70:71], v[126:127]
  s_waitcnt lgkmcnt(0)
  v_pk_add_f32 v[72:73], v[72:73], v[128:129]
  v_pk_add_f32 v[74:75], v[74:75], v[130:131]
  v_cvt_pk_bf16_f32 v76, v60, v61
  v_cvt_pk_bf16_f32 v77, v62, v63
  v_cvt_pk_bf16_f32 v78, v64, v65
  v_cvt_pk_bf16_f32 v79, v66, v67
  s_nop 0
  v_permlane16_swap_b32 v76, v78
  v_permlane16_swap_b32 v77, v79
  v_cvt_pk_bf16_f32 v80, v68, v69
  v_cvt_pk_bf16_f32 v81, v70, v71
  v_cvt_pk_bf16_f32 v82, v72, v73
  v_cvt_pk_bf16_f32 v83, v74, v75
  s_nop 0
  v_permlane16_swap_b32 v80, v82
  v_permlane16_swap_b32 v81, v83
  s_cmp_lg_u32 s10, 0
  s_cbranch_scc1 Lslow_29
  buffer_store_dwordx4 v[76:79], v29, s[76:79], s96 offen
  buffer_store_dwordx4 v[80:83], v29, s[76:79], s96 offen offset:1024
  buffer_store_dword v27, v18, s[76:79], 0 offen offset:128
Lback_30:
  ds_read_b32 v24, v253
  v_pk_add_f32 v[84:85], v[60:61], v[62:63]
  v_pk_mul_f32 v[86:87], v[60:61], v[60:61]
  v_pk_fma_f32 v[86:87], v[62:63], v[62:63], v[86:87]
  v_pk_add_f32 v[84:85], v[84:85], v[64:65]
  v_pk_fma_f32 v[86:87], v[64:65], v[64:65], v[86:87]
  v_pk_add_f32 v[84:85], v[84:85], v[66:67]
  v_pk_fma_f32 v[86:87], v[66:67], v[66:67], v[86:87]
  v_pk_add_f32 v[84:85], v[84:85], v[68:69]
  v_pk_fma_f32 v[86:87], v[68:69], v[68:69], v[86:87]
  v_pk_add_f32 v[84:85], v[84:85], v[70:71]
  v_pk_fma_f32 v[86:87], v[70:71], v[70:71], v[86:87]
  v_pk_add_f32 v[84:85], v[84:85], v[72:73]
  v_pk_fma_f32 v[86:87], v[72:73], v[72:73], v[86:87]
  v_pk_add_f32 v[84:85], v[84:85], v[74:75]
  v_pk_fma_f32 v[86:87], v[74:75], v[74:75], v[86:87]
  v_add_f32 v88, v84, v85
  v_add_f32 v89, v86, v87
  s_nop 1
  v_permlane32_swap_b32 v88, v89
  v_add_f32 v88, v88, v89
  v_mov_b32 v84, v88
  s_nop 1
  v_permlane16_swap_b32 v88, v84
  v_add_f32 v88, v88, v84
  v_mov_b32 v89, v88
  s_nop 1
  v_permlane32_swap_b32 v88, v89
  v_or_b32 v90, 1, v27
  s_cmp_lg_u32 s10, 0
  s_cbranch_scc1 Lslow_31
  buffer_store_dwordx3 v[88:90], v9, s[76:79], 0 offen
Lback_32:
  v_cndmask_b32 v25, 0, 1, s[0:1]
  s_waitcnt lgkmcnt(0)
  v_cmp_gt_u32 vcc, v25, v24
  s_nop 0
  s_cbranch_vccnz Llrg_34
Lldg_33:
  s_and_b32 s12, s8, 1
  s_mul_i32 s12, s12, 28672
  s_add_u32 s12, s12, 57344
  v_add_u32 v5, s12, v39
  v_xor_b32 v6, 32, v5
  v_xor_b32 v7, 64, v5
  v_xor_b32 v8, 96, v5
  ds_read_b64_tr_b16 v[132:133], v5 offset:0
  ds_read_b64_tr_b16 v[134:135], v5 offset:512
  ds_read_b64_tr_b16 v[136:137], v6 offset:0
  ds_read_b64_tr_b16 v[138:139], v6 offset:512
  ds_read_b64_tr_b16 v[140:141], v7 offset:0
  ds_read_b64_tr_b16 v[142:143], v7 offset:512
  ds_read_b64_tr_b16 v[144:145], v8 offset:0
  ds_read_b64_tr_b16 v[146:147], v8 offset:512
  ds_read_b64_tr_b16 v[148:149], v5 offset:4096
  ds_read_b64_tr_b16 v[150:151], v5 offset:4608
  ds_read_b64_tr_b16 v[152:153], v6 offset:4096
  ds_read_b64_tr_b16 v[154:155], v6 offset:4608
  ds_read_b64_tr_b16 v[156:157], v7 offset:4096
  ds_read_b64_tr_b16 v[158:159], v7 offset:4608
  ds_read_b64_tr_b16 v[160:161], v8 offset:4096
  ds_read_b64_tr_b16 v[162:163], v8 offset:4608
  ds_read_b64_tr_b16 v[164:165], v5 offset:8192
  ds_read_b64_tr_b16 v[166:167], v5 offset:8704
  ds_read_b64_tr_b16 v[168:169], v6 offset:8192
  ds_read_b64_tr_b16 v[170:171], v6 offset:8704
  ds_read_b64_tr_b16 v[172:173], v7 offset:8192
  ds_read_b64_tr_b16 v[174:175], v7 offset:8704
  ds_read_b64_tr_b16 v[176:177], v8 offset:8192
  ds_read_b64_tr_b16 v[178:179], v8 offset:8704
  ds_read_b64_tr_b16 v[180:181], v5 offset:12288
  ds_read_b64_tr_b16 v[182:183], v5 offset:12800
  ds_read_b64_tr_b16 v[184:185], v6 offset:12288
  ds_read_b64_tr_b16 v[186:187], v6 offset:12800
  ds_read_b64_tr_b16 v[188:189], v7 offset:12288
  ds_read_b64_tr_b16 v[190:191], v7 offset:12800
  ds_read_b64_tr_b16 v[192:193], v8 offset:12288
  ds_read_b64_tr_b16 v[194:195], v8 offset:12800
  ds_read_b64_tr_b16 v[196:197], v5 offset:16384
  ds_read_b64_tr_b16 v[198:199], v5 offset:16896
  ds_read_b64_tr_b16 v[200:201], v6 offset:16384
  ds_read_b64_tr_b16 v[202:203], v6 offset:16896
  ds_read_b64_tr_b16 v[204:205], v7 offset:16384
  ds_read_b64_tr_b16 v[206:207], v7 offset:16896
  ds_read_b64_tr_b16 v[208:209], v8 offset:16384
  ds_read_b64_tr_b16 v[210:211], v8 offset:16896
  ds_read_b64_tr_b16 v[212:213], v5 offset:20480
  ds_read_b64_tr_b16 v[214:215], v5 offset:20992
  ds_read_b64_tr_b16 v[216:217], v6 offset:20480
  ds_read_b64_tr_b16 v[218:219], v6 offset:20992
  ds_read_b64_tr_b16 v[220:221], v7 offset:20480
  ds_read_b64_tr_b16 v[222:223], v7 offset:20992
  ds_read_b64_tr_b16 v[224:225], v8 offset:20480
  ds_read_b64_tr_b16 v[226:227], v8 offset:20992
  ds_read_b64_tr_b16 v[228:229], v5 offset:24576
  ds_read_b64_tr_b16 v[230:231], v5 offset:25088
  ds_read_b64_tr_b16 v[232:233], v6 offset:24576
  ds_read_b64_tr_b16 v[234:235], v6 offset:25088
  ds_read_b64_tr_b16 v[236:237], v7 offset:24576
  ds_read_b64_tr_b16 v[238:239], v7 offset:25088
  ds_read_b64_tr_b16 v[240:241], v8 offset:24576
  ds_read_b64_tr_b16 v[242:243], v8 offset:25088
  v_mov_b32 v23, 3
  ds_write_b32 v251, v23
  s_lshl_b32 s12, s8, 12
  s_add_u32 s12, s12, 98304
  v_add_u32 v5, s12, v4
  v_xor_b32 v6, 4096, v5
  v_xor_b32 v7, 4, v251
  s_add_u32 s92, s87, 215040
  s_add_u32 s93, s87, 219136
  s_add_u32 s94, s86, 215040
  s_add_u32 s95, s86, 219136
  v_lshlrev_b32 v8, 4, v3
  v_add_u32 v8, 163328, v8
  s_mov_b32 s96, 71680
  s_or_b32 s85, s9, 1
Lpollh_35:
  buffer_load_dword v16, v255, s[76:79], 0 offen offset:128 sc1
  s_waitcnt vmcnt(0)
  v_cmp_ne_u32 vcc, s9, v16
  s_nop 0
  s_cbranch_vccz Lpdh_36
  s_sub_u32 s11, s11, 1
  s_cbranch_scc0 Lpollh_35
  s_mov_b32 s11, 0
Lpdh_36:
  buffer_load_dwordx4 v[76:79], v28, s[76:79], s92 offen offset:0 sc1
  buffer_load_dwordx4 v[80:83], v28, s[76:79], s92 offen offset:1024 sc1
  buffer_load_dwordx4 v[84:87], v28, s[76:79], s92 offen offset:2048 sc1
  buffer_load_dwordx4 v[88:91], v28, s[76:79], s92 offen offset:3072 sc1
  buffer_load_dwordx4 v[92:95], v28, s[76:79], s93 offen offset:0 sc1
  buffer_load_dwordx4 v[96:99], v28, s[76:79], s93 offen offset:1024 sc1
  buffer_load_dwordx4 v[100:103], v28, s[76:79], s93 offen offset:2048 sc1
  s_waitcnt vmcnt(6) lgkmcnt(15)
  v_mfma_f32_16x16x32_bf16 v[116:119], v[132:135], v[76:79], 0
  s_waitcnt lgkmcnt(15)
  v_mfma_f32_16x16x32_bf16 v[120:123], v[136:139], v[76:79], 0
  buffer_load_dwordx4 v[104:107], v28, s[76:79], s94 offen offset:0 sc1
  s_waitcnt lgkmcnt(15)
  v_mfma_f32_16x16x32_bf16 v[124:127], v[140:143], v[76:79], 0
  buffer_load_dwordx4 v[108:111], v28, s[76:79], s94 offen offset:1024 sc1
  s_waitcnt lgkmcnt(15)
  v_mfma_f32_16x16x32_bf16 v[128:131], v[144:147], v[76:79], 0
  buffer_load_dwordx4 v[112:115], v28, s[76:79], s94 offen offset:2048 sc1
  v_mov_b32 v23, 4
  ds_write_b32 v251, v23
  s_waitcnt vmcnt(8) lgkmcnt(15)
  v_mfma_f32_16x16x32_bf16 v[116:119], v[148:151], v[80:83], v[116:119]
  s_waitcnt lgkmcnt(15)
  v_mfma_f32_16x16x32_bf16 v[120:123], v[152:155], v[80:83], v[120:123]
  s_waitcnt lgkmcnt(15)
  v_mfma_f32_16x16x32_bf16 v[124:127], v[156:159], v[80:83], v[124:127]
  s_waitcnt lgkmcnt(15)
  v_mfma_f32_16x16x32_bf16 v[128:131], v[160:163], v[80:83], v[128:131]
  buffer_load_dwordx4 v[76:79], v28, s[76:79], s94 offen offset:3072 sc1
  buffer_load_dwordx3 v[32:34], v30, s[76:79], 0 offen sc1
  buffer_load_dwordx3 v[36:38], v31, s[76:79], 0 offen sc1
  s_waitcnt vmcnt(10) lgkmcnt(15)
  v_mfma_f32_16x16x32_bf16 v[116:119], v[164:167], v[84:87], v[116:119]
  s_waitcnt lgkmcnt(15)
  v_mfma_f32_16x16x32_bf16 v[120:123], v[168:171], v[84:87], v[120:123]
  s_waitcnt lgkmcnt(15)
  v_mfma_f32_16x16x32_bf16 v[124:127], v[172:175], v[84:87], v[124:127]
  s_waitcnt lgkmcnt(15)
  v_mfma_f32_16x16x32_bf16 v[128:131], v[176:179], v[84:87], v[128:131]
  buffer_load_dwordx4 v[80:83], v28, s[76:79], s95 offen offset:0 sc1
  s_waitcnt vmcnt(10) lgkmcnt(15)
  v_mfma_f32_16x16x32_bf16 v[116:119], v[180:183], v[88:91], v[116:119]
  s_waitcnt lgkmcnt(15)
  v_mfma_f32_16x16x32_bf16 v[120:123], v[184:187], v[88:91], v[120:123]
  s_waitcnt lgkmcnt(15)
  v_mfma_f32_16x16x32_bf16 v[124:127], v[188:191], v[88:91], v[124:127]
  s_waitcnt lgkmcnt(15)
  v_mfma_f32_16x16x32_bf16 v[128:131], v[192:195], v[88:91], v[128:131]
  buffer_load_dwordx4 v[84:87], v28, s[76:79], s95 offen offset:1024 sc1
  s_waitcnt vmcnt(10) lgkmcnt(15)
  v_mfma_f32_16x16x32_bf16 v[116:119], v[196:199], v[92:95], v[116:119]
  s_waitcnt lgkmcnt(15)
  v_mfma_f32_16x16x32_bf16 v[120:123], v[200:203], v[92:95], v[120:123]
  s_waitcnt lgkmcnt(15)
  v_mfma_f32_16x16x32_bf16 v[124:127], v[204:207], v[92:95], v[124:127]
  s_waitcnt lgkmcnt(15)
  v_mfma_f32_16x16x32_bf16 v[128:131], v[208:211], v[92:95], v[128:131]
  buffer_load_dwordx4 v[88:91], v28, s[76:79], s95 offen offset:2048 sc1
  ds_read_b32 v24, v253
  s_waitcnt vmcnt(10) lgkmcnt(15)
  v_mfma_f32_16x16x32_bf16 v[116:119], v[212:215], v[96:99], v[116:119]
  s_waitcnt lgkmcnt(15)
  v_mfma_f32_16x16x32_bf16 v[120:123], v[216:219], v[96:99], v[120:123]
  s_waitcnt lgkmcnt(13)
  v_mfma_f32_16x16x32_bf16 v[124:127], v[220:223], v[96:99], v[124:127]
  s_waitcnt lgkmcnt(11)
  v_mfma_f32_16x16x32_bf16 v[128:131], v[224:227], v[96:99], v[128:131]
  s_waitcnt vmcnt(9) lgkmcnt(9)
  v_mfma_f32_16x16x32_bf16 v[116:119], v[228:231], v[100:103], v[116:119]
  s_waitcnt lgkmcnt(7)
  v_mfma_f32_16x16x32_bf16 v[120:123], v[232:235], v[100:103], v[120:123]
  s_waitcnt lgkmcnt(5)
  v_mfma_f32_16x16x32_bf16 v[124:127], v[236:239], v[100:103], v[124:127]
  s_waitcnt lgkmcnt(3)
  v_mfma_f32_16x16x32_bf16 v[128:131], v[240:243], v[100:103], v[128:131]
  v_cndmask_b32 v25, 3, 1, s[0:1]
  s_waitcnt lgkmcnt(0)
  v_cmp_gt_u32 vcc, v25, v24
  s_nop 0
  s_cbranch_vccnz Llrg_38
Lldg_37:
  s_waitcnt vmcnt(8)
  v_mfma_f32_16x16x32_bf16 v[44:47], v[132:135], v[104:107], 0
  v_mfma_f32_16x16x32_bf16 v[48:51], v[136:139], v[104:107], 0
  v_mfma_f32_16x16x32_bf16 v[52:55], v[140:143], v[104:107], 0
  v_mfma_f32_16x16x32_bf16 v[56:59], v[144:147], v[104:107], 0
  v_cmp_u_f32 vcc, v116, v116
  s_nop 0
  s_cbranch_vccnz Lnr_40
Lnd_39:
  ds_write_b128 v5, v[116:119] offset:0
  ds_write_b128 v5, v[120:123] offset:1024
  ds_write_b128 v5, v[124:127] offset:2048
  ds_write_b128 v5, v[128:131] offset:3072
  v_mov_b32 v23, 2
  ds_write_b32 v251, v23 offset:32
  s_waitcnt vmcnt(7)
  v_mfma_f32_16x16x32_bf16 v[44:47], v[148:151], v[108:111], v[44:47]
  v_mfma_f32_16x16x32_bf16 v[48:51], v[152:155], v[108:111], v[48:51]
  v_mfma_f32_16x16x32_bf16 v[52:55], v[156:159], v[108:111], v[52:55]
  v_mfma_f32_16x16x32_bf16 v[56:59], v[160:163], v[108:111], v[56:59]
  s_waitcnt vmcnt(4)
  v_cmp_ne_u32 vcc, s85, v34
  s_waitcnt vmcnt(3)
  v_cmp_ne_u32 s[14:15], s85, v38
  s_nop 0
  s_or_b64 vcc, vcc, s[14:15]
  s_cbranch_vccnz Lprhs_42
Lpdhs_41:
  v_mfma_f32_16x16x32_bf16 v[44:47], v[164:167], v[112:115], v[44:47]
  v_fmac_f32 v32, v36, v22
  v_fmac_f32 v33, v37, v22
  v_mfma_f32_16x16x32_bf16 v[48:51], v[168:171], v[112:115], v[48:51]
  s_nop 0
  v_permlane32_swap_b32 v32, v33
  v_add_f32 v32, v32, v33
  v_mfma_f32_16x16x32_bf16 v[52:55], v[172:175], v[112:115], v[52:55]
  v_mov_b32 v34, v32
  s_nop 1
  v_permlane16_swap_b32 v32, v34
  v_mfma_f32_16x16x32_bf16 v[56:59], v[176:179], v[112:115], v[56:59]
  v_add_f32 v32, v32, v34
  v_mov_b32 v33, v32
  ds_read_b128 v[92:95], v8 offset:0
  ds_read_b128 v[96:99], v8 offset:64
  ds_read_b128 v[100:103], v8 offset:128
  ds_read_b128 v[104:107], v8 offset:192
  v_mfma_f32_16x16x32_bf16 v[44:47], v[180:183], v[76:79], v[44:47]
  v_permlane32_swap_b32 v32, v33
  v_mul_f32 v32, s82, v32
  v_mfma_f32_16x16x32_bf16 v[48:51], v[184:187], v[76:79], v[48:51]
  v_mul_f32 v34, v32, v32
  v_fma_f32 v33, v33, s82, -v34
  v_mfma_f32_16x16x32_bf16 v[52:55], v[188:191], v[76:79], v[52:55]
  v_add_f32 v34, 0x3727c5ac, v33
  v_rsq_f32 v36, v34
  v_mfma_f32_16x16x32_bf16 v[56:59], v[192:195], v[76:79], v[56:59]
  v_mul_f32 v10, -1.0, v32
  v_mul_f32 v34, v36, v36
  ds_read_b32 v24, v7 offset:32
  ds_read_b128 v[116:119], v6 offset:0
  ds_read_b128 v[120:123], v6 offset:1024
  ds_read_b128 v[124:127], v6 offset:2048
  ds_read_b128 v[128:131], v6 offset:3072
  s_waitcnt vmcnt(2)
  v_mfma_f32_16x16x32_bf16 v[44:47], v[196:199], v[80:83], v[44:47]
  v_mul_f32 v34, v34, v33
  v_add_f32 v34, 0x3727c5ac, v34
  v_mfma_f32_16x16x32_bf16 v[48:51], v[200:203], v[80:83], v[48:51]
  v_rsq_f32 v34, v34
  v_mul_f32 v12, v10, v36
  v_mfma_f32_16x16x32_bf16 v[52:55], v[204:207], v[80:83], v[52:55]
  v_mul_f32 v38, v36, v34
  v_mul_f32 v33, v38, v38
  v_mfma_f32_16x16x32_bf16 v[56:59], v[208:211], v[80:83], v[56:59]
  v_mul_f32 v32, 0xc0135761, v38
  v_mul_f32 v33, v33, v38
  s_waitcnt vmcnt(1)
  v_mfma_f32_16x16x32_bf16 v[44:47], v[212:215], v[84:87], v[44:47]
  v_rcp_f32 v34, v38
  v_mul_f32 v33, 0xbdd2d3e8, v33
  v_mfma_f32_16x16x32_bf16 v[48:51], v[216:219], v[84:87], v[48:51]
  v_mov_b32 v38, v33
  v_mfma_f32_16x16x32_bf16 v[52:55], v[220:223], v[84:87], v[52:55]
  v_mfma_f32_16x16x32_bf16 v[56:59], v[224:227], v[84:87], v[56:59]
  s_waitcnt lgkmcnt(4)
  v_cmp_gt_u32 vcc, 2, v24
  s_nop 0
  s_cbranch_vccnz Llrx_44
Lldx_43:
  s_waitcnt vmcnt(0)
  v_mfma_f32_16x16x32_bf16 v[44:47], v[228:231], v[88:91], v[44:47]
  s_waitcnt lgkmcnt(3)
  v_pk_fma_f32 v[116:117], v[92:93], v[10:11], v[116:117] op_sel_hi:[1,0,1]
  v_pk_fma_f32 v[118:119], v[94:95], v[10:11], v[118:119] op_sel_hi:[1,0,1]
  v_mfma_f32_16x16x32_bf16 v[48:51], v[232:235], v[88:91], v[48:51]
  s_waitcnt lgkmcnt(2)
  v_pk_fma_f32 v[120:121], v[96:97], v[10:11], v[120:121] op_sel_hi:[1,0,1]
  v_pk_fma_f32 v[122:123], v[98:99], v[10:11], v[122:123] op_sel_hi:[1,0,1]
  v_mfma_f32_16x16x32_bf16 v[52:55], v[236:239], v[88:91], v[52:55]
  s_waitcnt lgkmcnt(1)
  v_pk_fma_f32 v[124:125], v[100:101], v[10:11], v[124:125] op_sel_hi:[1,0,1]
  v_pk_fma_f32 v[126:127], v[102:103], v[10:11], v[126:127] op_sel_hi:[1,0,1]
  v_mfma_f32_16x16x32_bf16 v[56:59], v[240:243], v[88:91], v[56:59]
  s_waitcnt lgkmcnt(0)
  v_pk_fma_f32 v[128:129], v[104:105], v[10:11], v[128:129] op_sel_hi:[1,0,1]
  v_pk_fma_f32 v[130:131], v[106:107], v[10:11], v[130:131] op_sel_hi:[1,0,1]
  v_cmp_u_f32 vcc, v44, v44
  s_nop 0
  s_cbranch_vccnz Lnr_46
Lnd_45:
  v_pk_add_f32 v[44:45], v[44:45], v[116:117]
  v_pk_add_f32 v[46:47], v[46:47], v[118:119]
  v_pk_add_f32 v[48:49], v[48:49], v[120:121]
  v_pk_add_f32 v[50:51], v[50:51], v[122:123]
  v_pk_add_f32 v[52:53], v[52:53], v[124:125]
  v_pk_add_f32 v[54:55], v[54:55], v[126:127]
  v_pk_add_f32 v[56:57], v[56:57], v[128:129]
  v_pk_add_f32 v[58:59], v[58:59], v[130:131]
  v_pk_mul_f32 v[76:77], v[44:45], v[44:45]
  v_pk_mul_f32 v[78:79], v[46:47], v[46:47]
  v_pk_mul_f32 v[80:81], v[48:49], v[48:49]
  v_pk_mul_f32 v[82:83], v[50:51], v[50:51]
  v_pk_fma_f32 v[76:77], v[76:77], v[38:39], v[32:33] op_sel_hi:[1,0,0]
  v_pk_fma_f32 v[78:79], v[78:79], v[38:39], v[32:33] op_sel_hi:[1,0,0]
  v_pk_fma_f32 v[80:81], v[80:81], v[38:39], v[32:33] op_sel_hi:[1,0,0]
  v_pk_fma_f32 v[82:83], v[82:83], v[38:39], v[32:33] op_sel_hi:[1,0,0]
  v_pk_mul_f32 v[76:77], v[76:77], v[44:45]
  v_pk_mul_f32 v[78:79], v[78:79], v[46:47]
  v_pk_mul_f32 v[80:81], v[80:81], v[48:49]
  v_pk_mul_f32 v[82:83], v[82:83], v[50:51]
  v_exp_f32 v76, v76
  v_exp_f32 v77, v77
  v_exp_f32 v78, v78
  v_exp_f32 v79, v79
  v_exp_f32 v80, v80
  v_exp_f32 v81, v81
  v_exp_f32 v82, v82
  v_exp_f32 v83, v83
  v_pk_fma_f32 v[76:77], v[76:77], v[34:35], v[34:35] op_sel_hi:[1,0,0]
  v_pk_fma_f32 v[78:79], v[78:79], v[34:35], v[34:35] op_sel_hi:[1,0,0]
  v_pk_fma_f32 v[80:81], v[80:81], v[34:35], v[34:35] op_sel_hi:[1,0,0]
  v_pk_fma_f32 v[82:83], v[82:83], v[34:35], v[34:35] op_sel_hi:[1,0,0]
  v_rcp_f32 v76, v76
  v_rcp_f32 v77, v77
  v_rcp_f32 v78, v78
  v_rcp_f32 v79, v79
  v_rcp_f32 v80, v80
  v_rcp_f32 v81, v81
  v_rcp_f32 v82, v82
  v_rcp_f32 v83, v83
  v_pk_mul_f32 v[44:45], v[44:45], v[76:77]
  v_pk_mul_f32 v[46:47], v[46:47], v[78:79]
  v_pk_mul_f32 v[48:49], v[48:49], v[80:81]
  v_pk_mul_f32 v[50:51], v[50:51], v[82:83]
  v_cvt_pk_bf16_f32 v92, v44, v45
  v_cvt_pk_bf16_f32 v93, v46, v47
  v_cvt_pk_bf16_f32 v94, v48, v49
  v_cvt_pk_bf16_f32 v95, v50, v51
  s_nop 0
  v_permlane16_swap_b32 v92, v94
  v_permlane16_swap_b32 v93, v95
  buffer_store_dwordx4 v[92:95], v252, s[76:79], 0 offen offset:0 sc1
  s_cmp_lg_u32 s10, 0
  s_cbranch_scc1 Lslow_47
  buffer_store_dwordx4 v[92:95], v29, s[76:79], s96 offen offset:0
Lback_48:
  v_pk_mul_f32 v[84:85], v[52:53], v[52:53]
  v_pk_mul_f32 v[86:87], v[54:55], v[54:55]
  v_pk_mul_f32 v[88:89], v[56:57], v[56:57]
  v_pk_mul_f32 v[90:91], v[58:59], v[58:59]
  v_pk_fma_f32 v[84:85], v[84:85], v[38:39], v[32:33] op_sel_hi:[1,0,0]
  v_pk_fma_f32 v[86:87], v[86:87], v[38:39], v[32:33] op_sel_hi:[1,0,0]
  v_pk_fma_f32 v[88:89], v[88:89], v[38:39], v[32:33] op_sel_hi:[1,0,0]
  v_pk_fma_f32 v[90:91], v[90:91], v[38:39], v[32:33] op_sel_hi:[1,0,0]
  v_pk_mul_f32 v[84:85], v[84:85], v[52:53]
  v_pk_mul_f32 v[86:87], v[86:87], v[54:55]
  v_pk_mul_f32 v[88:89], v[88:89], v[56:57]
  v_pk_mul_f32 v[90:91], v[90:91], v[58:59]
  v_exp_f32 v84, v84
  v_exp_f32 v85, v85
  v_exp_f32 v86, v86
  v_exp_f32 v87, v87
  v_exp_f32 v88, v88
  v_exp_f32 v89, v89
  v_exp_f32 v90, v90
  v_exp_f32 v91, v91
  v_pk_fma_f32 v[84:85], v[84:85], v[34:35], v[34:35] op_sel_hi:[1,0,0]
  v_pk_fma_f32 v[86:87], v[86:87], v[34:35], v[34:35] op_sel_hi:[1,0,0]
  v_pk_fma_f32 v[88:89], v[88:89], v[34:35], v[34:35] op_sel_hi:[1,0,0]
  v_pk_fma_f32 v[90:91], v[90:91], v[34:35], v[34:35] op_sel_hi:[1,0,0]
  v_rcp_f32 v84, v84
  v_rcp_f32 v85, v85
  v_rcp_f32 v86, v86
  v_rcp_f32 v87, v87
  v_rcp_f32 v88, v88
  v_rcp_f32 v89, v89
  ds_read_b32 v24, v253
  v_rcp_f32 v90, v90
  v_rcp_f32 v91, v91
  v_pk_mul_f32 v[52:53], v[52:53], v[84:85]
  v_pk_mul_f32 v[54:55], v[54:55], v[86:87]
  v_pk_mul_f32 v[56:57], v[56:57], v[88:89]
  v_pk_mul_f32 v[58:59], v[58:59], v[90:91]
  v_cvt_pk_bf16_f32 v96, v52, v53
  v_cvt_pk_bf16_f32 v97, v54, v55
  v_cvt_pk_bf16_f32 v98, v56, v57
  v_cvt_pk_bf16_f32 v99, v58, v59
  s_nop 0
  v_permlane16_swap_b32 v96, v98
  v_permlane16_swap_b32 v97, v99
  buffer_store_dwordx4 v[96:99], v252, s[76:79], 0 offen offset:1024 sc1
  s_cmp_lg_u32 s10, 0
  s_cbranch_scc1 Lslow_49
  buffer_store_dwordx4 v[96:99], v29, s[76:79], s96 offen offset:1024
  buffer_store_dword v27, v18, s[76:79], 0 offen
Lback_50:
  v_cndmask_b32 v25, 0, 4, s[0:1]
  s_waitcnt lgkmcnt(0)
  v_cmp_gt_u32 vcc, v25, v24
  s_nop 0
  s_cbranch_vccnz Llrg_52
Lldg_51:
  s_and_b32 s12, s8, 1
  s_mul_i32 s12, s12, 16384
  s_add_u32 s12, s12, 0
  v_add_u32 v5, s12, v39
  v_xor_b32 v6, 32, v5
  v_xor_b32 v7, 64, v5
  v_xor_b32 v8, 96, v5
  ds_read_b64_tr_b16 v[132:133], v5 offset:0
  ds_read_b64_tr_b16 v[134:135], v5 offset:512
  ds_read_b64_tr_b16 v[136:137], v6 offset:0
  ds_read_b64_tr_b16 v[138:139], v6 offset:512
  ds_read_b64_tr_b16 v[140:141], v7 offset:0
  ds_read_b64_tr_b16 v[142:143], v7 offset:512
  ds_read_b64_tr_b16 v[144:145], v8 offset:0
  ds_read_b64_tr_b16 v[146:147], v8 offset:512
  ds_read_b64_tr_b16 v[148:149], v5 offset:4096
  ds_read_b64_tr_b16 v[150:151], v5 offset:4608
  ds_read_b64_tr_b16 v[152:153], v6 offset:4096
  ds_read_b64_tr_b16 v[154:155], v6 offset:4608
  ds_read_b64_tr_b16 v[156:157], v7 offset:4096
  ds_read_b64_tr_b16 v[158:159], v7 offset:4608
  ds_read_b64_tr_b16 v[160:161], v8 offset:4096
  ds_read_b64_tr_b16 v[162:163], v8 offset:4608
  ds_read_b64_tr_b16 v[164:165], v5 offset:8192
  ds_read_b64_tr_b16 v[166:167], v5 offset:8704
  ds_read_b64_tr_b16 v[168:169], v6 offset:8192
  ds_read_b64_tr_b16 v[170:171], v6 offset:8704
  ds_read_b64_tr_b16 v[172:173], v7 offset:8192
  ds_read_b64_tr_b16 v[174:175], v7 offset:8704
  ds_read_b64_tr_b16 v[176:177], v8 offset:8192
  ds_read_b64_tr_b16 v[178:179], v8 offset:8704
  ds_read_b64_tr_b16 v[180:181], v5 offset:28672
  ds_read_b64_tr_b16 v[182:183], v5 offset:29184
  ds_read_b64_tr_b16 v[184:185], v6 offset:28672
  ds_read_b64_tr_b16 v[186:187], v6 offset:29184
  ds_read_b64_tr_b16 v[188:189], v7 offset:28672
  ds_read_b64_tr_b16 v[190:191], v7 offset:29184
  ds_read_b64_tr_b16 v[192:193], v8 offset:28672
  ds_read_b64_tr_b16 v[194:195], v8 offset:29184
  ds_read_b64_tr_b16 v[196:197], v5 offset:32768
  ds_read_b64_tr_b16 v[198:199], v5 offset:33280
  ds_read_b64_tr_b16 v[200:201], v6 offset:32768
  ds_read_b64_tr_b16 v[202:203], v6 offset:33280
  ds_read_b64_tr_b16 v[204:205], v7 offset:32768
  ds_read_b64_tr_b16 v[206:207], v7 offset:33280
  ds_read_b64_tr_b16 v[208:209], v8 offset:32768
  ds_read_b64_tr_b16 v[210:211], v8 offset:33280
  ds_read_b64_tr_b16 v[212:213], v5 offset:36864
  ds_read_b64_tr_b16 v[214:215], v5 offset:37376
  ds_read_b64_tr_b16 v[216:217], v6 offset:36864
  ds_read_b64_tr_b16 v[218:219], v6 offset:37376
  ds_read_b64_tr_b16 v[220:221], v7 offset:36864
  ds_read_b64_tr_b16 v[222:223], v7 offset:37376
  ds_read_b64_tr_b16 v[224:225], v8 offset:36864
  ds_read_b64_tr_b16 v[226:227], v8 offset:37376
  v_xor_b32 v5, 0, v40
  v_xor_b32 v6, 32, v40
  v_xor_b32 v7, 64, v40
  v_xor_b32 v8, 96, v40
  ds_read_b64_tr_b16 v[228:229], v5 offset:0
  ds_read_b64_tr_b16 v[230:231], v5 offset:512
  ds_read_b64_tr_b16 v[232:233], v6 offset:0
  ds_read_b64_tr_b16 v[234:235], v6 offset:512
  ds_read_b64_tr_b16 v[236:237], v7 offset:0
  ds_read_b64_tr_b16 v[238:239], v7 offset:512
  ds_read_b64_tr_b16 v[240:241], v8 offset:0
  ds_read_b64_tr_b16 v[242:243], v8 offset:512
  v_mov_b32 v23, 5
  ds_write_b32 v251, v23
  s_lshl_b32 s12, s8, 12
  s_add_u32 s12, s12, 40960
  v_add_u32 v5, s12, v4
  v_xor_b32 v6, 4096, v5
  v_xor_b32 v7, 4, v251
  v_pk_fma_f32 v[44:45], v[60:61], v[36:37], v[12:13] op_sel_hi:[1,0,0]
  v_pk_fma_f32 v[46:47], v[62:63], v[36:37], v[12:13] op_sel_hi:[1,0,0]
  v_pk_fma_f32 v[48:49], v[64:65], v[36:37], v[12:13] op_sel_hi:[1,0,0]
  v_pk_fma_f32 v[50:51], v[66:67], v[36:37], v[12:13] op_sel_hi:[1,0,0]
  v_pk_fma_f32 v[52:53], v[68:69], v[36:37], v[12:13] op_sel_hi:[1,0,0]
  v_pk_fma_f32 v[54:55], v[70:71], v[36:37], v[12:13] op_sel_hi:[1,0,0]
  v_pk_fma_f32 v[56:57], v[72:73], v[36:37], v[12:13] op_sel_hi:[1,0,0]
  v_pk_fma_f32 v[58:59], v[74:75], v[36:37], v[12:13] op_sel_hi:[1,0,0]
  s_mov_b32 s92, 57344
  s_mov_b32 s93, 64512
  s_mov_b32 s96, 0
  v_lshrrev_b32 v15, 5, v1
  v_lshlrev_b32 v15, 3, v15
  v_bfe_u32 v17, v1, 2, 2
  v_add_u32 v15, v15, v17
  v_and_b32 v16, 3, v1
  v_and_b32 v14, 1, v3
  v_lshlrev_b32 v14, 5, v14
  v_lshl_add_u32 v14, v16, 3, v14
  v_lshl_add_u32 v14, v15, 7, v14
  v_lshrrev_b32 v17, 1, v17
  v_lshl_add_u32 v14, v17, 6, v14
  s_and_b32 s12, s84, 1
  s_lshl_b32 s12, s12, 6
  v_xor_b32 v14, s12, v14
  s_lshr_b32 s12, s84, 1
  s_lshl_b32 s12, s12, 11
  s_add_u32 s12, s12, 114688
  v_add_u32 v14, s12, v14
  s_mul_i32 s12, s8, 7168
  s_add_u32 s12, s12, s80
  v_add_u32 v28, s12, v4
Lpollt_53:
  buffer_load_dword v16, v250, s[76:79], 0 offen sc1
  s_waitcnt vmcnt(0)
  v_cmp_ne_u32 vcc, s9, v16
  s_nop 0
  s_cbranch_vccz Lpdt_54
  s_sub_u32 s11, s11, 1
  s_cbranch_scc0 Lpollt_53
  s_mov_b32 s11, 0
Lpdt_54:
  buffer_load_dwordx4 v[76:79], v244, s[76:79], s92 offen offset:0 sc1
  buffer_load_dwordx4 v[80:83], v244, s[76:79], s92 offen offset:1024 sc1
  buffer_load_dwordx4 v[84:87], v244, s[76:79], s92 offen offset:2048 sc1
  buffer_load_dwordx4 v[88:91], v245, s[76:79], s93 offen offset:0 sc1
  buffer_load_dwordx4 v[92:95], v245, s[76:79], s93 offen offset:1024 sc1
  buffer_load_dwordx4 v[96:99], v245, s[76:79], s93 offen offset:2048 sc1
  buffer_load_dwordx4 v[100:103], v246, s[76:79], s92 offen offset:0 sc1
  buffer_load_dword v17, v19, s[76:79], 0 offen sc1
  s_waitcnt vmcnt(7) lgkmcnt(15)
  v_mfma_f32_16x16x32_bf16 v[116:119], v[132:135], v[76:79], 0
  s_waitcnt lgkmcnt(15)
  v_mfma_f32_16x16x32_bf16 v[120:123], v[136:139], v[76:79], 0
  s_waitcnt lgkmcnt(15)
  v_mfma_f32_16x16x32_bf16 v[124:127], v[140:143], v[76:79], 0
  s_waitcnt lgkmcnt(15)
  v_mfma_f32_16x16x32_bf16 v[128:131], v[144:147], v[76:79], 0
  s_waitcnt vmcnt(6) lgkmcnt(15)
  v_mfma_f32_16x16x32_bf16 v[116:119], v[148:151], v[80:83], v[116:119]
  s_waitcnt lgkmcnt(15)
  v_mfma_f32_16x16x32_bf16 v[120:123], v[152:155], v[80:83], v[120:123]
  s_waitcnt lgkmcnt(15)
  v_mfma_f32_16x16x32_bf16 v[124:127], v[156:159], v[80:83], v[124:127]
  s_waitcnt lgkmcnt(15)
  v_mfma_f32_16x16x32_bf16 v[128:131], v[160:163], v[80:83], v[128:131]
  s_waitcnt vmcnt(5) lgkmcnt(15)
  v_mfma_f32_16x16x32_bf16 v[116:119], v[164:167], v[84:87], v[116:119]
  s_waitcnt lgkmcnt(15)
  v_mfma_f32_16x16x32_bf16 v[120:123], v[168:171], v[84:87], v[120:123]
  s_waitcnt lgkmcnt(15)
  v_mfma_f32_16x16x32_bf16 v[124:127], v[172:175], v[84:87], v[124:127]
  s_waitcnt lgkmcnt(15)
  v_mfma_f32_16x16x32_bf16 v[128:131], v[176:179], v[84:87], v[128:131]
  s_waitcnt vmcnt(0)
  v_cmp_eq_u32 vcc, -1, v17
  s_nop 0
  s_cbranch_vccnz Lprhl_56
Lpdhl_55:
  s_waitcnt lgkmcnt(15)
  v_mfma_f32_16x16x32_bf16 v[116:119], v[180:183], v[88:91], v[116:119]
  s_waitcnt lgkmcnt(15)
  v_mfma_f32_16x16x32_bf16 v[120:123], v[184:187], v[88:91], v[120:123]
  buffer_load_dwordx4 v[104:107], v247, s[76:79], s92 offen offset:0 sc1
  s_waitcnt lgkmcnt(15)
  v_mfma_f32_16x16x32_bf16 v[124:127], v[188:191], v[88:91], v[124:127]
  buffer_load_dwordx4 v[108:111], v247, s[76:79], s92 offen offset:1024 sc1
  s_waitcnt lgkmcnt(15)
  v_mfma_f32_16x16x32_bf16 v[128:131], v[192:195], v[88:91], v[128:131]
  buffer_load_dwordx4 v[112:115], v247, s[76:79], s92 offen offset:2048 sc1
  v_mov_b32 v23, 6
  ds_write_b32 v251, v23
  s_waitcnt lgkmcnt(15)
  v_mfma_f32_16x16x32_bf16 v[116:119], v[196:199], v[92:95], v[116:119]
  s_waitcnt lgkmcnt(15)
  v_mfma_f32_16x16x32_bf16 v[120:123], v[200:203], v[92:95], v[120:123]
  buffer_load_dwordx4 v[76:79], v248, s[76:79], s93 offen offset:0 sc1
  s_waitcnt lgkmcnt(15)
  v_mfma_f32_16x16x32_bf16 v[124:127], v[204:207], v[92:95], v[124:127]
  s_waitcnt lgkmcnt(15)
  v_mfma_f32_16x16x32_bf16 v[128:131], v[208:211], v[92:95], v[128:131]
  buffer_load_dwordx4 v[80:83], v248, s[76:79], s93 offen offset:1024 sc1
  ds_read_b32 v24, v253
  s_waitcnt lgkmcnt(15)
  v_mfma_f32_16x16x32_bf16 v[116:119], v[212:215], v[96:99], v[116:119]
  s_waitcnt lgkmcnt(15)
  v_mfma_f32_16x16x32_bf16 v[120:123], v[216:219], v[96:99], v[120:123]
  buffer_load_dwordx4 v[84:87], v248, s[76:79], s93 offen offset:2048 sc1
  s_waitcnt lgkmcnt(13)
  v_mfma_f32_16x16x32_bf16 v[124:127], v[220:223], v[96:99], v[124:127]
  s_waitcnt lgkmcnt(11)
  v_mfma_f32_16x16x32_bf16 v[128:131], v[224:227], v[96:99], v[128:131]
  buffer_load_dwordx4 v[88:91], v249, s[76:79], s92 offen offset:0 sc1
  s_waitcnt lgkmcnt(9)
  v_mfma_f32_16x16x32_bf16 v[116:119], v[228:231], v[100:103], v[116:119]
  s_waitcnt lgkmcnt(7)
  v_mfma_f32_16x16x32_bf16 v[120:123], v[232:235], v[100:103], v[120:123]
  s_waitcnt lgkmcnt(5)
  v_mfma_f32_16x16x32_bf16 v[124:127], v[236:239], v[100:103], v[124:127]
  s_waitcnt lgkmcnt(3)
  v_mfma_f32_16x16x32_bf16 v[128:131], v[240:243], v[100:103], v[128:131]
  v_cndmask_b32 v25, 5, 0, s[0:1]
  s_waitcnt lgkmcnt(0)
  v_cmp_gt_u32 vcc, v25, v24
  s_nop 0
  s_cbranch_vccnz Llrg_58
Lldg_57:
  s_waitcnt vmcnt(6)
  v_mfma_f32_16x16x32_bf16 v[44:47], v[132:135], v[104:107], v[44:47]
  v_mfma_f32_16x16x32_bf16 v[48:51], v[136:139], v[104:107], v[48:51]
  v_mfma_f32_16x16x32_bf16 v[52:55], v[140:143], v[104:107], v[52:55]
  v_mfma_f32_16x16x32_bf16 v[56:59], v[144:147], v[104:107], v[56:59]
  v_cmp_u_f32 vcc, v116, v116
  s_nop 0
  s_cbranch_vccnz Lnr_60
Lnd_59:
  ds_write_b128 v5, v[116:119] offset:0
  ds_write_b128 v5, v[120:123] offset:1024
  ds_write_b128 v5, v[124:127] offset:2048
  ds_write_b128 v5, v[128:131] offset:3072
  v_mov_b32 v23, 3
  ds_write_b32 v251, v23 offset:32
  s_waitcnt vmcnt(5)
  v_mfma_f32_16x16x32_bf16 v[44:47], v[148:151], v[108:111], v[44:47]
  v_mfma_f32_16x16x32_bf16 v[48:51], v[152:155], v[108:111], v[48:51]
  v_mfma_f32_16x16x32_bf16 v[52:55], v[156:159], v[108:111], v[52:55]
  v_mfma_f32_16x16x32_bf16 v[56:59], v[160:163], v[108:111], v[56:59]
  s_waitcnt vmcnt(4)
  v_mfma_f32_16x16x32_bf16 v[44:47], v[164:167], v[112:115], v[44:47]
  v_mfma_f32_16x16x32_bf16 v[48:51], v[168:171], v[112:115], v[48:51]
  v_mfma_f32_16x16x32_bf16 v[52:55], v[172:175], v[112:115], v[52:55]
  v_mfma_f32_16x16x32_bf16 v[56:59], v[176:179], v[112:115], v[56:59]
  s_waitcnt vmcnt(3)
  v_mfma_f32_16x16x32_bf16 v[44:47], v[180:183], v[76:79], v[44:47]
  v_mfma_f32_16x16x32_bf16 v[48:51], v[184:187], v[76:79], v[48:51]
  v_mfma_f32_16x16x32_bf16 v[52:55], v[188:191], v[76:79], v[52:55]
  v_mfma_f32_16x16x32_bf16 v[56:59], v[192:195], v[76:79], v[56:59]
  ds_read_b32 v24, v7 offset:32
  ds_read_b128 v[116:119], v6 offset:0
  ds_read_b128 v[120:123], v6 offset:1024
  ds_read_b128 v[124:127], v6 offset:2048
  ds_read_b128 v[128:131], v6 offset:3072
  s_waitcnt vmcnt(2)
  v_mfma_f32_16x16x32_bf16 v[44:47], v[196:199], v[80:83], v[44:47]
  v_mfma_f32_16x16x32_bf16 v[48:51], v[200:203], v[80:83], v[48:51]
  v_mfma_f32_16x16x32_bf16 v[52:55], v[204:207], v[80:83], v[52:55]
  v_mfma_f32_16x16x32_bf16 v[56:59], v[208:211], v[80:83], v[56:59]
  s_waitcnt vmcnt(1)
  v_mfma_f32_16x16x32_bf16 v[44:47], v[212:215], v[84:87], v[44:47]
  v_mfma_f32_16x16x32_bf16 v[48:51], v[216:219], v[84:87], v[48:51]
  v_mfma_f32_16x16x32_bf16 v[52:55], v[220:223], v[84:87], v[52:55]
  v_mfma_f32_16x16x32_bf16 v[56:59], v[224:227], v[84:87], v[56:59]
  s_waitcnt lgkmcnt(4)
  v_cmp_gt_u32 vcc, 3, v24
  s_nop 0
  s_cbranch_vccnz Llrx_62
Lldx_61:
  s_waitcnt vmcnt(0)
  v_mfma_f32_16x16x32_bf16 v[44:47], v[228:231], v[88:91], v[44:47]
  v_mfma_f32_16x16x32_bf16 v[48:51], v[232:235], v[88:91], v[48:51]
  v_mfma_f32_16x16x32_bf16 v[52:55], v[236:239], v[88:91], v[52:55]
  v_mfma_f32_16x16x32_bf16 v[56:59], v[240:243], v[88:91], v[56:59]
  s_nop 4
  v_cmp_u_f32 vcc, v44, v44
  s_nop 0
  s_cbranch_vccnz Lnr_64
Lnd_63:
  s_waitcnt lgkmcnt(3)
  v_pk_add_f32 v[44:45], v[44:45], v[116:117]
  v_pk_add_f32 v[46:47], v[46:47], v[118:119]
  s_waitcnt lgkmcnt(2)
  v_pk_add_f32 v[48:49], v[48:49], v[120:121]
  v_pk_add_f32 v[50:51], v[50:51], v[122:123]
  s_waitcnt lgkmcnt(1)
  v_pk_add_f32 v[52:53], v[52:53], v[124:125]
  v_pk_add_f32 v[54:55], v[54:55], v[126:127]
  s_waitcnt lgkmcnt(0)
  v_pk_add_f32 v[56:57], v[56:57], v[128:129]
  v_pk_add_f32 v[58:59], v[58:59], v[130:131]
  v_cvt_pk_bf16_f32 v76, v44, v45
  v_cvt_pk_bf16_f32 v77, v46, v47
  v_cvt_pk_bf16_f32 v78, v48, v49
  v_cvt_pk_bf16_f32 v79, v50, v51
  s_nop 0
  v_permlane16_swap_b32 v76, v78
  v_permlane16_swap_b32 v77, v79
  v_cvt_pk_bf16_f32 v80, v52, v53
  v_cvt_pk_bf16_f32 v81, v54, v55
  v_cvt_pk_bf16_f32 v82, v56, v57
  v_cvt_pk_bf16_f32 v83, v58, v59
  s_nop 0
  v_permlane16_swap_b32 v80, v82
  v_permlane16_swap_b32 v81, v83
  s_cmp_lg_u32 s10, 0
  s_cbranch_scc1 Lslow_65
  buffer_store_dwordx4 v[76:79], v29, s[76:79], s96 offen
  buffer_store_dwordx4 v[80:83], v29, s[76:79], s96 offen offset:1024
Lback_66:
  v_pk_add_f32 v[84:85], v[44:45], v[46:47]
  v_pk_mul_f32 v[86:87], v[44:45], v[44:45]
  v_pk_fma_f32 v[86:87], v[46:47], v[46:47], v[86:87]
  v_pk_add_f32 v[84:85], v[84:85], v[48:49]
  v_pk_fma_f32 v[86:87], v[48:49], v[48:49], v[86:87]
  v_pk_add_f32 v[84:85], v[84:85], v[50:51]
  v_pk_fma_f32 v[86:87], v[50:51], v[50:51], v[86:87]
  v_pk_add_f32 v[84:85], v[84:85], v[52:53]
  v_pk_fma_f32 v[86:87], v[52:53], v[52:53], v[86:87]
  v_pk_add_f32 v[84:85], v[84:85], v[54:55]
  v_pk_fma_f32 v[86:87], v[54:55], v[54:55], v[86:87]
  v_pk_add_f32 v[84:85], v[84:85], v[56:57]
  v_pk_fma_f32 v[86:87], v[56:57], v[56:57], v[86:87]
  v_pk_add_f32 v[84:85], v[84:85], v[58:59]
  v_pk_fma_f32 v[86:87], v[58:59], v[58:59], v[86:87]
  v_add_f32 v88, v84, v85
  v_add_f32 v89, v86, v87
  s_nop 1
  v_permlane32_swap_b32 v88, v89
  v_add_f32 v88, v88, v89
  v_mov_b32 v84, v88
  s_nop 1
  v_permlane16_swap_b32 v88, v84
  v_add_f32 v88, v88, v84
  v_mov_b32 v89, v88
  s_nop 1
  v_permlane32_swap_b32 v88, v89
  v_or_b32 v90, 2, v27
  s_cmp_lg_u32 s10, 0
  s_cbranch_scc1 Lslow_67
  buffer_store_dwordx3 v[88:90], v9, s[76:79], 0 offen
Lback_68:
  v_pk_add_f32 v[240:241], v[60:61], v[44:45]
  v_pk_add_f32 v[242:243], v[62:63], v[46:47]
  v_pk_add_f32 v[244:245], v[64:65], v[48:49]
  v_pk_add_f32 v[246:247], v[66:67], v[50:51]
  v_pk_add_f32 v[248:249], v[68:69], v[52:53]
  v_pk_add_f32 v[250:251], v[70:71], v[54:55]
  v_pk_add_f32 v[252:253], v[72:73], v[56:57]
  v_pk_add_f32 v[254:255], v[74:75], v[58:59]
  s_setprio 0
  s_barrier
  v_subrev_u32 v8, 57344, v14
  v_subrev_u32 v17, 114688, v14
  ds_read_b64_tr_b16 v[196:197], v17 offset:0
  ds_read_b64_tr_b16 v[198:199], v17 offset:512
  ds_read_b64_tr_b16 v[200:201], v17 offset:4096
  ds_read_b64_tr_b16 v[202:203], v17 offset:4608
  ds_read_b64_tr_b16 v[204:205], v17 offset:8192
  ds_read_b64_tr_b16 v[206:207], v17 offset:8704
  ds_read_b64_tr_b16 v[208:209], v17 offset:12288
  ds_read_b64_tr_b16 v[210:211], v17 offset:12800
  ds_read_b64_tr_b16 v[212:213], v17 offset:16384
  ds_read_b64_tr_b16 v[214:215], v17 offset:16896
  ds_read_b64_tr_b16 v[216:217], v17 offset:20480
  ds_read_b64_tr_b16 v[218:219], v17 offset:20992
  ds_read_b64_tr_b16 v[220:221], v17 offset:24576
  ds_read_b64_tr_b16 v[222:223], v17 offset:25088
  ds_read_b64_tr_b16 v[224:225], v17 offset:28672
  ds_read_b64_tr_b16 v[226:227], v17 offset:29184
  ds_read_b64_tr_b16 v[228:229], v17 offset:32768
  ds_read_b64_tr_b16 v[230:231], v17 offset:33280
  ds_read_b64_tr_b16 v[232:233], v17 offset:36864
  ds_read_b64_tr_b16 v[234:235], v17 offset:37376
  ds_read_b64_tr_b16 v[236:237], v14 offset:40960
  ds_read_b64_tr_b16 v[238:239], v14 offset:41472
  v_lshrrev_b32 v15, 2, v2
  v_and_b32 v16, 1, v3
  v_cmp_eq_u32 vcc, v15, v16
  v_mov_b32 v15, 0x3f803f80
  s_nop 0
  v_cndmask_b32 v108, 0, v15, vcc
  v_cndmask_b32 v109, 0, v15, vcc
  v_cndmask_b32 v110, 0, v15, vcc
  v_cndmask_b32 v111, 0, v15, vcc
  s_lshl_b32 s12, s8, 2
  s_add_u32 s12, s12, 159744
  v_mov_b32 v0, s12
  v_and_b32 v26, 7, v1
  v_lshlrev_b32 v26, 2, v26
  v_add_u32 v26, 159744, v26
  s_waitcnt vmcnt(1)
  s_waitcnt lgkmcnt(0)
  s_barrier
  s_setprio 3
  ds_read_b64_tr_b16 v[128:129], v14 offset:0
  ds_read_b64_tr_b16 v[130:131], v14 offset:512
  ds_read_b64_tr_b16 v[132:133], v14 offset:4096
  ds_read_b64_tr_b16 v[134:135], v14 offset:4608
  ds_read_b64_tr_b16 v[136:137], v14 offset:8192
  ds_read_b64_tr_b16 v[138:139], v14 offset:8704
  ds_read_b64_tr_b16 v[140:141], v8 offset:0
  ds_read_b64_tr_b16 v[142:143], v8 offset:512
  ds_read_b64_tr_b16 v[144:145], v8 offset:4096
  ds_read_b64_tr_b16 v[146:147], v8 offset:4608
  ds_read_b64_tr_b16 v[148:149], v8 offset:8192
  ds_read_b64_tr_b16 v[150:151], v8 offset:8704
  ds_read_b64_tr_b16 v[152:153], v8 offset:12288
  ds_read_b64_tr_b16 v[154:155], v8 offset:12800
  ds_read_b64_tr_b16 v[156:157], v8 offset:16384
  ds_read_b64_tr_b16 v[158:159], v8 offset:16896
  ds_read_b64_tr_b16 v[160:161], v8 offset:20480
  ds_read_b64_tr_b16 v[162:163], v8 offset:20992
  ds_read_b64_tr_b16 v[164:165], v8 offset:24576
  ds_read_b64_tr_b16 v[166:167], v8 offset:25088
  ds_read_b64_tr_b16 v[168:169], v8 offset:28672
  ds_read_b64_tr_b16 v[170:171], v8 offset:29184
  ds_read_b64_tr_b16 v[172:173], v8 offset:32768
  ds_read_b64_tr_b16 v[174:175], v8 offset:33280
  ds_read_b64_tr_b16 v[176:177], v8 offset:36864
  ds_read_b64_tr_b16 v[178:179], v8 offset:37376
  ds_read_b64_tr_b16 v[180:181], v8 offset:40960
  ds_read_b64_tr_b16 v[182:183], v8 offset:41472
  ds_read_b64_tr_b16 v[184:185], v8 offset:45056
  ds_read_b64_tr_b16 v[186:187], v8 offset:45568
  ds_read_b64_tr_b16 v[188:189], v8 offset:49152
  ds_read_b64_tr_b16 v[190:191], v8 offset:49664
  ds_read_b64_tr_b16 v[192:193], v8 offset:53248
  ds_read_b64_tr_b16 v[194:195], v8 offset:53760
  v_mov_b32 v23, 7
  ds_write_b32 v0, v23
  v_bfe_u32 v15, v1, 4, 1
  v_mul_u32_u24 v5, 14336, v15
  v_lshl_add_u32 v5, v2, 4, v5
  v_lshrrev_b32 v16, 5, v1
  v_lshl_add_u32 v5, v16, 8, v5
  v_and_b32 v6, 31, v1
  v_lshlrev_b32 v6, 5, v6
  v_add_u32 v6, 160256, v6
  s_mul_i32 s12, s84, 28672
  s_lshl_b32 s13, s7, 7
  s_add_u32 s12, s12, s13
  v_lshrrev_b32 v15, 3, v1
  v_mul_u32_u24 v10, 896, v15
  v_bfe_u32 v15, v1, 4, 1
  v_lshlrev_b32 v15, 2, v15
  v_and_b32 v16, 7, v1
  v_xor_b32 v15, v15, v16
  v_lshl_add_u32 v10, v15, 4, v10
  v_add_u32 v10, s12, v10
  v_add_u32 v11, 6144, v10
  s_mul_i32 s92, s7, 229376
  s_sub_u32 s93, s92, 1605632
  s_lshl_b32 s94, s7, 13
  s_sub_u32 s95, s94, 57344
  s_lshl_b32 s97, s84, 11
  v_lshrrev_b32 v15, 5, v1
  v_bfe_u32 v16, v1, 2, 2
  v_lshl_add_u32 v15, v15, 2, v16
  v_and_b32 v18, 1, v3
  v_lshlrev_b32 v18, 5, v18
  v_and_b32 v16, 3, v1
  v_lshl_add_u32 v18, v16, 3, v18
  v_lshl_add_u32 v18, v15, 7, v18
  v_bfe_u32 v16, v1, 3, 1
  v_lshl_add_u32 v18, v16, 6, v18
  v_add_u32 v18, s97, v18
  v_add_u32 v18, 114688, v18
  v_xor_b32 v19, 64, v18
  s_and_b32 s12, s84, 1
  s_lshl_b32 s12, s12, 12
  s_lshr_b32 s13, s84, 1
  s_mul_i32 s13, s13, 71680
  s_add_u32 s12, s12, s13
  s_add_u32 s12, s12, s80
  s_add_u32 s12, s12, 0
  v_add_u32 v7, s12, v4
  s_lshl_b32 s12, s84, 5
  s_add_u32 s12, s12, s80
  s_add_u32 s12, s12, 200960
  v_min_u32 v15, 6, v1
  v_lshlrev_b32 v15, 2, v15
  v_add_u32 v12, s12, v15
  s_lshl_b32 s13, s7, 2
  s_add_u32 s12, s12, s13
  v_add_u32 v9, s12, v21
  v_mov_b32 v38, 0
  v_mov_b32 v39, 0
  s_mul_i32 s12, s84, 7168
  v_and_b32 v17, 60, v1
  v_lshl_add_u32 v17, v1, 6, v17
  v_add_u32 v17, s12, v17
  v_mfma_f32_16x16x32_bf16 v[32:35], v[108:111], v[196:199], 0
  v_mfma_f32_16x16x32_bf16 v[32:35], v[108:111], v[200:203], v[32:35]
  v_mfma_f32_16x16x32_bf16 v[32:35], v[108:111], v[204:207], v[32:35]
  v_mfma_f32_16x16x32_bf16 v[32:35], v[108:111], v[208:211], v[32:35]
  buffer_load_dwordx3 v[60:62], v30, s[76:79], 0 offen sc1
  v_mfma_f32_16x16x32_bf16 v[32:35], v[108:111], v[212:215], v[32:35]
  v_mfma_f32_16x16x32_bf16 v[32:35], v[108:111], v[216:219], v[32:35]
  v_mfma_f32_16x16x32_bf16 v[32:35], v[108:111], v[220:223], v[32:35]
  buffer_load_dwordx3 v[64:66], v31, s[76:79], 0 offen sc1
  v_mfma_f32_16x16x32_bf16 v[32:35], v[108:111], v[224:227], v[32:35]
  v_mfma_f32_16x16x32_bf16 v[32:35], v[108:111], v[228:231], v[32:35]
  v_mfma_f32_16x16x32_bf16 v[32:35], v[108:111], v[232:235], v[32:35]
  s_mul_i32 s12, s84, 7168
  s_mov_b32 s13, 28672
  s_add_u32 m0, s12, 28672
  s_nop 0
  buffer_load_dwordx4 v28, s[76:79], s13 offen offset:0 sc1 lds
  v_mfma_f32_16x16x32_bf16 v[32:35], v[108:111], v[236:239], v[32:35]
  s_waitcnt lgkmcnt(15)
  v_mfma_f32_16x16x32_bf16 v[32:35], v[108:111], v[128:131], v[32:35]
  s_waitcnt lgkmcnt(15)
  v_mfma_f32_16x16x32_bf16 v[32:35], v[108:111], v[132:135], v[32:35]
  buffer_load_dwordx4 v28, s[76:79], s13 offen offset:1024 sc1 lds
  s_waitcnt lgkmcnt(15)
  v_mfma_f32_16x16x32_bf16 v[32:35], v[108:111], v[136:139], v[32:35]
  s_waitcnt lgkmcnt(15)
  v_mfma_f32_16x16x32_bf16 v[32:35], v[108:111], v[140:143], v[32:35]
  s_waitcnt lgkmcnt(15)
  v_mfma_f32_16x16x32_bf16 v[32:35], v[108:111], v[144:147], v[32:35]
  buffer_load_dwordx4 v28, s[76:79], s13 offen offset:2048 sc1 lds
  s_waitcnt lgkmcnt(15)
  v_mfma_f32_16x16x32_bf16 v[32:35], v[108:111], v[148:151], v[32:35]
  s_waitcnt lgkmcnt(15)
  v_mfma_f32_16x16x32_bf16 v[32:35], v[108:111], v[152:155], v[32:35]
  s_waitcnt lgkmcnt(15)
  v_mfma_f32_16x16x32_bf16 v[32:35], v[108:111], v[156:159], v[32:35]
  buffer_load_dwordx4 v28, s[76:79], s13 offen offset:3072 sc1 lds
  s_waitcnt lgkmcnt(15)
  v_mfma_f32_16x16x32_bf16 v[32:35], v[108:111], v[160:163], v[32:35]
  s_waitcnt lgkmcnt(15)
  v_mfma_f32_16x16x32_bf16 v[32:35], v[108:111], v[164:167], v[32:35]
  ds_read_b32 v24, v26
  s_waitcnt lgkmcnt(14)
  v_mfma_f32_16x16x32_bf16 v[32:35], v[108:111], v[168:171], v[32:35]
  s_mov_b32 s13, 32768
  s_add_u32 m0, s12, 32768
  s_nop 0
  buffer_load_dwordx4 v28, s[76:79], s13 offen offset:0 sc1 lds
  s_waitcnt lgkmcnt(12)
  v_mfma_f32_16x16x32_bf16 v[32:35], v[108:111], v[172:175], v[32:35]
  s_waitcnt lgkmcnt(10)
  v_mfma_f32_16x16x32_bf16 v[32:35], v[108:111], v[176:179], v[32:35]
  s_waitcnt lgkmcnt(8)
  v_mfma_f32_16x16x32_bf16 v[32:35], v[108:111], v[180:183], v[32:35]
  buffer_load_dwordx4 v28, s[76:79], s13 offen offset:1024 sc1 lds
  s_waitcnt lgkmcnt(6)
  v_mfma_f32_16x16x32_bf16 v[32:35], v[108:111], v[184:187], v[32:35]
  s_waitcnt lgkmcnt(4)
  v_mfma_f32_16x16x32_bf16 v[32:35], v[108:111], v[188:191], v[32:35]
  s_waitcnt lgkmcnt(2)
  v_mfma_f32_16x16x32_bf16 v[32:35], v[108:111], v[192:195], v[32:35]
  buffer_load_dwordx4 v28, s[76:79], s13 offen offset:2048 sc1 lds
  v_cndmask_b32 v25, 7, 0, s[0:1]
  s_waitcnt lgkmcnt(0)
  v_cmp_gt_u32 vcc, v25, v24
  s_nop 0
  s_cbranch_vccnz Llrg_70
Lldg_69:
  s_nop 1
  v_cvt_pk_bf16_f32 v37, v32, v32
  v_and_b32 v33, 0xffff0000, v37
  v_sub_f32 v33, v32, v33
  v_cvt_pk_bf16_f32 v36, v32, v33
  v_subrev_u32 v108, 114688, v18
  v_subrev_u32 v109, 114688, v19
  s_or_b32 s85, s9, 2
  s_waitcnt vmcnt(8)
  v_cmp_ne_u32 vcc, s85, v62
  s_waitcnt vmcnt(7)
  v_cmp_ne_u32 s[14:15], s85, v66
  s_nop 0
  s_or_b64 vcc, vcc, s[14:15]
  s_cbranch_vccnz Lprxs_72
Lpdxs_71:
  s_cmp_ge_u32 s7, 7
  s_cselect_b32 s98, s93, s92
  s_add_u32 m0, s97, 57344
  s_add_u32 s98, s98, 0
  buffer_load_dwordx4 v10, s[68:71], s98 offen lds
  v_fmac_f32 v60, v64, v22
  v_fmac_f32 v61, v65, v22
  s_nop 1
  v_permlane32_swap_b32 v60, v61
  v_add_f32 v60, v60, v61
  v_mov_b32 v62, v60
  s_nop 1
  v_permlane16_swap_b32 v60, v62
  v_add_f32 v60, v60, v62
  buffer_load_dwordx4 v11, s[68:71], s98 offen offset:1024 lds
  v_mov_b32 v61, v60
  s_nop 1
  v_permlane32_swap_b32 v60, v61
  v_mul_f32 v60, s82, v60
  v_mul_f32 v62, v60, v60
  v_fma_f32 v61, v61, s82, -v62
  v_mul_f32 v63, -1.0, v60
  v_cvt_pk_bf16_f32 v40, v63, v63
  s_cmp_ge_u32 s7, 7
  s_cselect_b32 s98, s93, s92
  s_add_u32 m0, s97, 65536
  s_add_u32 s98, s98, 14336
  buffer_load_dwordx4 v10, s[68:71], s98 offen lds
  v_and_b32 v62, 0xffff0000, v40
  v_sub_f32 v62, v63, v62
  v_cvt_pk_bf16_f32 v41, v62, 0
  v_add_f32 v62, 0x3727c5ac, v61
  v_rsq_f32 v64, v62
  s_nop 0
  v_mul_f32 v45, v64, v64
  v_mul_f32 v44, 0xc0135761, v64
  buffer_load_dwordx4 v11, s[68:71], s98 offen offset:1024 lds
  v_mul_f32 v45, v45, v64
  v_rcp_f32 v46, v64
  v_mul_f32 v45, 0xbdd2d3e8, v45
  s_lshl_b32 s12, s8, 9
  s_add_u32 s12, s12, 160256
  v_lshlrev_b32 v15, 5, v2
  v_add_u32 v15, s12, v15
  ds_write_b128 v15, v[40:43]
  ds_write_b128 v15, v[44:47] offset:16
  ds_read_b32 v24, v26
  s_waitcnt vmcnt(4)
  ds_read_b32 v40, v17 offset:28672
  ds_read_b32 v41, v17 offset:31744
  s_waitcnt lgkmcnt(0)
  v_max_u32 v40, v40, v41
  v_cmp_eq_u32 vcc, -1, v40
  s_nop 0
  s_cbranch_vccnz Lxr_74
Lxd_73:
  v_mov_b32 v23, 8
  ds_write_b32 v0, v23
  s_setprio 1
  v_cndmask_b32 v25, 0, 5, s[0:1]
  v_cmp_gt_u32 vcc, v25, v24
  s_nop 0
  s_cbranch_vccnz Llrg_76
Lldg_75:
  ds_read_b128 v[76:79], v5 offset:0
  ds_read_b128 v[80:83], v5 offset:512
  ds_read_b128 v[84:87], v5 offset:1024
  s_or_b32 s85, s9, 3
  s_cmp_ge_u32 s7, 6
  s_cselect_b32 s98, s93, s92
  s_add_u32 m0, s97, 73728
  s_add_u32 s98, s98, 229376
  buffer_load_dwordx4 v10, s[68:71], s98 offen lds
  buffer_load_dwordx4 v11, s[68:71], s98 offen offset:1024 lds
  s_cmp_ge_u32 s7, 6
  s_cselect_b32 s98, s93, s92
  s_add_u32 m0, s97, 81920
  s_add_u32 s98, s98, 243712
  buffer_load_dwordx4 v10, s[68:71], s98 offen lds
  buffer_load_dwordx4 v11, s[68:71], s98 offen offset:1024 lds
  s_cmp_ge_u32 s7, 5
  s_cselect_b32 s98, s93, s92
  s_add_u32 m0, s97, 90112
  s_add_u32 s98, s98, 458752
  buffer_load_dwordx4 v10, s[68:71], s98 offen lds
  buffer_load_dwordx4 v11, s[68:71], s98 offen offset:1024 lds
  s_setprio 1
  ds_read_b128 v[88:91], v5 offset:1536
  s_waitcnt lgkmcnt(3)
  v_mfma_f32_32x32x16_bf16 v[44:59], v[128:131], v[76:79], 0
  s_cmp_ge_u32 s7, 5
  s_cselect_b32 s98, s93, s92
  s_add_u32 m0, s97, 98304
  s_add_u32 s98, s98, 473088
  buffer_load_dwordx4 v10, s[68:71], s98 offen lds
  ds_read_b128 v[76:79], v5 offset:2048
  s_waitcnt lgkmcnt(3)
  v_mfma_f32_32x32x16_bf16 v[44:59], v[132:135], v[80:83], v[44:59]
  ds_read_b128 v[80:83], v5 offset:2560
  s_waitcnt lgkmcnt(3)
  v_mfma_f32_32x32x16_bf16 v[44:59], v[136:139], v[84:87], v[44:59]
  ds_read_b128 v[84:87], v5 offset:3072
  s_waitcnt lgkmcnt(3)
  v_mfma_f32_32x32x16_bf16 v[44:59], v[140:143], v[88:91], v[44:59]
  buffer_load_dwordx4 v11, s[68:71], s98 offen offset:1024 lds
  ds_read_b128 v[88:91], v5 offset:3584
  s_waitcnt lgkmcnt(3)
  v_mfma_f32_32x32x16_bf16 v[44:59], v[144:147], v[76:79], v[44:59]
  ds_read_b128 v[76:79], v5 offset:4096
  s_waitcnt lgkmcnt(3)
  v_mfma_f32_32x32x16_bf16 v[44:59], v[148:151], v[80:83], v[44:59]
  s_cmp_ge_u32 s7, 4
  s_cselect_b32 s98, s93, s92
  s_add_u32 m0, s97, 106496
  s_add_u32 s98, s98, 688128
  buffer_load_dwordx4 v10, s[68:71], s98 offen lds
  ds_read_b128 v[80:83], v5 offset:4608
  s_waitcnt lgkmcnt(3)
  v_mfma_f32_32x32x16_bf16 v[44:59], v[152:155], v[84:87], v[44:59]
  ds_read_b128 v[84:87], v5 offset:5120
  s_waitcnt lgkmcnt(3)
  v_mfma_f32_32x32x16_bf16 v[44:59], v[156:159], v[88:91], v[44:59]
  ds_read_b128 v[88:91], v5 offset:5632
  s_waitcnt lgkmcnt(3)
  v_mfma_f32_32x32x16_bf16 v[44:59], v[160:163], v[76:79], v[44:59]
  buffer_load_dwordx4 v11, s[68:71], s98 offen offset:1024 lds
  ds_read_b128 v[76:79], v5 offset:6144
  s_waitcnt lgkmcnt(3)
  v_mfma_f32_32x32x16_bf16 v[44:59], v[164:167], v[80:83], v[44:59]
  ds_read_b128 v[80:83], v5 offset:6656
  s_waitcnt lgkmcnt(3)
  v_mfma_f32_32x32x16_bf16 v[44:59], v[168:171], v[84:87], v[44:59]
  s_cmp_ge_u32 s7, 7
  s_cselect_b32 s98, s93, s92
  s_add_u32 m0, s97, 114688
  s_add_u32 s98, s98, 114688
  buffer_load_dwordx4 v10, s[68:71], s98 offen lds
  ds_read_b128 v[84:87], v5 offset:7168
  s_waitcnt lgkmcnt(3)
  v_mfma_f32_32x32x16_bf16 v[44:59], v[172:175], v[88:91], v[44:59]
  ds_read_b128 v[88:91], v5 offset:7680
  s_waitcnt lgkmcnt(3)
  v_mfma_f32_32x32x16_bf16 v[44:59], v[176:179], v[76:79], v[44:59]
  ds_read_b128 v[76:79], v5 offset:8192
  s_waitcnt lgkmcnt(3)
  v_mfma_f32_32x32x16_bf16 v[44:59], v[180:183], v[80:83], v[44:59]
  buffer_load_dwordx4 v11, s[68:71], s98 offen offset:1024 lds
  ds_read_b128 v[80:83], v5 offset:8704
  s_waitcnt lgkmcnt(3)
  v_mfma_f32_32x32x16_bf16 v[44:59], v[184:187], v[84:87], v[44:59]
  ds_read_b128 v[84:87], v5 offset:9216
  s_waitcnt lgkmcnt(3)
  v_mfma_f32_32x32x16_bf16 v[44:59], v[188:191], v[88:91], v[44:59]
  s_cmp_ge_u32 s7, 7
  s_cselect_b32 s98, s93, s92
  s_add_u32 m0, s97, 122880
  s_add_u32 s98, s98, 129024
  buffer_load_dwordx4 v10, s[68:71], s98 offen lds
  ds_read_b128 v[88:91], v5 offset:9728
  s_waitcnt lgkmcnt(3)
  v_mfma_f32_32x32x16_bf16 v[44:59], v[192:195], v[76:79], v[44:59]
  ds_read_b128 v[76:79], v5 offset:10240
  s_waitcnt lgkmcnt(3)
  v_mfma_f32_32x32x16_bf16 v[44:59], v[196:199], v[80:83], v[44:59]
  ds_read_b128 v[80:83], v5 offset:10752
  s_waitcnt lgkmcnt(3)
  v_mfma_f32_32x32x16_bf16 v[44:59], v[200:203], v[84:87], v[44:59]
  buffer_load_dwordx4 v11, s[68:71], s98 offen offset:1024 lds
  ds_read_b128 v[84:87], v5 offset:11264
  s_waitcnt lgkmcnt(3)
  v_mfma_f32_32x32x16_bf16 v[44:59], v[204:207], v[88:91], v[44:59]
  ds_read_b128 v[88:91], v5 offset:11776
  s_waitcnt lgkmcnt(3)
  v_mfma_f32_32x32x16_bf16 v[44:59], v[208:211], v[76:79], v[44:59]
  s_cmp_ge_u32 s7, 6
  s_cselect_b32 s98, s93, s92
  s_add_u32 m0, s97, 131072
  s_add_u32 s98, s98, 344064
  buffer_load_dwordx4 v10, s[68:71], s98 offen lds
  ds_read_b128 v[76:79], v5 offset:12288
  s_waitcnt lgkmcnt(3)
  v_mfma_f32_32x32x16_bf16 v[44:59], v[212:215], v[80:83], v[44:59]
  ds_read_b128 v[80:83], v5 offset:12800
  s_waitcnt lgkmcnt(3)
  v_mfma_f32_32x32x16_bf16 v[44:59], v[216:219], v[84:87], v[44:59]
  ds_read_b32 v24, v26
  ds_read_b128 v[84:87], v5 offset:13312
  s_waitcnt lgkmcnt(4)
  v_mfma_f32_32x32x16_bf16 v[44:59], v[220:223], v[88:91], v[44:59]
  buffer_load_dwordx4 v11, s[68:71], s98 offen offset:1024 lds
  ds_read_b128 v[88:91], v5 offset:13824
  s_waitcnt lgkmcnt(4)
  v_mfma_f32_32x32x16_bf16 v[44:59], v[224:227], v[76:79], v[44:59]
  v_cndmask_b32 v25, 8, 0, s[0:1]
  s_waitcnt lgkmcnt(2)
  v_cmp_gt_u32 vcc, v25, v24
  s_nop 0
  s_cbranch_vccnz Llrg_78
Lldg_77:
  ds_read_b128 v[76:79], v6 offset:0
  v_mfma_f32_32x32x16_bf16 v[44:59], v[228:231], v[80:83], v[44:59]
  s_cmp_ge_u32 s7, 6
  s_cselect_b32 s98, s93, s92
  s_add_u32 m0, s97, 139264
  s_add_u32 s98, s98, 358400
  buffer_load_dwordx4 v10, s[68:71], s98 offen lds
  ds_read_b128 v[28:31], v6 offset:16
  ds_read_b128 v[32:35], v6 offset:1040
  ds_read_b128 v[80:83], v5 offset:28672
  s_waitcnt lgkmcnt(5)
  v_mfma_f32_32x32x16_bf16 v[44:59], v[232:235], v[84:87], v[44:59]
  ds_read_b128 v[84:87], v5 offset:29184
  s_waitcnt lgkmcnt(5)
  v_mfma_f32_32x32x16_bf16 v[44:59], v[236:239], v[88:91], v[44:59]
  ds_read_b128 v[88:91], v5 offset:29696
  s_waitcnt lgkmcnt(5)
  v_mfma_f32_32x32x16_bf16 v[44:59], v[36:39], v[76:79], v[44:59]
  buffer_load_dwordx4 v11, s[68:71], s98 offen offset:1024 lds
  buffer_load_dword v8, v12, s[76:79], 0 offen sc1
  ds_read_b128 v[76:79], v5 offset:30208
  s_waitcnt lgkmcnt(3)
  v_mfma_f32_32x32x16_bf16 v[60:75], v[128:131], v[80:83], 0
  s_waitcnt vmcnt(9)
  v_mov_b32 v23, 9
  ds_write_b32 v0, v23
  s_setprio 2
  s_cmp_ge_u32 s7, 5
  s_cselect_b32 s98, s93, s92
  s_add_u32 m0, s97, 147456
  s_add_u32 s98, s98, 573440
  buffer_load_dwordx4 v10, s[68:71], s98 offen lds
  ds_read_b32 v24, v26
  buffer_load_dwordx4 v11, s[68:71], s98 offen offset:1024 lds
  v_mul_f32 v92, v44, v44
  v_mul_f32 v93, v45, v45
  v_mul_f32 v94, v46, v46
  v_mul_f32 v95, v47, v47
  v_cndmask_b32 v25, 9, 6, s[0:1]
  s_waitcnt lgkmcnt(0)
  v_cmp_gt_u32 vcc, v25, v24
  s_nop 0
  s_cbranch_vccnz Llrg_80
Lldg_79:
  s_cmp_ge_u32 s7, 5
  s_cselect_b32 s98, s93, s92
  s_add_u32 m0, s97, 0
  s_add_u32 s98, s98, 587776
  buffer_load_dwordx4 v10, s[68:71], s98 offen lds
  v_mul_f32 v96, v48, v48
  v_mul_f32 v97, v49, v49
  v_mul_f32 v98, v50, v50
  v_mul_f32 v99, v51, v51
  v_fma_f32 v92, v92, v29, v28
  v_fma_f32 v93, v93, v29, v28
  v_fma_f32 v94, v94, v29, v28
  v_fma_f32 v95, v95, v29, v28
  buffer_load_dwordx4 v11, s[68:71], s98 offen offset:1024 lds
  v_fma_f32 v96, v96, v29, v28
  v_fma_f32 v97, v97, v29, v28
  v_fma_f32 v98, v98, v29, v28
  v_fma_f32 v99, v99, v29, v28
  v_mul_f32 v92, v92, v44
  v_mul_f32 v93, v93, v45
  v_mul_f32 v94, v94, v46
  v_mul_f32 v95, v95, v47
  v_mul_f32 v96, v96, v48
  v_mul_f32 v97, v97, v49
  s_cmp_ge_u32 s7, 4
  s_cselect_b32 s98, s93, s92
  s_add_u32 m0, s97, 8192
  s_add_u32 s98, s98, 802816
  buffer_load_dwordx4 v10, s[68:71], s98 offen lds
  v_mul_f32 v98, v98, v50
  v_mul_f32 v99, v99, v51
  v_exp_f32 v92, v92
  v_exp_f32 v93, v93
  v_exp_f32 v94, v94
  v_exp_f32 v95, v95
  v_exp_f32 v96, v96
  v_exp_f32 v97, v97
  buffer_load_dwordx4 v11, s[68:71], s98 offen offset:1024 lds
  v_exp_f32 v98, v98
  v_exp_f32 v99, v99
  v_fma_f32 v92, v92, v30, v30
  v_fma_f32 v93, v93, v30, v30
  v_fma_f32 v94, v94, v30, v30
  v_fma_f32 v95, v95, v30, v30
  v_fma_f32 v96, v96, v30, v30
  v_fma_f32 v97, v97, v30, v30
  v_fma_f32 v98, v98, v30, v30
  v_fma_f32 v99, v99, v30, v30
  s_cmp_ge_u32 s7, 4
  s_cselect_b32 s98, s93, s92
  s_add_u32 m0, s97, 16384
  s_add_u32 s98, s98, 817152
  buffer_load_dwordx4 v10, s[68:71], s98 offen lds
  v_rcp_f32 v92, v92
  v_rcp_f32 v93, v93
  v_rcp_f32 v94, v94
  v_rcp_f32 v95, v95
  v_rcp_f32 v96, v96
  v_rcp_f32 v97, v97
  v_rcp_f32 v98, v98
  v_rcp_f32 v99, v99
  buffer_load_dwordx4 v11, s[68:71], s98 offen offset:1024 lds
  v_mul_f32 v44, v44, v92
  v_mul_f32 v45, v45, v93
  v_mul_f32 v46, v46, v94
  v_mul_f32 v47, v47, v95
  v_mul_f32 v48, v48, v96
  v_mul_f32 v49, v49, v97
  s_waitcnt vmcnt(8)
  v_cmp_ne_u32 vcc, s85, v8
  s_nop 0
  s_cbranch_vccnz Lprxd_82
Lpdxd_81:
  v_mul_f32 v50, v50, v98
  v_mul_f32 v51, v51, v99
  v_cvt_pk_bf16_f32 v100, v44, v45
  v_cvt_pk_bf16_f32 v101, v46, v47
  v_cvt_pk_bf16_f32 v102, v48, v49
  v_cvt_pk_bf16_f32 v103, v50, v51
  s_cmp_lg_u32 s10, 0
  s_cbranch_scc1 Lslow_83
  buffer_store_dwordx4 v[100:103], v7, s[76:79], s94 offen offset:0
Lback_84:
  v_mul_f32 v92, v52, v52
  v_mul_f32 v93, v53, v53
  v_mul_f32 v94, v54, v54
  v_mul_f32 v95, v55, v55
  v_mul_f32 v96, v56, v56
  v_mul_f32 v97, v57, v57
  v_mul_f32 v98, v58, v58
  v_mul_f32 v99, v59, v59
  v_fma_f32 v92, v92, v29, v28
  v_fma_f32 v93, v93, v29, v28
  v_fma_f32 v94, v94, v29, v28
  v_fma_f32 v95, v95, v29, v28
  v_fma_f32 v96, v96, v29, v28
  v_fma_f32 v97, v97, v29, v28
  v_fma_f32 v98, v98, v29, v28
  v_fma_f32 v99, v99, v29, v28
  v_mul_f32 v92, v92, v52
  v_mul_f32 v93, v93, v53
  v_mul_f32 v94, v94, v54
  v_mul_f32 v95, v95, v55
  v_mul_f32 v96, v96, v56
  v_mul_f32 v97, v97, v57
  v_mul_f32 v98, v98, v58
  v_mul_f32 v99, v99, v59
  v_exp_f32 v92, v92
  v_exp_f32 v93, v93
  v_exp_f32 v94, v94
  v_exp_f32 v95, v95
  v_exp_f32 v96, v96
  v_exp_f32 v97, v97
  v_exp_f32 v98, v98
  v_exp_f32 v99, v99
  v_fma_f32 v92, v92, v30, v30
  v_fma_f32 v93, v93, v30, v30
  v_fma_f32 v94, v94, v30, v30
  v_fma_f32 v95, v95, v30, v30
  v_fma_f32 v96, v96, v30, v30
  v_fma_f32 v97, v97, v30, v30
  v_fma_f32 v98, v98, v30, v30
  v_fma_f32 v99, v99, v30, v30
  v_rcp_f32 v92, v92
  v_rcp_f32 v93, v93
  v_rcp_f32 v94, v94
  v_rcp_f32 v95, v95
  v_rcp_f32 v96, v96
  v_rcp_f32 v97, v97
  v_rcp_f32 v98, v98
  v_rcp_f32 v99, v99
  v_mul_f32 v52, v52, v92
  v_mul_f32 v53, v53, v93
  v_mul_f32 v54, v54, v94
  v_mul_f32 v55, v55, v95
  v_mul_f32 v56, v56, v96
  v_mul_f32 v57, v57, v97
  v_mul_f32 v58, v58, v98
  v_mul_f32 v59, v59, v99
  v_cvt_pk_bf16_f32 v104, v52, v53
  v_cvt_pk_bf16_f32 v105, v54, v55
  v_cvt_pk_bf16_f32 v106, v56, v57
  v_cvt_pk_bf16_f32 v107, v58, v59
  s_cmp_lg_u32 s10, 0
  s_cbranch_scc1 Lslow_85
  buffer_store_dwordx4 v[104:107], v7, s[76:79], s94 offen offset:1024
Lback_86:
  s_setprio 1
  ds_read_b128 v[80:83], v5 offset:30720
  v_mfma_f32_32x32x16_bf16 v[60:75], v[132:135], v[84:87], v[60:75]
  ds_read_b128 v[84:87], v5 offset:31232
  v_mfma_f32_32x32x16_bf16 v[60:75], v[136:139], v[88:91], v[60:75]
  ds_read_b64_tr_b16 v[128:129], v18 offset:0
  ds_read_b64_tr_b16 v[130:131], v18 offset:1024
  ds_read_b128 v[88:91], v5 offset:31744
  v_mfma_f32_32x32x16_bf16 v[60:75], v[140:143], v[76:79], v[60:75]
  ds_read_b64_tr_b16 v[132:133], v19 offset:0
  ds_read_b64_tr_b16 v[134:135], v19 offset:1024
  ds_read_b128 v[76:79], v5 offset:32256
  s_waitcnt lgkmcnt(7)
  v_mfma_f32_32x32x16_bf16 v[60:75], v[144:147], v[80:83], v[60:75]
  ds_read_b64_tr_b16 v[136:137], v18 offset:8192
  ds_read_b128 v[80:83], v5 offset:32768
  s_waitcnt lgkmcnt(8)
  v_mfma_f32_32x32x16_bf16 v[60:75], v[148:151], v[84:87], v[60:75]
  ds_read_b64_tr_b16 v[138:139], v18 offset:9216
  ds_read_b64_tr_b16 v[140:141], v19 offset:8192
  ds_read_b128 v[84:87], v5 offset:33280
  s_waitcnt lgkmcnt(8)
  v_mfma_f32_32x32x16_bf16 v[60:75], v[152:155], v[88:91], v[60:75]
  ds_read_b64_tr_b16 v[142:143], v19 offset:9216
  s_waitcnt vmcnt(0)
  s_cmp_lg_u32 s10, 0
  s_cbranch_scc1 Lslow_87
  buffer_store_dword v27, v9, s[76:79], 0 offen offset:384
Lback_88:
  ds_read_b128 v[88:91], v5 offset:33792
  s_waitcnt lgkmcnt(7)
  v_mfma_f32_32x32x16_bf16 v[60:75], v[156:159], v[76:79], v[60:75]
  ds_read_b64_tr_b16 v[144:145], v18 offset:16384
  ds_read_b64_tr_b16 v[146:147], v18 offset:17408
  ds_read_b128 v[76:79], v5 offset:34304
  s_waitcnt lgkmcnt(8)
  v_mfma_f32_32x32x16_bf16 v[60:75], v[160:163], v[80:83], v[60:75]
  ds_read_b64_tr_b16 v[148:149], v19 offset:16384
  ds_read_b64_tr_b16 v[150:151], v19 offset:17408
  ds_read_b128 v[80:83], v5 offset:34816
  s_waitcnt lgkmcnt(8)
  v_mfma_f32_32x32x16_bf16 v[60:75], v[164:167], v[84:87], v[60:75]
  ds_read_b64_tr_b16 v[152:153], v18 offset:24576
  ds_read_b128 v[84:87], v5 offset:35328
  s_waitcnt lgkmcnt(8)
  v_mfma_f32_32x32x16_bf16 v[60:75], v[168:171], v[88:91], v[60:75]
  ds_read_b64_tr_b16 v[154:155], v18 offset:25600
  ds_read_b64_tr_b16 v[156:157], v19 offset:24576
  ds_read_b128 v[88:91], v5 offset:35840
  s_waitcnt lgkmcnt(8)
  v_mfma_f32_32x32x16_bf16 v[60:75], v[172:175], v[76:79], v[60:75]
  ds_read_b64_tr_b16 v[158:159], v19 offset:25600
  ds_read_b128 v[76:79], v5 offset:36352
  s_waitcnt lgkmcnt(7)
  v_mfma_f32_32x32x16_bf16 v[60:75], v[176:179], v[80:83], v[60:75]
  ds_read_b64_tr_b16 v[160:161], v18 offset:32768
  ds_read_b64_tr_b16 v[162:163], v18 offset:33792
  ds_read_b128 v[80:83], v5 offset:36864
  s_waitcnt lgkmcnt(8)
  v_mfma_f32_32x32x16_bf16 v[60:75], v[180:183], v[84:87], v[60:75]
  ds_read_b64_tr_b16 v[164:165], v19 offset:32768
  ds_read_b64_tr_b16 v[166:167], v19 offset:33792
  ds_read_b128 v[84:87], v5 offset:37376
  s_waitcnt lgkmcnt(8)
  v_mfma_f32_32x32x16_bf16 v[60:75], v[184:187], v[88:91], v[60:75]
  ds_read_b64_tr_b16 v[168:169], v108 offset:0
  ds_read_b128 v[88:91], v5 offset:37888
  s_waitcnt lgkmcnt(8)
  v_mfma_f32_32x32x16_bf16 v[60:75], v[188:191], v[76:79], v[60:75]
  ds_read_b64_tr_b16 v[170:171], v108 offset:1024
  ds_read_b64_tr_b16 v[172:173], v109 offset:0
  ds_read_b128 v[76:79], v5 offset:38400
  s_waitcnt lgkmcnt(8)
  v_mfma_f32_32x32x16_bf16 v[60:75], v[192:195], v[80:83], v[60:75]
  ds_read_b64_tr_b16 v[174:175], v109 offset:1024
  ds_read_b128 v[80:83], v5 offset:38912
  s_waitcnt lgkmcnt(7)
  v_mfma_f32_32x32x16_bf16 v[60:75], v[196:199], v[84:87], v[60:75]
  ds_read_b64_tr_b16 v[176:177], v108 offset:8192
  ds_read_b64_tr_b16 v[178:179], v108 offset:9216
  ds_read_b128 v[84:87], v5 offset:39424
  s_waitcnt lgkmcnt(8)
  v_mfma_f32_32x32x16_bf16 v[60:75], v[200:203], v[88:91], v[60:75]
  ds_read_b64_tr_b16 v[180:181], v109 offset:8192
  ds_read_b64_tr_b16 v[182:183], v109 offset:9216
  ds_read_b128 v[88:91], v5 offset:39936
  s_waitcnt lgkmcnt(8)
  v_mfma_f32_32x32x16_bf16 v[60:75], v[204:207], v[76:79], v[60:75]
  ds_read_b64_tr_b16 v[184:185], v108 offset:16384
  ds_read_b128 v[76:79], v5 offset:40448
  s_waitcnt lgkmcnt(8)
  v_mfma_f32_32x32x16_bf16 v[60:75], v[208:211], v[80:83], v[60:75]
  ds_read_b64_tr_b16 v[186:187], v108 offset:17408
  ds_read_b64_tr_b16 v[188:189], v109 offset:16384
  ds_read_b128 v[80:83], v5 offset:40960
  s_waitcnt lgkmcnt(8)
  v_mfma_f32_32x32x16_bf16 v[60:75], v[212:215], v[84:87], v[60:75]
  ds_read_b64_tr_b16 v[190:191], v109 offset:17408
  ds_read_b128 v[84:87], v5 offset:41472
  s_waitcnt lgkmcnt(7)
  v_mfma_f32_32x32x16_bf16 v[60:75], v[216:219], v[88:91], v[60:75]
  ds_read_b128 v[88:91], v5 offset:41984
  s_waitcnt lgkmcnt(6)
  v_mfma_f32_32x32x16_bf16 v[60:75], v[220:223], v[76:79], v[60:75]
  ds_read_b128 v[76:79], v5 offset:42496
  s_waitcnt lgkmcnt(4)
  v_mfma_f32_32x32x16_bf16 v[60:75], v[224:227], v[80:83], v[60:75]
  ds_read_b128 v[80:83], v6 offset:1024
  s_waitcnt lgkmcnt(3)
  v_mfma_f32_32x32x16_bf16 v[60:75], v[228:231], v[84:87], v[60:75]
  s_waitcnt lgkmcnt(2)
  v_mfma_f32_32x32x16_bf16 v[60:75], v[232:235], v[88:91], v[60:75]
  s_waitcnt lgkmcnt(1)
  v_mfma_f32_32x32x16_bf16 v[60:75], v[236:239], v[76:79], v[60:75]
  s_waitcnt lgkmcnt(0)
  v_mfma_f32_32x32x16_bf16 v[60:75], v[36:39], v[80:83], v[60:75]
  buffer_load_dword v16, v12, s[76:79], 0 offen offset:384 sc1
  v_mov_b32 v23, 10
  ds_write_b32 v0, v23
  s_setprio 2
  s_nop 7
  v_mul_f32 v92, v60, v60
  v_mul_f32 v93, v61, v61
  v_mul_f32 v94, v62, v62
  v_mul_f32 v95, v63, v63
  s_waitcnt vmcnt(0)
  v_cmp_ne_u32 vcc, s9, v16
  s_nop 0
  s_cbranch_vccnz Lprn0_90
Lpdn0_89:
  s_cmp_ge_u32 s7, 6
  s_cselect_b32 s13, s95, s94
  s_add_u32 s13, s13, 8192
  buffer_load_dwordx4 v[208:211], v7, s[76:79], s13 offen offset:0 sc1
  v_mul_f32 v96, v64, v64
  v_mul_f32 v97, v65, v65
  v_mul_f32 v98, v66, v66
  v_mul_f32 v99, v67, v67
  v_fma_f32 v92, v92, v33, v32
  v_fma_f32 v93, v93, v33, v32
  v_fma_f32 v94, v94, v33, v32
  v_fma_f32 v95, v95, v33, v32
  v_fma_f32 v96, v96, v33, v32
  v_fma_f32 v97, v97, v33, v32
  buffer_load_dwordx4 v[212:215], v7, s[76:79], s13 offen offset:1024 sc1
  v_fma_f32 v98, v98, v33, v32
  v_fma_f32 v99, v99, v33, v32
  v_mul_f32 v92, v92, v60
  v_mul_f32 v93, v93, v61
  v_mul_f32 v94, v94, v62
  v_mul_f32 v95, v95, v63
  v_mul_f32 v96, v96, v64
  v_mul_f32 v97, v97, v65
  v_mul_f32 v98, v98, v66
  v_mul_f32 v99, v99, v67
  s_cmp_ge_u32 s7, 5
  s_cselect_b32 s13, s95, s94
  s_add_u32 s13, s13, 16384
  buffer_load_dwordx4 v[216:219], v7, s[76:79], s13 offen offset:0 sc1
  v_exp_f32 v92, v92
  v_exp_f32 v93, v93
  v_exp_f32 v94, v94
  v_exp_f32 v95, v95
  v_exp_f32 v96, v96
  v_exp_f32 v97, v97
  v_exp_f32 v98, v98
  v_exp_f32 v99, v99
  v_fma_f32 v92, v92, v34, v34
  v_fma_f32 v93, v93, v34, v34
  buffer_load_dwordx4 v[220:223], v7, s[76:79], s13 offen offset:1024 sc1
  v_fma_f32 v94, v94, v34, v34
  v_fma_f32 v95, v95, v34, v34
  v_fma_f32 v96, v96, v34, v34
  v_fma_f32 v97, v97, v34, v34
  v_fma_f32 v98, v98, v34, v34
  v_fma_f32 v99, v99, v34, v34
  v_rcp_f32 v92, v92
  v_rcp_f32 v93, v93
  v_rcp_f32 v94, v94
  v_rcp_f32 v95, v95
  s_cmp_ge_u32 s7, 3
  s_cselect_b32 s98, s93, s92
  s_add_u32 m0, s97, 114688
  s_add_u32 s98, s98, 1032192
  buffer_load_dwordx4 v10, s[68:71], s98 offen lds
  s_cmp_ge_u32 s7, 4
  s_cselect_b32 s13, s95, s94
  s_add_u32 s13, s13, 24576
  buffer_load_dwordx4 v[224:227], v7, s[76:79], s13 offen offset:0 sc1
  v_rcp_f32 v96, v96
  v_rcp_f32 v97, v97
  v_rcp_f32 v98, v98
  v_rcp_f32 v99, v99
  v_mul_f32 v60, v60, v92
  v_mul_f32 v61, v61, v93
  v_mul_f32 v62, v62, v94
  v_mul_f32 v63, v63, v95
  buffer_load_dwordx4 v11, s[68:71], s98 offen offset:1024 lds
  v_mul_f32 v64, v64, v96
  v_mul_f32 v65, v65, v97
  buffer_load_dwordx4 v[228:231], v7, s[76:79], s13 offen offset:1024 sc1
  v_mul_f32 v66, v66, v98
  v_mul_f32 v67, v67, v99
  v_cvt_pk_bf16_f32 v76, v60, v61
  v_cvt_pk_bf16_f32 v77, v62, v63
  v_cvt_pk_bf16_f32 v78, v64, v65
  v_cvt_pk_bf16_f32 v79, v66, v67
  s_cmp_lg_u32 s10, 0
  s_cbranch_scc1 Lslow_91
  buffer_store_dwordx4 v[76:79], v7, s[76:79], s94 offen offset:2048
Lback_92:
  v_mul_f32 v92, v68, v68
  v_mul_f32 v93, v69, v69
  v_mul_f32 v94, v70, v70
  s_cmp_ge_u32 s7, 3
  s_cselect_b32 s13, s95, s94
  s_add_u32 s13, s13, 32768
  buffer_load_dwordx4 v[232:235], v7, s[76:79], s13 offen offset:0 sc1
  v_mul_f32 v95, v71, v71
  v_mul_f32 v96, v72, v72
  v_mul_f32 v97, v73, v73
  v_mul_f32 v98, v74, v74
  v_mul_f32 v99, v75, v75
  v_fma_f32 v92, v92, v33, v32
  v_fma_f32 v93, v93, v33, v32
  v_fma_f32 v94, v94, v33, v32
  s_cmp_ge_u32 s7, 3
  s_cselect_b32 s98, s93, s92
  s_add_u32 m0, s97, 122880
  s_add_u32 s98, s98, 1046528
  buffer_load_dwordx4 v10, s[68:71], s98 offen lds
  v_fma_f32 v95, v95, v33, v32
  v_fma_f32 v96, v96, v33, v32
  buffer_load_dwordx4 v[236:239], v7, s[76:79], s13 offen offset:1024 sc1
  v_fma_f32 v97, v97, v33, v32
  v_fma_f32 v98, v98, v33, v32
  v_fma_f32 v99, v99, v33, v32
  v_mul_f32 v92, v92, v68
  v_mul_f32 v93, v93, v69
  v_mul_f32 v94, v94, v70
  buffer_load_dwordx4 v11, s[68:71], s98 offen offset:1024 lds
  v_mul_f32 v95, v95, v71
  v_mul_f32 v96, v96, v72
  v_mul_f32 v97, v97, v73
  v_mul_f32 v98, v98, v74
  s_cmp_ge_u32 s7, 2
  s_cselect_b32 s13, s95, s94
  s_add_u32 s13, s13, 40960
  buffer_load_dwordx4 v[36:39], v7, s[76:79], s13 offen offset:0 sc1
  v_mul_f32 v99, v99, v75
  v_exp_f32 v92, v92
  v_exp_f32 v93, v93
  v_exp_f32 v94, v94
  v_exp_f32 v95, v95
  v_exp_f32 v96, v96
  v_exp_f32 v97, v97
  v_exp_f32 v98, v98
  v_exp_f32 v99, v99
  v_fma_f32 v92, v92, v34, v34
  buffer_load_dwordx4 v[40:43], v7, s[76:79], s13 offen offset:1024 sc1
  v_fma_f32 v93, v93, v34, v34
  v_fma_f32 v94, v94, v34, v34
  v_fma_f32 v95, v95, v34, v34
  v_fma_f32 v96, v96, v34, v34
  v_fma_f32 v97, v97, v34, v34
  v_fma_f32 v98, v98, v34, v34
  s_cmp_ge_u32 s7, 2
  s_cselect_b32 s98, s93, s92
  s_add_u32 m0, s97, 131072
  s_add_u32 s98, s98, 1261568
  buffer_load_dwordx4 v10, s[68:71], s98 offen lds
  v_fma_f32 v99, v99, v34, v34
  v_rcp_f32 v92, v92
  v_rcp_f32 v93, v93
  v_rcp_f32 v94, v94
  s_cmp_ge_u32 s7, 1
  s_cselect_b32 s13, s95, s94
  s_add_u32 s13, s13, 49152
  buffer_load_dwordx4 v[84:87], v7, s[76:79], s13 offen offset:0 sc1
  v_rcp_f32 v95, v95
  v_rcp_f32 v96, v96
  v_rcp_f32 v97, v97
  v_rcp_f32 v98, v98
  buffer_load_dwordx4 v11, s[68:71], s98 offen offset:1024 lds
  v_rcp_f32 v99, v99
  v_mul_f32 v68, v68, v92
  v_mul_f32 v69, v69, v93
  v_mul_f32 v70, v70, v94
  v_mul_f32 v71, v71, v95
  v_mul_f32 v72, v72, v96
  buffer_load_dwordx4 v[88:91], v7, s[76:79], s13 offen offset:1024 sc1
  v_mul_f32 v73, v73, v97
  v_mul_f32 v74, v74, v98
  v_mul_f32 v75, v75, v99
  v_cvt_pk_bf16_f32 v80, v68, v69
  v_cvt_pk_bf16_f32 v81, v70, v71
  v_cvt_pk_bf16_f32 v82, v72, v73
  v_cvt_pk_bf16_f32 v83, v74, v75
  s_cmp_lg_u32 s10, 0
  s_cbranch_scc1 Lslow_93
  buffer_store_dwordx4 v[80:83], v7, s[76:79], s94 offen offset:3072
Lback_94:
  s_setprio 1
  v_mfma_f32_32x32x16_bf16 v[44:59], v[128:131], v[100:103], 0
  v_mfma_f32_32x32x16_bf16 v[112:127], v[132:135], v[100:103], 0
  s_cmp_ge_u32 s7, 2
  s_cselect_b32 s98, s93, s92
  s_add_u32 m0, s97, 139264
  s_add_u32 s98, s98, 1275904
  buffer_load_dwordx4 v10, s[68:71], s98 offen lds
  ds_read_b32 v24, v26
  s_add_u32 s12, s97, 40960
  v_and_b32 v15, 7, v2
  v_xor_b32 v15, v15, v3
  v_lshlrev_b32 v15, 4, v15
  v_lshl_add_u32 v15, v2, 7, v15
  v_add_u32 v15, s12, v15
  v_xor_b32 v17, 64, v15
  v_mfma_f32_32x32x16_bf16 v[44:59], v[136:139], v[104:107], v[44:59]
  v_mfma_f32_32x32x16_bf16 v[112:127], v[140:143], v[104:107], v[112:127]
  buffer_load_dwordx4 v11, s[68:71], s98 offen offset:1024 lds
  v_mfma_f32_32x32x16_bf16 v[60:75], v[128:131], v[76:79], 0
  v_cndmask_b32 v25, 10, 7, s[0:1]
  s_waitcnt lgkmcnt(0)
  v_cmp_gt_u32 vcc, v25, v24
  s_nop 0
  s_cbranch_vccnz Llrg_96
Lldg_95:
  v_mfma_f32_32x32x16_bf16 v[92:107], v[132:135], v[76:79], 0
  ds_write_b128 v15, v[240:243] offset:0
  v_mfma_f32_32x32x16_bf16 v[60:75], v[136:139], v[80:83], v[60:75]
  v_mfma_f32_32x32x16_bf16 v[92:107], v[140:143], v[80:83], v[92:107]
  ds_write_b128 v17, v[244:247] offset:0
  s_waitcnt vmcnt(21)
  v_mfma_f32_32x32x16_bf16 v[44:59], v[144:147], v[208:211], v[44:59]
  s_cmp_ge_u32 s7, 1
  s_cselect_b32 s98, s93, s92
  s_add_u32 m0, s97, 147456
  s_add_u32 s98, s98, 1490944
  buffer_load_dwordx4 v10, s[68:71], s98 offen lds
  v_mfma_f32_32x32x16_bf16 v[112:127], v[148:151], v[208:211], v[112:127]
  ds_write_b128 v15, v[248:251] offset:8192
  s_waitcnt vmcnt(21)
  v_mfma_f32_32x32x16_bf16 v[44:59], v[152:155], v[212:215], v[44:59]
  s_waitcnt vmcnt(16)
  ds_read_b64_tr_b16 v[192:193], v18 offset:0
  ds_read_b64_tr_b16 v[194:195], v18 offset:1024
  ds_read_b64_tr_b16 v[196:197], v19 offset:0
  ds_read_b64_tr_b16 v[198:199], v19 offset:1024
  buffer_load_dwordx4 v11, s[68:71], s98 offen offset:1024 lds
  v_mfma_f32_32x32x16_bf16 v[112:127], v[156:159], v[212:215], v[112:127]
  ds_write_b128 v17, v[252:255] offset:8192
  v_mfma_f32_32x32x16_bf16 v[44:59], v[160:163], v[216:219], v[44:59]
  s_waitcnt vmcnt(4)
  s_cmp_lg_u32 s10, 0
  s_cbranch_scc1 Lslow_97
  buffer_store_dword v27, v9, s[76:79], 0 offen offset:640
Lback_98:
  v_mfma_f32_32x32x16_bf16 v[112:127], v[164:167], v[216:219], v[112:127]
  v_mov_b32 v23, 11
  ds_write_b32 v0, v23
  v_mfma_f32_32x32x16_bf16 v[44:59], v[168:171], v[220:223], v[44:59]
  v_mfma_f32_32x32x16_bf16 v[112:127], v[172:175], v[220:223], v[112:127]
  s_cmp_ge_u32 s7, 1
  s_cselect_b32 s98, s93, s92
  s_add_u32 m0, s97, 0
  s_add_u32 s98, s98, 1505280
  buffer_load_dwordx4 v10, s[68:71], s98 offen lds
  v_mfma_f32_32x32x16_bf16 v[44:59], v[176:179], v[224:227], v[44:59]
  v_mfma_f32_32x32x16_bf16 v[112:127], v[180:183], v[224:227], v[112:127]
  ds_read_b64_tr_b16 v[200:201], v18 offset:8192
  ds_read_b64_tr_b16 v[202:203], v18 offset:9216
  ds_read_b64_tr_b16 v[204:205], v19 offset:8192
  ds_read_b64_tr_b16 v[206:207], v19 offset:9216
  buffer_load_dwordx4 v11, s[68:71], s98 offen offset:1024 lds
  v_mfma_f32_32x32x16_bf16 v[44:59], v[184:187], v[228:231], v[44:59]
  v_mfma_f32_32x32x16_bf16 v[112:127], v[188:191], v[228:231], v[112:127]
  buffer_load_dword v16, v12, s[76:79], 0 offen offset:640 sc1
  s_waitcnt lgkmcnt(8)
  v_mfma_f32_32x32x16_bf16 v[44:59], v[192:195], v[232:235], v[44:59]
  s_waitcnt lgkmcnt(6)
  v_mfma_f32_32x32x16_bf16 v[112:127], v[196:199], v[232:235], v[112:127]
  ds_read_b64_tr_b16 v[208:209], v18 offset:16384
  ds_read_b64_tr_b16 v[210:211], v18 offset:17408
  ds_read_b64_tr_b16 v[212:213], v19 offset:16384
  ds_read_b64_tr_b16 v[214:215], v19 offset:17408
  s_waitcnt lgkmcnt(6)
  v_mfma_f32_32x32x16_bf16 v[44:59], v[200:203], v[236:239], v[44:59]
  s_waitcnt lgkmcnt(4)
  v_mfma_f32_32x32x16_bf16 v[112:127], v[204:207], v[236:239], v[112:127]
  s_waitcnt vmcnt(6)
  ds_read_b64_tr_b16 v[216:217], v18 offset:24576
  ds_read_b64_tr_b16 v[218:219], v18 offset:25600
  ds_read_b64_tr_b16 v[220:221], v19 offset:24576
  ds_read_b64_tr_b16 v[222:223], v19 offset:25600
  s_waitcnt lgkmcnt(6)
  v_mfma_f32_32x32x16_bf16 v[44:59], v[208:211], v[36:39], v[44:59]
  s_waitcnt lgkmcnt(4)
  v_mfma_f32_32x32x16_bf16 v[112:127], v[212:215], v[36:39], v[112:127]
  s_waitcnt vmcnt(4)
  ds_read_b64_tr_b16 v[224:225], v18 offset:32768
  ds_read_b64_tr_b16 v[226:227], v18 offset:33792
  ds_read_b64_tr_b16 v[228:229], v19 offset:32768
  ds_read_b64_tr_b16 v[230:231], v19 offset:33792
  s_waitcnt lgkmcnt(6)
  v_mfma_f32_32x32x16_bf16 v[44:59], v[216:219], v[40:43], v[44:59]
  s_waitcnt lgkmcnt(4)
  v_mfma_f32_32x32x16_bf16 v[112:127], v[220:223], v[40:43], v[112:127]
  s_waitcnt vmcnt(1)
  ds_read_b64_tr_b16 v[232:233], v108 offset:0
  ds_read_b64_tr_b16 v[234:235], v108 offset:1024
  ds_read_b64_tr_b16 v[236:237], v109 offset:0
  ds_read_b64_tr_b16 v[238:239], v109 offset:1024
  v_mov_b32 v23, 12
  ds_write_b32 v0, v23
  s_lshl_b32 s12, s84, 12
  s_add_u32 s12, s12, 90112
  v_and_b32 v109, 7, v1
  v_lshrrev_b32 v110, 5, v1
  v_xor_b32 v109, v109, v110
  v_and_b32 v108, 31, v1
  v_lshlrev_b32 v108, 7, v108
  v_lshl_add_u32 v108, v109, 4, v108
  v_add_u32 v108, s12, v108
  v_xor_b32 v109, 32, v108
  v_xor_b32 v110, 64, v108
  v_xor_b32 v111, 96, v108
  s_waitcnt lgkmcnt(7)
  v_mfma_f32_32x32x16_bf16 v[44:59], v[224:227], v[84:87], v[44:59]
  s_waitcnt lgkmcnt(5)
  v_mfma_f32_32x32x16_bf16 v[112:127], v[228:231], v[84:87], v[112:127]
  s_waitcnt vmcnt(0)
  v_cmp_ne_u32 vcc, s9, v16
  s_nop 0
  s_cbranch_vccnz Lprn1_100
Lpdn1_99:
  s_cmp_ge_u32 s7, 6
  s_cselect_b32 s13, s95, s94
  s_add_u32 s13, s13, 8192
  buffer_load_dwordx4 v[28:31], v7, s[76:79], s13 offen offset:2048 sc1
  buffer_load_dwordx4 v[32:35], v7, s[76:79], s13 offen offset:3072 sc1
  s_cmp_ge_u32 s7, 5
  s_cselect_b32 s13, s95, s94
  s_add_u32 s13, s13, 16384
  buffer_load_dwordx4 v[76:79], v7, s[76:79], s13 offen offset:2048 sc1
  buffer_load_dwordx4 v[128:131], v7, s[76:79], s13 offen offset:3072 sc1
  s_cmp_ge_u32 s7, 4
  s_cselect_b32 s13, s95, s94
  s_add_u32 s13, s13, 24576
  buffer_load_dwordx4 v[132:135], v7, s[76:79], s13 offen offset:2048 sc1
  s_waitcnt lgkmcnt(3)
  v_mfma_f32_32x32x16_bf16 v[44:59], v[232:235], v[88:91], v[44:59]
  ds_read_b32 v24, v26
  buffer_load_dwordx4 v[80:83], v7, s[76:79], s13 offen offset:3072 sc1
  s_waitcnt lgkmcnt(2)
  v_mfma_f32_32x32x16_bf16 v[112:127], v[236:239], v[88:91], v[112:127]
  s_cmp_ge_u32 s7, 3
  s_cselect_b32 s13, s95, s94
  s_add_u32 s13, s13, 32768
  buffer_load_dwordx4 v[136:139], v7, s[76:79], s13 offen offset:2048 sc1
  s_waitcnt vmcnt(6)
  v_mfma_f32_32x32x16_bf16 v[60:75], v[144:147], v[28:31], v[60:75]
  buffer_load_dwordx4 v[140:143], v7, s[76:79], s13 offen offset:3072 sc1
  v_mfma_f32_32x32x16_bf16 v[92:107], v[148:151], v[28:31], v[92:107]
  v_cndmask_b32 v25, 12, 8, s[0:1]
  s_waitcnt lgkmcnt(0)
  v_cmp_gt_u32 vcc, v25, v24
  s_nop 0
  s_cbranch_vccnz Llrg_102
Lldg_101:
  ds_write_b128 v108, v[44:47] offset:0
  s_cmp_ge_u32 s7, 2
  s_cselect_b32 s13, s95, s94
  s_add_u32 s13, s13, 40960
  buffer_load_dwordx4 v[240:243], v7, s[76:79], s13 offen offset:2048 sc1
  s_waitcnt vmcnt(7)
  v_mfma_f32_32x32x16_bf16 v[60:75], v[152:155], v[32:35], v[60:75]
  ds_write_b128 v109, v[48:51] offset:0
  buffer_load_dwordx4 v[244:247], v7, s[76:79], s13 offen offset:3072 sc1
  v_mfma_f32_32x32x16_bf16 v[92:107], v[156:159], v[32:35], v[92:107]
  ds_write_b128 v110, v[52:55] offset:0
  s_cmp_ge_u32 s7, 1
  s_cselect_b32 s13, s95, s94
  s_add_u32 s13, s13, 49152
  buffer_load_dwordx4 v[248:251], v7, s[76:79], s13 offen offset:2048 sc1
  s_waitcnt vmcnt(8)
  v_mfma_f32_32x32x16_bf16 v[60:75], v[160:163], v[76:79], v[60:75]
  ds_write_b128 v111, v[56:59] offset:0
  buffer_load_dwordx4 v[252:255], v7, s[76:79], s13 offen offset:3072 sc1
  v_mfma_f32_32x32x16_bf16 v[92:107], v[164:167], v[76:79], v[92:107]
  ds_write_b128 v108, v[112:115] offset:16384
  s_waitcnt vmcnt(8)
  v_mfma_f32_32x32x16_bf16 v[60:75], v[168:171], v[128:131], v[60:75]
  ds_write_b128 v109, v[116:119] offset:16384
  v_mfma_f32_32x32x16_bf16 v[92:107], v[172:175], v[128:131], v[92:107]
  ds_write_b128 v110, v[120:123] offset:16384
  s_waitcnt vmcnt(7)
  v_mfma_f32_32x32x16_bf16 v[60:75], v[176:179], v[132:135], v[60:75]
  ds_write_b128 v111, v[124:127] offset:16384
  v_mfma_f32_32x32x16_bf16 v[92:107], v[180:183], v[132:135], v[92:107]
  v_mov_b32 v23, 13
  ds_write_b32 v0, v23
  s_waitcnt vmcnt(6)
  v_mfma_f32_32x32x16_bf16 v[60:75], v[184:187], v[80:83], v[60:75]
  v_mfma_f32_32x32x16_bf16 v[92:107], v[188:191], v[80:83], v[92:107]
  s_waitcnt vmcnt(5)
  v_mfma_f32_32x32x16_bf16 v[60:75], v[192:195], v[136:139], v[60:75]
  s_waitcnt vmcnt(4)
  v_mfma_f32_32x32x16_bf16 v[60:75], v[200:203], v[140:143], v[60:75]
  s_waitcnt vmcnt(3)
  v_mfma_f32_32x32x16_bf16 v[60:75], v[208:211], v[240:243], v[60:75]
  s_waitcnt vmcnt(2)
  v_mfma_f32_32x32x16_bf16 v[60:75], v[216:219], v[244:247], v[60:75]
  s_waitcnt vmcnt(1)
  v_mfma_f32_32x32x16_bf16 v[60:75], v[224:227], v[248:251], v[60:75]
  s_waitcnt vmcnt(0)
  v_mfma_f32_32x32x16_bf16 v[60:75], v[232:235], v[252:255], v[60:75]
  v_mfma_f32_32x32x16_bf16 v[92:107], v[196:199], v[136:139], v[92:107]
  v_mfma_f32_32x32x16_bf16 v[92:107], v[204:207], v[140:143], v[92:107]
  s_nop 9
  ds_write_b128 v108, v[60:63] offset:32768
  v_mfma_f32_32x32x16_bf16 v[92:107], v[212:215], v[240:243], v[92:107]
  ds_write_b128 v109, v[64:67] offset:32768
  ds_write_b128 v110, v[68:71] offset:32768
  v_mfma_f32_32x32x16_bf16 v[92:107], v[220:223], v[244:247], v[92:107]
  ds_write_b128 v111, v[72:75] offset:32768
  v_mov_b32 v23, 14
  ds_write_b32 v0, v23
  v_mfma_f32_32x32x16_bf16 v[92:107], v[228:231], v[248:251], v[92:107]
  v_mfma_f32_32x32x16_bf16 v[92:107], v[236:239], v[252:255], v[92:107]
  s_nop 11
  ds_write_b128 v108, v[92:95] offset:49152
  ds_write_b128 v109, v[96:99] offset:49152
  ds_write_b128 v110, v[100:103] offset:49152
  ds_write_b128 v111, v[104:107] offset:49152
  v_mov_b32 v23, 15
  ds_write_b32 v0, v23
  s_or_b32 s12, s3, s8
  s_cmp_eq_u32 s12, 0
  s_cbranch_scc0 Lend
  v_mov_b32 v15, s9
  buffer_store_dword v15, v21, s[76:79], 0 offen sc1
  s_branch Lend
LB:
  ds_write_b64 v28, v[210:211]
  ds_write_b64 v28, v[210:211] offset:8
  ds_write_b64 v28, v[210:211] offset:16
  s_and_b32 s12, s84, 1
  s_lshl_b32 s12, s12, 5
  v_xor_b32 v7, s12, v5
  s_lshr_b32 s12, s84, 1
  s_lshl_b32 s12, s12, 11
  s_add_u32 s12, s12, 28672
  v_add_u32 v7, s12, v7
  v_and_b32 v15, 1, v3
  v_lshlrev_b32 v15, 8, v15
  v_lshl_add_u32 v8, v2, 3, v15
  v_add_u32 v8, 161792, v8
  v_and_b32 v47, 3, v1
  v_mul_u32_u24 v47, 224, v47
  v_add_u32 v47, 154816, v47
  v_and_b32 v15, 4, v1
  v_add_u32 v47, v47, v15
  s_mov_b32 s0, 0xf0f0f0f0
  s_mov_b32 s1, 0xf0f0f0f0
  s_add_u32 m0, s94, 2048
  s_nop 0
  buffer_load_dwordx4 v10, s[40:43], s96 offen lds
  buffer_load_dwordx4 v11, s[40:43], s96 offen offset:1024 lds
  s_add_u32 s96, s96, 128
  s_cmp_eq_u32 s96, 896
  s_cselect_b32 s96, 0, s96
  s_add_u32 m0, s95, 8192
  s_mul_i32 s93, s92, 1344
  buffer_load_dwordx4 v9, s[44:47], s93 offen offset:0 lds
  s_add_u32 s92, s92, 128
  s_cmp_eq_u32 s92, 896
  s_cselect_b32 s92, 0, s92
  s_add_u32 m0, s94, 4096
  s_nop 0
  buffer_load_dwordx4 v10, s[40:43], s96 offen lds
  buffer_load_dwordx4 v11, s[40:43], s96 offen offset:1024 lds
  s_add_u32 s96, s96, 128
  s_cmp_eq_u32 s96, 896
  s_cselect_b32 s96, 0, s96
  s_waitcnt lgkmcnt(0)
  s_add_u32 s9, s9, 0x9E3779B9
  s_andn2_b32 s9, s9, 15
  s_getreg_b32 s10, hwreg(HW_REG_XCC_ID)
  s_and_b32 s10, s10, 15
  s_or_b32 s10, s10, s9
  s_and_b32 s85, s9, 0xbfffbfff
  v_mov_b32 v15, s85
  s_mov_b32 s12, 0x00880088
  s_mov_b32 s13, 0x00880088
  s_waitcnt vmcnt(7)
  v_cndmask_b32 v55, v55, v15, s[12:13]
  s_mov_b32 s12, 0x11001100
  s_mov_b32 s13, 0x11001100
  v_cndmask_b32 v52, v52, v15, s[12:13]
  buffer_store_dwordx4 v[52:55], v49, s[76:79], 0 offen sc1
  s_waitcnt lgkmcnt(0)
  s_waitcnt vmcnt(7)
  s_barrier
  ds_read_b128 v[132:135], v12 offset:0
  ds_read_b128 v[76:79], v44 offset:0
  ds_read_b128 v[136:139], v21 offset:0
  ds_read_b128 v[80:83], v45 offset:0
  s_add_u32 m0, s94, 6144
  s_nop 0
  buffer_load_dwordx4 v10, s[40:43], s96 offen lds
  buffer_load_dwordx4 v11, s[40:43], s96 offen offset:1024 lds
  s_add_u32 s96, s96, 128
  s_cmp_eq_u32 s96, 896
  s_cselect_b32 s96, 0, s96
  s_waitcnt lgkmcnt(3)
  v_mfma_f32_16x16x32_bf16 v[192:195], v[132:135], v[132:135], 0
  v_mfma_f32_16x16x32_bf16 v[188:191], v[32:35], v[132:135], 0
  s_waitcnt lgkmcnt(2)
  v_mfma_f32_16x16x32_bf16 v[72:75], v[76:79], v[76:79], 0
  v_mfma_f32_16x16x32_bf16 v[68:71], v[32:35], v[76:79], 0
  s_waitcnt lgkmcnt(1)
  v_mfma_f32_16x16x32_bf16 v[192:195], v[136:139], v[136:139], v[192:195]
  v_mfma_f32_16x16x32_bf16 v[188:191], v[32:35], v[136:139], v[188:191]
  s_waitcnt lgkmcnt(0)
  v_mfma_f32_16x16x32_bf16 v[72:75], v[80:83], v[80:83], v[72:75]
  v_mfma_f32_16x16x32_bf16 v[68:71], v[32:35], v[80:83], v[68:71]
  s_waitcnt vmcnt(6)
  s_barrier
  ds_read_b128 v[140:143], v12 offset:2048
  ds_read_b128 v[84:87], v44 offset:2048
  ds_read_b128 v[144:147], v21 offset:2048
  ds_read_b128 v[88:91], v45 offset:2048
  v_lshrrev_b32 v15, 5, v1
  v_lshlrev_b32 v15, 5, v15
  v_xor_b32 v48, v15, v4
  s_mul_i32 s12, s5, 28672
  s_add_u32 s12, s12, s95
  s_add_u32 s12, s12, 1114112
  v_add_u32 v48, s12, v48
  s_cmp_eq_u32 s81, 1
  s_cselect_b32 s12, 0, 60
  v_and_b32 v15, 8, v1
  v_lshlrev_b32 v15, 2, v15
  v_xor_b32 v15, s12, v15
  v_lshl_add_u32 v15, v2, 6, v15
  s_add_u32 s12, s95, 28672
  v_lshl_add_u32 v49, v3, 12, v15
  v_add_u32 v49, s12, v49
  v_lshl_add_u32 v50, v3, 10, v15
  v_add_u32 v50, s97, v50
  s_add_u32 m0, s95, 12288
  s_mul_i32 s93, s92, 1344
  buffer_load_dwordx4 v9, s[44:47], s93 offen offset:0 lds
  s_add_u32 s92, s92, 128
  s_cmp_eq_u32 s92, 896
  s_cselect_b32 s92, 0, s92
  s_add_u32 m0, s94, 8192
  s_nop 0
  buffer_load_dwordx4 v10, s[40:43], s96 offen lds
  buffer_load_dwordx4 v11, s[40:43], s96 offen offset:1024 lds
  s_add_u32 s96, s96, 128
  s_cmp_eq_u32 s96, 896
  s_cselect_b32 s96, 0, s96
  s_waitcnt lgkmcnt(3)
  v_mfma_f32_16x16x32_bf16 v[192:195], v[140:143], v[140:143], v[192:195]
  v_mfma_f32_16x16x32_bf16 v[188:191], v[32:35], v[140:143], v[188:191]
  s_waitcnt lgkmcnt(2)
  v_mfma_f32_16x16x32_bf16 v[72:75], v[84:87], v[84:87], v[72:75]
  v_mfma_f32_16x16x32_bf16 v[68:71], v[32:35], v[84:87], v[68:71]
  s_waitcnt lgkmcnt(1)
  v_mfma_f32_16x16x32_bf16 v[192:195], v[144:147], v[144:147], v[192:195]
  v_mfma_f32_16x16x32_bf16 v[188:191], v[32:35], v[144:147], v[188:191]
  s_waitcnt lgkmcnt(0)
  v_mfma_f32_16x16x32_bf16 v[72:75], v[88:91], v[88:91], v[72:75]
  v_mfma_f32_16x16x32_bf16 v[68:71], v[32:35], v[88:91], v[68:71]
  s_waitcnt vmcnt(6)
  s_barrier
  ds_read_b128 v[148:151], v12 offset:4096
  ds_read_b128 v[92:95], v44 offset:4096
  ds_read_b128 v[152:155], v21 offset:4096
  ds_read_b128 v[96:99], v45 offset:4096
  ds_read_b64_tr_b16 v[36:37], v17
  ds_read_b64_tr_b16 v[38:39], v19
  ds_read_b64_tr_b16 v[40:41], v18
  ds_read_b64_tr_b16 v[42:43], v20
  v_mov_b32 v15, s10
  s_lshl_b32 s12, s3, 6
  s_add_u32 s12, s12, 4096
  s_cmp_eq_u32 s8, 4
  s_cselect_b32 s12, s12, 2147418112
  v_mov_b32 v16, s12
  buffer_store_dword v15, v16, s[76:79], 0 offen sc1
  s_add_u32 m0, s95, 16384
  s_mul_i32 s93, s92, 1344
  buffer_load_dwordx4 v9, s[44:47], s93 offen offset:0 lds
  s_add_u32 s92, s92, 128
  s_cmp_eq_u32 s92, 896
  s_cselect_b32 s92, 0, s92
  s_add_u32 m0, s94, 10240
  s_nop 0
  buffer_load_dwordx4 v10, s[40:43], s96 offen lds
  buffer_load_dwordx4 v11, s[40:43], s96 offen offset:1024 lds
  s_add_u32 s96, s96, 128
  s_cmp_eq_u32 s96, 896
  s_cselect_b32 s96, 0, s96
  s_waitcnt lgkmcnt(7)
  v_mfma_f32_16x16x32_bf16 v[192:195], v[148:151], v[148:151], v[192:195]
  v_mfma_f32_16x16x32_bf16 v[188:191], v[32:35], v[148:151], v[188:191]
  s_waitcnt lgkmcnt(6)
  v_mfma_f32_16x16x32_bf16 v[72:75], v[92:95], v[92:95], v[72:75]
  v_mfma_f32_16x16x32_bf16 v[68:71], v[32:35], v[92:95], v[68:71]
  s_waitcnt lgkmcnt(5)
  v_mfma_f32_16x16x32_bf16 v[192:195], v[152:155], v[152:155], v[192:195]
  v_mfma_f32_16x16x32_bf16 v[188:191], v[32:35], v[152:155], v[188:191]
  s_waitcnt lgkmcnt(4)
  v_mfma_f32_16x16x32_bf16 v[72:75], v[96:99], v[96:99], v[72:75]
  v_mfma_f32_16x16x32_bf16 v[68:71], v[32:35], v[96:99], v[68:71]
  s_waitcnt vmcnt(6)
  s_barrier
  ds_read_b128 v[156:159], v12 offset:6144
  ds_read_b128 v[100:103], v44 offset:6144
  ds_read_b128 v[160:163], v21 offset:6144
  ds_read_b128 v[104:107], v45 offset:6144
  s_waitcnt lgkmcnt(7)
  v_cndmask_b32 v36, v36, v13, s[88:89]
  v_cndmask_b32 v37, v37, v13, s[88:89]
  s_waitcnt lgkmcnt(5)
  v_cndmask_b32 v40, v40, v13, s[88:89]
  v_cndmask_b32 v41, v41, v13, s[88:89]
  v_cndmask_b32 v38, v38, v13, s[90:91]
  v_cndmask_b32 v39, v39, v13, s[90:91]
  s_waitcnt lgkmcnt(4)
  v_cndmask_b32 v42, v42, v13, s[90:91]
  v_cndmask_b32 v43, v43, v13, s[90:91]
  s_add_u32 m0, s95, 20480
  s_mul_i32 s93, s92, 1344
  buffer_load_dwordx4 v9, s[44:47], s93 offen offset:0 lds
  s_add_u32 s92, s92, 128
  s_cmp_eq_u32 s92, 896
  s_cselect_b32 s92, 0, s92
  s_add_u32 m0, s94, 12288
  s_nop 0
  buffer_load_dwordx4 v10, s[40:43], s96 offen lds
  buffer_load_dwordx4 v11, s[40:43], s96 offen offset:1024 lds
  s_add_u32 s96, s96, 128
  s_cmp_eq_u32 s96, 896
  s_cselect_b32 s96, 0, s96
  v_mov_b32 v20, 2147418112
  s_mul_i32 s12, s84, 224
  s_add_u32 s12, s12, 154816
  v_mov_b32 v17, s12
  s_waitcnt lgkmcnt(3)
  v_mfma_f32_16x16x32_bf16 v[192:195], v[156:159], v[156:159], v[192:195]
  v_mfma_f32_16x16x32_bf16 v[188:191], v[32:35], v[156:159], v[188:191]
  s_waitcnt lgkmcnt(2)
  v_mfma_f32_16x16x32_bf16 v[72:75], v[100:103], v[100:103], v[72:75]
  v_mfma_f32_16x16x32_bf16 v[68:71], v[32:35], v[100:103], v[68:71]
  s_waitcnt lgkmcnt(1)
  v_mfma_f32_16x16x32_bf16 v[192:195], v[160:163], v[160:163], v[192:195]
  v_mfma_f32_16x16x32_bf16 v[188:191], v[32:35], v[160:163], v[188:191]
  s_waitcnt lgkmcnt(0)
  v_mfma_f32_16x16x32_bf16 v[72:75], v[104:107], v[104:107], v[72:75]
  v_mfma_f32_16x16x32_bf16 v[68:71], v[32:35], v[104:107], v[68:71]
  s_waitcnt vmcnt(5)
  s_barrier
  ds_read_b128 v[164:167], v12 offset:0
  ds_read_b128 v[108:111], v44 offset:8192
  ds_read_b128 v[168:171], v21 offset:0
  ds_read_b128 v[112:115], v45 offset:8192
  s_add_u32 m0, s95, 24576
  s_mul_i32 s93, s92, 1344
  buffer_load_dwordx4 v9, s[44:47], s93 offen offset:0 lds
  s_add_u32 s92, s92, 128
  s_cmp_eq_u32 s92, 896
  s_cselect_b32 s92, 0, s92
  s_add_u32 m0, s95, 28672
  s_lshl_b32 s93, s92, 5
  buffer_load_dwordx4 v48, s[76:79], s93 offen sc1 lds
  s_add_u32 s92, s92, 128
  s_cmp_eq_u32 s92, 896
  s_cselect_b32 s92, 0, s92
  s_add_u32 m0, s95, 32768
  s_lshl_b32 s93, s92, 5
  buffer_load_dwordx4 v48, s[76:79], s93 offen sc1 lds
  s_add_u32 s92, s92, 128
  s_cmp_eq_u32 s92, 896
  s_cselect_b32 s92, 0, s92
  s_add_u32 m0, s95, 36864
  s_lshl_b32 s93, s92, 5
  buffer_load_dwordx4 v48, s[76:79], s93 offen sc1 lds
  s_add_u32 s92, s92, 128
  s_cmp_eq_u32 s92, 896
  s_cselect_b32 s92, 0, s92
  s_add_u32 m0, s95, 40960
  s_lshl_b32 s93, s92, 5
  buffer_load_dwordx4 v48, s[76:79], s93 offen sc1 lds
  s_add_u32 s92, s92, 128
  s_cmp_eq_u32 s92, 896
  s_cselect_b32 s92, 0, s92
  s_waitcnt lgkmcnt(3)
  v_mfma_f32_16x16x32_bf16 v[192:195], v[164:167], v[164:167], v[192:195]
  v_mfma_f32_16x16x32_bf16 v[188:191], v[32:35], v[164:167], v[188:191]
  s_waitcnt lgkmcnt(2)
  v_mfma_f32_16x16x32_bf16 v[72:75], v[108:111], v[108:111], v[72:75]
  v_mfma_f32_16x16x32_bf16 v[68:71], v[32:35], v[108:111], v[68:71]
  s_waitcnt lgkmcnt(1)
  v_mfma_f32_16x16x32_bf16 v[192:195], v[168:171], v[168:171], v[192:195]
  v_mfma_f32_16x16x32_bf16 v[188:191], v[32:35], v[168:171], v[188:191]
  s_waitcnt lgkmcnt(0)
  v_mfma_f32_16x16x32_bf16 v[72:75], v[112:115], v[112:115], v[72:75]
  v_mfma_f32_16x16x32_bf16 v[68:71], v[32:35], v[112:115], v[68:71]
  s_waitcnt vmcnt(7)
  s_barrier
  ds_read_b128 v[172:175], v12 offset:2048
  ds_read_b128 v[116:119], v44 offset:10240
  ds_read_b128 v[176:179], v21 offset:2048
  ds_read_b128 v[120:123], v45 offset:10240
  s_add_u32 m0, s95, 45056
  s_lshl_b32 s93, s92, 5
  buffer_load_dwordx4 v48, s[76:79], s93 offen sc1 lds
  s_add_u32 s92, s92, 128
  s_cmp_eq_u32 s92, 896
  s_cselect_b32 s92, 0, s92
  s_add_u32 m0, s95, 49152
  s_lshl_b32 s93, s92, 5
  buffer_load_dwordx4 v48, s[76:79], s93 offen sc1 lds
  s_add_u32 s92, s92, 128
  s_cmp_eq_u32 s92, 896
  s_cselect_b32 s92, 0, s92
  s_add_u32 m0, s95, 53248
  s_lshl_b32 s93, s92, 5
  buffer_load_dwordx4 v48, s[76:79], s93 offen sc1 lds
  s_add_u32 s92, s92, 128
  s_cmp_eq_u32 s92, 896
  s_cselect_b32 s92, 0, s92
  s_waitcnt lgkmcnt(3)
  v_mfma_f32_16x16x32_bf16 v[192:195], v[172:175], v[172:175], v[192:195]
  v_mfma_f32_16x16x32_bf16 v[188:191], v[32:35], v[172:175], v[188:191]
  s_waitcnt lgkmcnt(2)
  v_mfma_f32_16x16x32_bf16 v[72:75], v[116:119], v[116:119], v[72:75]
  v_mfma_f32_16x16x32_bf16 v[68:71], v[32:35], v[116:119], v[68:71]
  s_waitcnt lgkmcnt(1)
  v_mfma_f32_16x16x32_bf16 v[192:195], v[176:179], v[176:179], v[192:195]
  v_mfma_f32_16x16x32_bf16 v[188:191], v[32:35], v[176:179], v[188:191]
  s_waitcnt lgkmcnt(0)
  v_mfma_f32_16x16x32_bf16 v[72:75], v[120:123], v[120:123], v[72:75]
  v_mfma_f32_16x16x32_bf16 v[68:71], v[32:35], v[120:123], v[68:71]
  s_waitcnt vmcnt(7)
  s_barrier
  s_setprio 2
  ds_read_b128 v[180:183], v12 offset:4096
  ds_read_b128 v[124:127], v44 offset:12288
  ds_read_b128 v[184:187], v21 offset:4096
  ds_read_b128 v[128:131], v45 offset:12288
  s_waitcnt lgkmcnt(3)
  v_mfma_f32_16x16x32_bf16 v[192:195], v[180:183], v[180:183], v[192:195]
  v_mfma_f32_16x16x32_bf16 v[188:191], v[32:35], v[180:183], v[188:191]
  s_waitcnt lgkmcnt(2)
  v_mfma_f32_16x16x32_bf16 v[72:75], v[124:127], v[124:127], v[72:75]
  v_mfma_f32_16x16x32_bf16 v[68:71], v[32:35], v[124:127], v[68:71]
  s_waitcnt lgkmcnt(1)
  v_mfma_f32_16x16x32_bf16 v[192:195], v[184:187], v[184:187], v[192:195]
  v_mfma_f32_16x16x32_bf16 v[188:191], v[32:35], v[184:187], v[188:191]
  s_waitcnt lgkmcnt(0)
  v_mfma_f32_16x16x32_bf16 v[72:75], v[128:131], v[128:131], v[72:75]
  v_mfma_f32_16x16x32_bf16 v[68:71], v[32:35], v[128:131], v[68:71]
  s_setprio 2
  s_nop 2
  v_mul_f32 v192, v192, v252
  v_mul_f32 v193, v193, v253
  v_mul_f32 v194, v194, v254
  v_mul_f32 v195, v195, v255
  v_mul_f32 v72, v72, v252
  v_mul_f32 v73, v73, v253
  v_mul_f32 v74, v74, v254
  v_mul_f32 v75, v75, v255
  v_add_f32 v192, v192, v193
  v_add_f32 v194, v194, v195
  v_mul_f32 v193, s82, v188
  v_add_f32 v72, v72, v73
  v_add_f32 v74, v74, v75
  v_mul_f32 v73, s82, v68
  s_waitcnt vmcnt(0)
  ds_read_b32 v44, v49 offset:0
  ds_read_b32 v45, v49 offset:12288
  v_add_f32 v192, v192, v194
  v_add_f32 v72, v72, v74
  v_mul_f32 v193, v193, v193
  v_mul_f32 v73, v73, v73
  v_permlane32_swap_b32 v192, v72
  v_add_f32 v192, v192, v72
  v_mov_b32 v194, v192
  s_nop 1
  v_permlane16_swap_b32 v192, v194
  v_add_f32 v192, v192, v194
  v_mov_b32 v72, v192
  s_nop 1
  v_permlane32_swap_b32 v192, v72
  v_fma_f32 v192, v192, s82, -v193
  v_fma_f32 v72, v72, s82, -v73
  v_add_f32 v192, 0x3727c5ac, v192
  v_add_f32 v72, 0x3727c5ac, v72
  v_rsq_f32 v190, v192
  v_rsq_f32 v70, v72
  v_mul_f32 v204, s83, v190
  v_mul_f32 v205, s83, v70
  ds_write_b64 v28, v[204:205] offset:8
  s_setprio 3
  s_waitcnt lgkmcnt(2)
  v_cmp_ne_u32 vcc, s85, v44
  s_waitcnt lgkmcnt(1)
  v_cmp_ne_u32 s[14:15], s85, v45
  s_nop 0
  s_or_b64 vcc, vcc, s[14:15]
  s_cbranch_vccnz Ltr_104
Ltd_103:
  v_mov_b32 v16, 1
  ds_write_b32 v17, v16 offset:0
  ds_read_b32 v15, v47
  v_mov_b32 v30, v205
  v_mul_f32 v192, v188, v29
  v_cvt_pk_bf16_f32 v216, v192, v192
  v_and_b32 v193, 0xffff0000, v216
  v_sub_f32 v193, v192, v193
  v_cvt_pk_bf16_f32 v217, v193, 0
  v_mul_f32 v72, v68, v29
  v_cvt_pk_bf16_f32 v224, v72, v72
  v_and_b32 v73, 0xffff0000, v224
  v_sub_f32 v73, v72, v73
  v_cvt_pk_bf16_f32 v225, v73, 0
  v_cmp_eq_u32 vcc, 0, v1
  s_nop 1
  v_cndmask_b32 v21, v20, v13, vcc
  s_lshl_b32 s12, s84, 7
  s_add_u32 s12, s12, 161792
  v_lshlrev_b32 v12, 3, v2
  v_add_u32 v12, s12, v12
  s_waitcnt lgkmcnt(0)
  v_cmp_gt_u32 vcc, 1, v15
  s_nop 0
  s_cbranch_vccnz Llrf1_106
Lldf1_105:
  ds_read_b64_tr_b16 v[228:229], v5 offset:28672
  ds_read_b64_tr_b16 v[230:231], v5 offset:28928
  ds_read_b64_tr_b16 v[232:233], v6 offset:28672
  ds_read_b64_tr_b16 v[234:235], v6 offset:28928
  ds_read_b64_tr_b16 v[236:237], v5 offset:30720
  ds_read_b64_tr_b16 v[238:239], v5 offset:30976
  ds_read_b64_tr_b16 v[240:241], v6 offset:30720
  ds_read_b64_tr_b16 v[242:243], v6 offset:30976
  ds_read_b64_tr_b16 v[196:197], v7 offset:0
  ds_read_b64_tr_b16 v[198:199], v7 offset:256
  s_add_u32 m0, s97, 0
  s_lshl_b32 s93, s92, 5
  s_add_u32 s93, s93, 458752
  buffer_load_dwordx4 v48, s[76:79], s93 offen sc1 lds
  s_add_u32 s92, s92, 128
  s_cmp_eq_u32 s92, 896
  s_cselect_b32 s92, 0, s92
  s_add_u32 m0, s97, 1024
  s_lshl_b32 s93, s92, 5
  s_add_u32 s93, s93, 458752
  buffer_load_dwordx4 v48, s[76:79], s93 offen sc1 lds
  s_add_u32 s92, s92, 128
  s_cmp_eq_u32 s92, 896
  s_cselect_b32 s92, 0, s92
  s_add_u32 m0, s97, 2048
  s_lshl_b32 s93, s92, 5
  s_add_u32 s93, s93, 458752
  buffer_load_dwordx4 v48, s[76:79], s93 offen sc1 lds
  s_add_u32 s92, s92, 128
  s_cmp_eq_u32 s92, 896
  s_cselect_b32 s92, 0, s92
  s_add_u32 m0, s97, 3072
  s_lshl_b32 s93, s92, 5
  s_add_u32 s93, s93, 458752
  buffer_load_dwordx4 v48, s[76:79], s93 offen sc1 lds
  s_add_u32 s92, s92, 128
  s_cmp_eq_u32 s92, 896
  s_cselect_b32 s92, 0, s92
  s_add_u32 m0, s97, 4096
  s_lshl_b32 s93, s92, 5
  s_add_u32 s93, s93, 458752
  buffer_load_dwordx4 v48, s[76:79], s93 offen sc1 lds
  s_add_u32 s92, s92, 128
  s_cmp_eq_u32 s92, 896
  s_cselect_b32 s92, 0, s92
  s_add_u32 m0, s97, 5120
  s_lshl_b32 s93, s92, 5
  s_add_u32 s93, s93, 458752
  buffer_load_dwordx4 v48, s[76:79], s93 offen sc1 lds
  s_add_u32 s92, s92, 128
  s_cmp_eq_u32 s92, 896
  s_cselect_b32 s92, 0, s92
  s_add_u32 m0, s97, 6144
  s_lshl_b32 s93, s92, 5
  s_add_u32 s93, s93, 458752
  buffer_load_dwordx4 v48, s[76:79], s93 offen sc1 lds
  s_add_u32 s92, s92, 128
  s_cmp_eq_u32 s92, 896
  s_cselect_b32 s92, 0, s92
  s_waitcnt lgkmcnt(8)
  v_mfma_f32_16x16x32_bf16 v[52:55], v[228:231], v[132:135], 0
  ds_read_b64_tr_b16 v[244:245], v5 offset:32768
  ds_read_b64_tr_b16 v[246:247], v5 offset:33024
  v_mfma_f32_16x16x32_bf16 v[60:63], v[228:231], v[76:79], 0
  ds_read_b64_tr_b16 v[248:249], v6 offset:32768
  ds_read_b64_tr_b16 v[250:251], v6 offset:33024
  s_waitcnt lgkmcnt(10)
  v_mfma_f32_16x16x32_bf16 v[56:59], v[232:235], v[132:135], 0
  ds_read_b64_tr_b16 v[200:201], v7 offset:4096
  ds_read_b64_tr_b16 v[202:203], v7 offset:4352
  v_mfma_f32_16x16x32_bf16 v[64:67], v[232:235], v[76:79], 0
  s_waitcnt lgkmcnt(10)
  v_mfma_f32_16x16x32_bf16 v[52:55], v[236:239], v[136:139], v[52:55]
  ds_read_b64_tr_b16 v[228:229], v5 offset:34816
  ds_read_b64_tr_b16 v[230:231], v5 offset:35072
  v_mfma_f32_16x16x32_bf16 v[60:63], v[236:239], v[80:83], v[60:63]
  ds_read_b64_tr_b16 v[232:233], v6 offset:34816
  s_waitcnt lgkmcnt(11)
  v_mfma_f32_16x16x32_bf16 v[56:59], v[240:243], v[136:139], v[56:59]
  ds_read_b64_tr_b16 v[234:235], v6 offset:35072
  ds_read_b64_tr_b16 v[192:193], v7 offset:8192
  v_mfma_f32_16x16x32_bf16 v[64:67], v[240:243], v[80:83], v[64:67]
  ds_read_b64_tr_b16 v[194:195], v7 offset:8448
  s_waitcnt lgkmcnt(12)
  v_mfma_f32_16x16x32_bf16 v[220:223], v[32:35], v[196:199], 0
  s_waitcnt lgkmcnt(10)
  v_mfma_f32_16x16x32_bf16 v[52:55], v[244:247], v[140:143], v[52:55]
  ds_read_b64_tr_b16 v[236:237], v5 offset:36864
  ds_read_b64_tr_b16 v[238:239], v5 offset:37120
  v_mfma_f32_16x16x32_bf16 v[60:63], v[244:247], v[84:87], v[60:63]
  ds_read_b64_tr_b16 v[240:241], v6 offset:36864
  s_waitcnt lgkmcnt(11)
  v_mfma_f32_16x16x32_bf16 v[56:59], v[248:251], v[140:143], v[56:59]
  ds_read_b64_tr_b16 v[242:243], v6 offset:37120
  ds_read_b64_tr_b16 v[72:73], v7 offset:12288
  v_mfma_f32_16x16x32_bf16 v[64:67], v[248:251], v[84:87], v[64:67]
  ds_read_b64_tr_b16 v[74:75], v7 offset:12544
  s_waitcnt lgkmcnt(12)
  v_mfma_f32_16x16x32_bf16 v[220:223], v[32:35], v[200:203], v[220:223]
  s_waitcnt lgkmcnt(10)
  v_mfma_f32_16x16x32_bf16 v[52:55], v[228:231], v[144:147], v[52:55]
  ds_read_b64_tr_b16 v[244:245], v5 offset:38912
  ds_read_b64_tr_b16 v[246:247], v5 offset:39168
  v_mfma_f32_16x16x32_bf16 v[60:63], v[228:231], v[88:91], v[60:63]
  ds_read_b64_tr_b16 v[248:249], v6 offset:38912
  s_waitcnt lgkmcnt(11)
  v_mfma_f32_16x16x32_bf16 v[56:59], v[232:235], v[144:147], v[56:59]
  ds_read_b64_tr_b16 v[250:251], v6 offset:39168
  ds_read_b64_tr_b16 v[196:197], v7 offset:16384
  v_mfma_f32_16x16x32_bf16 v[64:67], v[232:235], v[88:91], v[64:67]
  ds_read_b64_tr_b16 v[198:199], v7 offset:16640
  s_waitcnt lgkmcnt(12)
  v_mfma_f32_16x16x32_bf16 v[220:223], v[32:35], v[192:195], v[220:223]
  s_waitcnt lgkmcnt(10)
  v_mfma_f32_16x16x32_bf16 v[52:55], v[236:239], v[148:151], v[52:55]
  ds_read_b64_tr_b16 v[228:229], v5 offset:40960
  ds_read_b64_tr_b16 v[230:231], v5 offset:41216
  v_mfma_f32_16x16x32_bf16 v[60:63], v[236:239], v[92:95], v[60:63]
  ds_read_b64_tr_b16 v[232:233], v6 offset:40960
  s_waitcnt lgkmcnt(11)
  v_mfma_f32_16x16x32_bf16 v[56:59], v[240:243], v[148:151], v[56:59]
  ds_read_b64_tr_b16 v[234:235], v6 offset:41216
  ds_read_b64_tr_b16 v[200:201], v7 offset:20480
  v_mfma_f32_16x16x32_bf16 v[64:67], v[240:243], v[92:95], v[64:67]
  ds_read_b64_tr_b16 v[202:203], v7 offset:20736
  s_waitcnt lgkmcnt(12)
  v_mfma_f32_16x16x32_bf16 v[220:223], v[32:35], v[72:75], v[220:223]
  s_waitcnt lgkmcnt(10)
  v_mfma_f32_16x16x32_bf16 v[52:55], v[244:247], v[152:155], v[52:55]
  ds_read_b64_tr_b16 v[236:237], v5 offset:43008
  ds_read_b64_tr_b16 v[238:239], v5 offset:43264
  v_mfma_f32_16x16x32_bf16 v[60:63], v[244:247], v[96:99], v[60:63]
  ds_read_b64_tr_b16 v[240:241], v6 offset:43008
  s_waitcnt lgkmcnt(11)
  v_mfma_f32_16x16x32_bf16 v[56:59], v[248:251], v[152:155], v[56:59]
  ds_read_b64_tr_b16 v[242:243], v6 offset:43264
  ds_read_b64_tr_b16 v[192:193], v7 offset:24576
  v_mfma_f32_16x16x32_bf16 v[64:67], v[248:251], v[96:99], v[64:67]
  ds_read_b64_tr_b16 v[194:195], v7 offset:24832
  s_waitcnt lgkmcnt(12)
  v_mfma_f32_16x16x32_bf16 v[220:223], v[32:35], v[196:199], v[220:223]
  s_waitcnt lgkmcnt(10)
  v_mfma_f32_16x16x32_bf16 v[52:55], v[228:231], v[156:159], v[52:55]
  ds_read_b64_tr_b16 v[244:245], v5 offset:45056
  v_mfma_f32_16x16x32_bf16 v[60:63], v[228:231], v[100:103], v[60:63]
  ds_read_b64_tr_b16 v[246:247], v5 offset:45312
  s_waitcnt lgkmcnt(10)
  v_mfma_f32_16x16x32_bf16 v[56:59], v[232:235], v[156:159], v[56:59]
  ds_read_b64_tr_b16 v[248:249], v6 offset:45056
  v_mfma_f32_16x16x32_bf16 v[64:67], v[232:235], v[100:103], v[64:67]
  ds_read_b64_tr_b16 v[250:251], v6 offset:45312
  s_waitcnt lgkmcnt(10)
  v_mfma_f32_16x16x32_bf16 v[220:223], v[32:35], v[200:203], v[220:223]
  s_waitcnt lgkmcnt(8)
  v_mfma_f32_16x16x32_bf16 v[52:55], v[236:239], v[160:163], v[52:55]
  ds_read_b64_tr_b16 v[228:229], v5 offset:47104
  v_mfma_f32_16x16x32_bf16 v[60:63], v[236:239], v[104:107], v[60:63]
  ds_read_b64_tr_b16 v[230:231], v5 offset:47360
  s_waitcnt lgkmcnt(8)
  v_mfma_f32_16x16x32_bf16 v[56:59], v[240:243], v[160:163], v[56:59]
  ds_read_b64_tr_b16 v[232:233], v6 offset:47104
  v_mfma_f32_16x16x32_bf16 v[64:67], v[240:243], v[104:107], v[64:67]
  ds_read_b64_tr_b16 v[234:235], v6 offset:47360
  s_waitcnt lgkmcnt(8)
  v_mfma_f32_16x16x32_bf16 v[220:223], v[32:35], v[192:195], v[220:223]
  s_waitcnt lgkmcnt(6)
  v_mfma_f32_16x16x32_bf16 v[52:55], v[244:247], v[164:167], v[52:55]
  ds_read_b64_tr_b16 v[236:237], v5 offset:49152
  ds_read_b64_tr_b16 v[238:239], v5 offset:49408
  v_mfma_f32_16x16x32_bf16 v[60:63], v[244:247], v[108:111], v[60:63]
  ds_read_b64_tr_b16 v[240:241], v6 offset:49152
  s_waitcnt lgkmcnt(7)
  v_mfma_f32_16x16x32_bf16 v[56:59], v[248:251], v[164:167], v[56:59]
  ds_read_b64_tr_b16 v[242:243], v6 offset:49408
  v_mfma_f32_16x16x32_bf16 v[64:67], v[248:251], v[108:111], v[64:67]
  s_waitcnt lgkmcnt(6)
  v_mfma_f32_16x16x32_bf16 v[52:55], v[228:231], v[168:171], v[52:55]
  ds_read_b64_tr_b16 v[244:245], v5 offset:51200
  ds_read_b64_tr_b16 v[246:247], v5 offset:51456
  v_mfma_f32_16x16x32_bf16 v[60:63], v[228:231], v[112:115], v[60:63]
  ds_read_b64_tr_b16 v[248:249], v6 offset:51200
  s_waitcnt lgkmcnt(7)
  v_mfma_f32_16x16x32_bf16 v[56:59], v[232:235], v[168:171], v[56:59]
  ds_read_b64_tr_b16 v[250:251], v6 offset:51456
  v_mfma_f32_16x16x32_bf16 v[64:67], v[232:235], v[112:115], v[64:67]
  s_waitcnt lgkmcnt(6)
  v_mfma_f32_16x16x32_bf16 v[52:55], v[236:239], v[172:175], v[52:55]
  ds_read_b64_tr_b16 v[228:229], v5 offset:53248
  ds_read_b64_tr_b16 v[230:231], v5 offset:53504
  ds_read_b64_tr_b16 v[232:233], v6 offset:53248
  ds_read_b64_tr_b16 v[234:235], v6 offset:53504
  v_mfma_f32_16x16x32_bf16 v[60:63], v[236:239], v[116:119], v[60:63]
  v_cvt_pk_bf16_f32 v207, v220, v220
  v_and_b32 v196, 0xffff0000, v207
  v_sub_f32 v196, v220, v196
  s_waitcnt lgkmcnt(8)
  v_mfma_f32_16x16x32_bf16 v[56:59], v[240:243], v[172:175], v[56:59]
  v_cvt_pk_bf16_f32 v206, v220, v196
  ds_write_b64 v12, v[206:207] offset:0
  v_mov_b32 v16, 2
  ds_write_b32 v17, v16 offset:0
  v_mfma_f32_16x16x32_bf16 v[64:67], v[240:243], v[116:119], v[64:67]
  s_waitcnt lgkmcnt(8)
  v_mfma_f32_16x16x32_bf16 v[52:55], v[244:247], v[176:179], v[52:55]
  ds_read_b64_tr_b16 v[236:237], v5 offset:55296
  ds_read_b64_tr_b16 v[238:239], v5 offset:55552
  v_mfma_f32_16x16x32_bf16 v[60:63], v[244:247], v[120:123], v[60:63]
  ds_read_b64_tr_b16 v[240:241], v6 offset:55296
  s_waitcnt lgkmcnt(9)
  v_mfma_f32_16x16x32_bf16 v[56:59], v[248:251], v[176:179], v[56:59]
  ds_read_b64_tr_b16 v[242:243], v6 offset:55552
  v_mfma_f32_16x16x32_bf16 v[64:67], v[248:251], v[120:123], v[64:67]
  s_waitcnt lgkmcnt(8)
  v_mfma_f32_16x16x32_bf16 v[52:55], v[228:231], v[180:183], v[52:55]
  ds_read_b32 v15, v47
  v_mfma_f32_16x16x32_bf16 v[60:63], v[228:231], v[124:127], v[60:63]
  ds_read_b64 v[208:209], v8 offset:0
  s_waitcnt lgkmcnt(8)
  v_mfma_f32_16x16x32_bf16 v[56:59], v[232:235], v[180:183], v[56:59]
  ds_read_b64 v[212:213], v8 offset:128
  v_mfma_f32_16x16x32_bf16 v[64:67], v[232:235], v[124:127], v[64:67]
  s_waitcnt lgkmcnt(5)
  v_mfma_f32_16x16x32_bf16 v[52:55], v[236:239], v[184:187], v[52:55]
  v_mfma_f32_16x16x32_bf16 v[60:63], v[236:239], v[128:131], v[60:63]
  s_waitcnt lgkmcnt(3)
  v_mfma_f32_16x16x32_bf16 v[56:59], v[240:243], v[184:187], v[56:59]
  v_mfma_f32_16x16x32_bf16 v[64:67], v[240:243], v[128:131], v[64:67]
  s_waitcnt lgkmcnt(2)
  v_cmp_gt_u32 vcc, 2, v15
  s_nop 0
  s_cbranch_vccnz Llrf2_108
Lldf2_107:
  s_waitcnt lgkmcnt(1)
  v_mfma_f32_16x16x32_bf16 v[52:55], v[208:211], v[216:219], v[52:55]
  s_waitcnt lgkmcnt(0)
  v_mfma_f32_16x16x32_bf16 v[56:59], v[212:215], v[216:219], v[56:59]
  v_mfma_f32_16x16x32_bf16 v[60:63], v[208:211], v[224:227], v[60:63]
  v_mfma_f32_16x16x32_bf16 v[64:67], v[212:215], v[224:227], v[64:67]
  s_nop 3
  v_mul_f32 v52, v52, v190
  v_mul_f32 v53, v53, v190
  v_mul_f32 v54, v54, v190
  v_mul_f32 v55, v55, v190
  v_mul_f32 v56, v56, v190
  v_mul_f32 v57, v57, v190
  v_mul_f32 v58, v58, v190
  v_mul_f32 v59, v59, v190
  v_cndmask_b32 v52, v52, 1.0, s[88:89]
  v_cndmask_b32 v56, v56, 1.0, s[90:91]
  v_cvt_pk_bf16_f32 v188, v52, v53
  v_cvt_pk_bf16_f32 v189, v54, v55
  v_cvt_pk_bf16_f32 v190, v56, v57
  v_cvt_pk_bf16_f32 v191, v58, v59
  ds_write_b64 v23, v[188:189] offset:128
  ds_write_b64 v23, v[190:191] offset:160
  v_mul_f32 v60, v60, v70
  v_mul_f32 v61, v61, v70
  v_mul_f32 v62, v62, v70
  v_mul_f32 v63, v63, v70
  v_mul_f32 v64, v64, v70
  v_mul_f32 v65, v65, v70
  v_mul_f32 v66, v66, v70
  v_mul_f32 v67, v67, v70
  v_cndmask_b32 v60, v60, 1.0, s[88:89]
  v_cndmask_b32 v64, v64, 1.0, s[90:91]
  v_cvt_pk_bf16_f32 v68, v60, v61
  v_cvt_pk_bf16_f32 v69, v62, v63
  v_cvt_pk_bf16_f32 v70, v64, v65
  v_cvt_pk_bf16_f32 v71, v66, v67
  ds_write_b64 v46, v[68:69] offset:128
  ds_write_b64 v46, v[70:71] offset:160
  v_mov_b32 v16, 3
  ds_write_b32 v17, v16 offset:0
  s_setprio 0
  v_lshrrev_b32 v15, 1, v3
  v_mul_u32_u24 v15, 7168, v15
  v_add_u32 v15, 114688, v15
  v_add_u32 v10, v5, v15
  v_add_u32 v11, v6, v15
  s_and_b32 s12, s84, 1
  s_lshl_b32 s13, s12, 5
  v_xor_b32 v31, s13, v10
  s_lshr_b32 s13, s84, 1
  s_lshl_b32 s14, s13, 14
  v_add_u32 v31, s14, v31
  v_add_u32 v24, 155648, v4
  s_cmp_eq_u32 s81, 1
  s_cselect_b32 s12, 0, 1216
  s_add_u32 s12, s12, 155648
  v_lshlrev_b32 v25, 8, v3
  v_add_u32 v25, s12, v25
  s_mul_i32 s12, s5, 7
  s_lshr_b32 s12, s12, 1
  v_and_b32 v18, 1, v3
  v_lshrrev_b32 v19, 1, v3
  v_lshl_add_u32 v26, v18, 1, v19
  v_add_u32 v18, s12, v26
  v_lshlrev_b32 v18, 8, v18
  v_lshl_add_u32 v18, v2, 4, v18
  s_mul_i32 s86, s4, 1376256
  s_add_u32 s86, s86, 2097152
  s_add_u32 s87, s86, 688128
  s_mul_i32 s12, s84, 14336
  s_add_u32 s12, s12, 272384
  v_add_u32 v18, s12, v18
  v_add_u32 v19, 8, v18
  v_mov_b32 v20, 2147418112
  v_cndmask_b32 v18, v18, v20, s[88:89]
  v_cndmask_b32 v19, v19, v20, s[90:91]
  s_lshl_b32 s12, s84, 6
  s_lshl_b32 s13, s5, 2
  s_add_u32 s12, s12, s13
  s_add_u32 s12, s12, 200704
  s_add_u32 s12, s12, s86
  v_mul_u32_u24 v14, 688128, v1
  v_add_u32 v14, s12, v14
  v_cmp_gt_u32 vcc, 2, v1
  s_nop 1
  v_cndmask_b32 v14, v20, v14, vcc
  v_mov_b32 v27, s9
  s_mul_i32 s12, s84, 224
  s_add_u32 s12, s12, 154816
  v_mov_b32 v17, s12
  v_lshrrev_b32 v51, 3, v1
  s_lshl_b32 s12, s84, 3
  v_add_u32 v51, s12, v51
  v_mul_u32_u24 v51, 896, v51
  v_bfe_u32 v15, v1, 4, 1
  v_lshlrev_b32 v15, 1, v15
  s_and_b32 s12, s84, 1
  s_lshl_b32 s12, s12, 2
  v_and_b32 v16, 7, v1
  v_xor_b32 v15, v15, v16
  v_xor_b32 v15, s12, v15
  v_lshl_add_u32 v51, v15, 4, v51
  s_lshl_b32 s12, s7, 7
  s_cmp_eq_u32 s7, 7
  s_cselect_b32 s12, 2147418112, s12
  v_add_u32 v51, s12, v51
  s_waitcnt vmcnt(0)
  ds_read_b32 v44, v50 offset:0
  ds_read_b32 v45, v50 offset:3072
  s_waitcnt lgkmcnt(1)
  v_cmp_ne_u32 vcc, s85, v44
  s_waitcnt lgkmcnt(0)
  v_cmp_ne_u32 s[14:15], s85, v45
  s_nop 0
  s_or_b64 vcc, vcc, s[14:15]
  s_cbranch_vccnz Ltr_110
Ltd_109:
  v_mov_b32 v16, 4
  ds_write_b32 v17, v16 offset:0
  ds_read_b32 v15, v47
  s_waitcnt lgkmcnt(0)
  v_cmp_gt_u32 vcc, 4, v15
  s_nop 0
  s_cbranch_vccnz Llrf4_112
Lldf4_111:
  ds_read_b64_tr_b16 v[228:229], v10 offset:0
  ds_read_b64_tr_b16 v[230:231], v10 offset:256
  ds_read_b64_tr_b16 v[232:233], v11 offset:0
  ds_read_b64_tr_b16 v[234:235], v11 offset:256
  ds_read_b64_tr_b16 v[236:237], v10 offset:16384
  ds_read_b64_tr_b16 v[238:239], v10 offset:16640
  ds_read_b64_tr_b16 v[240:241], v11 offset:16384
  ds_read_b64_tr_b16 v[242:243], v11 offset:16640
  ds_read_b64_tr_b16 v[196:197], v31 offset:0
  ds_read_b64_tr_b16 v[198:199], v31 offset:256
  s_waitcnt lgkmcnt(8)
  v_mfma_f32_16x16x32_bf16 v[52:55], v[228:231], v[132:135], 0
  ds_read_b64_tr_b16 v[244:245], v10 offset:1024
  ds_read_b64_tr_b16 v[246:247], v10 offset:1280
  v_mfma_f32_16x16x32_bf16 v[60:63], v[228:231], v[76:79], 0
  ds_read_b64_tr_b16 v[248:249], v11 offset:1024
  ds_read_b64_tr_b16 v[250:251], v11 offset:1280
  s_waitcnt lgkmcnt(10)
  v_mfma_f32_16x16x32_bf16 v[56:59], v[232:235], v[132:135], 0
  ds_read_b64_tr_b16 v[200:201], v31 offset:1024
  ds_read_b64_tr_b16 v[202:203], v31 offset:1280
  v_mfma_f32_16x16x32_bf16 v[64:67], v[232:235], v[76:79], 0
  s_waitcnt lgkmcnt(10)
  v_mfma_f32_16x16x32_bf16 v[52:55], v[236:239], v[136:139], v[52:55]
  ds_read_b64_tr_b16 v[228:229], v10 offset:17408
  ds_read_b64_tr_b16 v[230:231], v10 offset:17664
  v_mfma_f32_16x16x32_bf16 v[60:63], v[236:239], v[80:83], v[60:63]
  ds_read_b64_tr_b16 v[232:233], v11 offset:17408
  s_waitcnt lgkmcnt(11)
  v_mfma_f32_16x16x32_bf16 v[56:59], v[240:243], v[136:139], v[56:59]
  ds_read_b64_tr_b16 v[234:235], v11 offset:17664
  ds_read_b64_tr_b16 v[192:193], v31 offset:2048
  v_mfma_f32_16x16x32_bf16 v[64:67], v[240:243], v[80:83], v[64:67]
  ds_read_b64_tr_b16 v[194:195], v31 offset:2304
  s_waitcnt lgkmcnt(12)
  v_mfma_f32_16x16x32_bf16 v[220:223], v[32:35], v[196:199], 0
  s_waitcnt lgkmcnt(10)
  v_mfma_f32_16x16x32_bf16 v[52:55], v[244:247], v[140:143], v[52:55]
  ds_read_b64_tr_b16 v[236:237], v10 offset:2048
  ds_read_b64_tr_b16 v[238:239], v10 offset:2304
  v_mfma_f32_16x16x32_bf16 v[60:63], v[244:247], v[84:87], v[60:63]
  ds_read_b64_tr_b16 v[240:241], v11 offset:2048
  s_waitcnt lgkmcnt(11)
  v_mfma_f32_16x16x32_bf16 v[56:59], v[248:251], v[140:143], v[56:59]
  ds_read_b64_tr_b16 v[242:243], v11 offset:2304
  ds_read_b64_tr_b16 v[72:73], v31 offset:3072
  v_mfma_f32_16x16x32_bf16 v[64:67], v[248:251], v[84:87], v[64:67]
  ds_read_b64_tr_b16 v[74:75], v31 offset:3328
  s_waitcnt lgkmcnt(12)
  v_mfma_f32_16x16x32_bf16 v[220:223], v[32:35], v[200:203], v[220:223]
  s_waitcnt lgkmcnt(10)
  v_mfma_f32_16x16x32_bf16 v[52:55], v[228:231], v[144:147], v[52:55]
  ds_read_b64_tr_b16 v[244:245], v10 offset:18432
  ds_read_b64_tr_b16 v[246:247], v10 offset:18688
  v_mfma_f32_16x16x32_bf16 v[60:63], v[228:231], v[88:91], v[60:63]
  ds_read_b64_tr_b16 v[248:249], v11 offset:18432
  s_waitcnt lgkmcnt(11)
  v_mfma_f32_16x16x32_bf16 v[56:59], v[232:235], v[144:147], v[56:59]
  ds_read_b64_tr_b16 v[250:251], v11 offset:18688
  ds_read_b64_tr_b16 v[196:197], v31 offset:4096
  v_mfma_f32_16x16x32_bf16 v[64:67], v[232:235], v[88:91], v[64:67]
  ds_read_b64_tr_b16 v[198:199], v31 offset:4352
  s_waitcnt lgkmcnt(12)
  v_mfma_f32_16x16x32_bf16 v[220:223], v[32:35], v[192:195], v[220:223]
  s_waitcnt lgkmcnt(10)
  v_mfma_f32_16x16x32_bf16 v[52:55], v[236:239], v[148:151], v[52:55]
  ds_read_b64_tr_b16 v[228:229], v10 offset:3072
  ds_read_b64_tr_b16 v[230:231], v10 offset:3328
  v_mfma_f32_16x16x32_bf16 v[60:63], v[236:239], v[92:95], v[60:63]
  ds_read_b64_tr_b16 v[232:233], v11 offset:3072
  s_waitcnt lgkmcnt(11)
  v_mfma_f32_16x16x32_bf16 v[56:59], v[240:243], v[148:151], v[56:59]
  ds_read_b64_tr_b16 v[234:235], v11 offset:3328
  ds_read_b64_tr_b16 v[200:201], v31 offset:5120
  v_mfma_f32_16x16x32_bf16 v[64:67], v[240:243], v[92:95], v[64:67]
  ds_read_b64_tr_b16 v[202:203], v31 offset:5376
  s_waitcnt lgkmcnt(12)
  v_mfma_f32_16x16x32_bf16 v[220:223], v[32:35], v[72:75], v[220:223]
  s_waitcnt lgkmcnt(10)
  v_mfma_f32_16x16x32_bf16 v[52:55], v[244:247], v[152:155], v[52:55]
  ds_read_b64_tr_b16 v[236:237], v10 offset:19456
  ds_read_b64_tr_b16 v[238:239], v10 offset:19712
  v_mfma_f32_16x16x32_bf16 v[60:63], v[244:247], v[96:99], v[60:63]
  ds_read_b64_tr_b16 v[240:241], v11 offset:19456
  s_waitcnt lgkmcnt(11)
  v_mfma_f32_16x16x32_bf16 v[56:59], v[248:251], v[152:155], v[56:59]
  ds_read_b64_tr_b16 v[242:243], v11 offset:19712
  ds_read_b64_tr_b16 v[192:193], v31 offset:6144
  v_mfma_f32_16x16x32_bf16 v[64:67], v[248:251], v[96:99], v[64:67]
  ds_read_b64_tr_b16 v[194:195], v31 offset:6400
  s_waitcnt lgkmcnt(12)
  v_mfma_f32_16x16x32_bf16 v[220:223], v[32:35], v[196:199], v[220:223]
  s_waitcnt lgkmcnt(10)
  v_mfma_f32_16x16x32_bf16 v[52:55], v[228:231], v[156:159], v[52:55]
  ds_read_b64_tr_b16 v[244:245], v10 offset:4096
  v_mfma_f32_16x16x32_bf16 v[60:63], v[228:231], v[100:103], v[60:63]
  ds_read_b64_tr_b16 v[246:247], v10 offset:4352
  s_waitcnt lgkmcnt(10)
  v_mfma_f32_16x16x32_bf16 v[56:59], v[232:235], v[156:159], v[56:59]
  ds_read_b64_tr_b16 v[248:249], v11 offset:4096
  v_mfma_f32_16x16x32_bf16 v[64:67], v[232:235], v[100:103], v[64:67]
  ds_read_b64_tr_b16 v[250:251], v11 offset:4352
  s_waitcnt lgkmcnt(10)
  v_mfma_f32_16x16x32_bf16 v[220:223], v[32:35], v[200:203], v[220:223]
  s_waitcnt lgkmcnt(8)
  v_mfma_f32_16x16x32_bf16 v[52:55], v[236:239], v[160:163], v[52:55]
  ds_read_b64_tr_b16 v[228:229], v10 offset:20480
  v_mfma_f32_16x16x32_bf16 v[60:63], v[236:239], v[104:107], v[60:63]
  ds_read_b64_tr_b16 v[230:231], v10 offset:20736
  s_waitcnt lgkmcnt(8)
  v_mfma_f32_16x16x32_bf16 v[56:59], v[240:243], v[160:163], v[56:59]
  ds_read_b64_tr_b16 v[232:233], v11 offset:20480
  v_mfma_f32_16x16x32_bf16 v[64:67], v[240:243], v[104:107], v[64:67]
  ds_read_b64_tr_b16 v[234:235], v11 offset:20736
  s_waitcnt lgkmcnt(8)
  v_mfma_f32_16x16x32_bf16 v[220:223], v[32:35], v[192:195], v[220:223]
  s_waitcnt lgkmcnt(6)
  v_mfma_f32_16x16x32_bf16 v[52:55], v[244:247], v[164:167], v[52:55]
  ds_read_b64_tr_b16 v[236:237], v10 offset:5120
  ds_read_b64_tr_b16 v[238:239], v10 offset:5376
  v_mfma_f32_16x16x32_bf16 v[60:63], v[244:247], v[108:111], v[60:63]
  ds_read_b64_tr_b16 v[240:241], v11 offset:5120
  s_waitcnt lgkmcnt(7)
  v_mfma_f32_16x16x32_bf16 v[56:59], v[248:251], v[164:167], v[56:59]
  ds_read_b64_tr_b16 v[242:243], v11 offset:5376
  v_mfma_f32_16x16x32_bf16 v[64:67], v[248:251], v[108:111], v[64:67]
  s_waitcnt lgkmcnt(6)
  v_mfma_f32_16x16x32_bf16 v[52:55], v[228:231], v[168:171], v[52:55]
  ds_read_b64_tr_b16 v[244:245], v10 offset:21504
  ds_read_b64_tr_b16 v[246:247], v10 offset:21760
  v_mfma_f32_16x16x32_bf16 v[60:63], v[228:231], v[112:115], v[60:63]
  ds_read_b64_tr_b16 v[248:249], v11 offset:21504
  s_waitcnt lgkmcnt(7)
  v_mfma_f32_16x16x32_bf16 v[56:59], v[232:235], v[168:171], v[56:59]
  ds_read_b64_tr_b16 v[250:251], v11 offset:21760
  v_mfma_f32_16x16x32_bf16 v[64:67], v[232:235], v[112:115], v[64:67]
  s_waitcnt lgkmcnt(6)
  v_mfma_f32_16x16x32_bf16 v[52:55], v[236:239], v[172:175], v[52:55]
  ds_read_b64_tr_b16 v[228:229], v10 offset:6144
  ds_read_b64_tr_b16 v[230:231], v10 offset:6400
  ds_read_b64_tr_b16 v[232:233], v11 offset:6144
  ds_read_b64_tr_b16 v[234:235], v11 offset:6400
  v_mfma_f32_16x16x32_bf16 v[60:63], v[236:239], v[116:119], v[60:63]
  v_cvt_pk_bf16_f32 v207, v220, v220
  v_and_b32 v196, 0xffff0000, v207
  v_sub_f32 v196, v220, v196
  s_waitcnt lgkmcnt(8)
  v_mfma_f32_16x16x32_bf16 v[56:59], v[240:243], v[172:175], v[56:59]
  v_cvt_pk_bf16_f32 v206, v220, v196
  ds_write_b64 v12, v[206:207] offset:512
  v_mov_b32 v16, 5
  ds_write_b32 v17, v16 offset:0
  v_mfma_f32_16x16x32_bf16 v[64:67], v[240:243], v[116:119], v[64:67]
  s_waitcnt lgkmcnt(8)
  v_mfma_f32_16x16x32_bf16 v[52:55], v[244:247], v[176:179], v[52:55]
  ds_read_b64_tr_b16 v[236:237], v10 offset:22528
  ds_read_b64_tr_b16 v[238:239], v10 offset:22784
  v_mfma_f32_16x16x32_bf16 v[60:63], v[244:247], v[120:123], v[60:63]
  ds_read_b64_tr_b16 v[240:241], v11 offset:22528
  ds_read_b64_tr_b16 v[242:243], v11 offset:22784
  s_waitcnt lgkmcnt(10)
  v_mfma_f32_16x16x32_bf16 v[56:59], v[248:251], v[176:179], v[56:59]
  s_lshl_b32 s12, s7, 9
  s_lshr_b32 s13, s84, 1
  s_lshl_b32 s13, s13, 7
  s_add_u32 s12, s12, s13
  s_and_b32 s13, s84, 1
  s_mul_i32 s13, s13, 28672
  s_add_u32 s12, s12, s13
  s_cmp_eq_u32 s7, 7
  s_cselect_b32 s12, 2147418112, s12
  v_lshrrev_b32 v15, 3, v1
  v_mul_u32_u24 v48, 3584, v15
  v_bfe_u32 v15, v1, 4, 1
  v_lshlrev_b32 v15, 2, v15
  v_and_b32 v16, 7, v1
  v_xor_b32 v15, v15, v16
  v_lshl_add_u32 v48, v15, 4, v48
  v_add_u32 v48, s12, v48
  v_mfma_f32_16x16x32_bf16 v[64:67], v[248:251], v[120:123], v[64:67]
  s_waitcnt lgkmcnt(8)
  v_mfma_f32_16x16x32_bf16 v[52:55], v[228:231], v[180:183], v[52:55]
  ds_read_b32 v15, v47
  v_mfma_f32_16x16x32_bf16 v[60:63], v[228:231], v[124:127], v[60:63]
  ds_read_b64 v[208:209], v8 offset:512
  s_waitcnt lgkmcnt(8)
  v_mfma_f32_16x16x32_bf16 v[56:59], v[232:235], v[180:183], v[56:59]
  ds_read_b64 v[212:213], v8 offset:640
  v_mfma_f32_16x16x32_bf16 v[64:67], v[232:235], v[124:127], v[64:67]
  s_waitcnt lgkmcnt(5)
  v_mfma_f32_16x16x32_bf16 v[52:55], v[236:239], v[184:187], v[52:55]
  v_mfma_f32_16x16x32_bf16 v[60:63], v[236:239], v[128:131], v[60:63]
  s_waitcnt lgkmcnt(3)
  v_mfma_f32_16x16x32_bf16 v[56:59], v[240:243], v[184:187], v[56:59]
  v_mfma_f32_16x16x32_bf16 v[64:67], v[240:243], v[128:131], v[64:67]
  s_waitcnt lgkmcnt(2)
  v_cmp_gt_u32 vcc, 5, v15
  s_nop 0
  s_cbranch_vccnz Llrf5_114
Lldf5_113:
  s_waitcnt lgkmcnt(1)
  v_mfma_f32_16x16x32_bf16 v[52:55], v[208:211], v[216:219], v[52:55]
  s_waitcnt lgkmcnt(0)
  v_mfma_f32_16x16x32_bf16 v[56:59], v[212:215], v[216:219], v[56:59]
  v_mfma_f32_16x16x32_bf16 v[60:63], v[208:211], v[224:227], v[60:63]
  v_mfma_f32_16x16x32_bf16 v[64:67], v[212:215], v[224:227], v[64:67]
  v_mov_b32 v16, 6
  ds_write_b32 v17, v16 offset:0
  s_nop 1
  v_cvt_pk_bf16_f32 v192, v52, v53
  v_cvt_pk_bf16_f32 v193, v54, v55
  v_cvt_pk_bf16_f32 v194, v56, v57
  v_cvt_pk_bf16_f32 v195, v58, v59
  s_nop 1
  v_mfma_f32_16x16x32_bf16 v[52:55], v[36:39], v[192:195], 0
  v_mfma_f32_16x16x32_bf16 v[56:59], v[40:43], v[192:195], 0
  v_cvt_pk_bf16_f32 v72, v60, v61
  v_cvt_pk_bf16_f32 v73, v62, v63
  v_cvt_pk_bf16_f32 v74, v64, v65
  v_cvt_pk_bf16_f32 v75, v66, v67
  s_nop 1
  v_mfma_f32_16x16x32_bf16 v[60:63], v[36:39], v[72:75], 0
  v_mfma_f32_16x16x32_bf16 v[64:67], v[40:43], v[72:75], 0
  v_max3_f32 v148, v52, v53, v54
  s_nop 5
  v_max3_f32 v172, v60, v61, v62
  v_max3_f32 v150, -v52, -v53, -v54
  v_max3_f32 v174, -v60, -v61, -v62
  v_max3_f32 v148, v148, v55, v56
  v_max3_f32 v172, v172, v63, v64
  v_max3_f32 v150, v150, -v55, -v56
  v_max3_f32 v174, v174, -v63, -v64
  v_max3_f32 v148, v148, v57, v58
  v_max3_f32 v172, v172, v65, v66
  v_max3_f32 v150, v150, -v57, -v58
  v_max3_f32 v174, v174, -v65, -v66
  v_max_f32 v148, v148, v59
  v_max_f32 v172, v172, v67
  v_max_f32_e64 v150, v150, -v59
  v_max_f32_e64 v174, v174, -v67
  s_nop 0
  v_permlane32_swap_b32 v148, v150
  v_permlane32_swap_b32 v172, v174
  v_max_f32 v148, v148, v150
  v_max_f32 v172, v172, v174
  v_mov_b32 v149, v148
  v_mov_b32 v173, v172
  s_nop 0
  v_permlane16_swap_b32 v148, v149
  v_permlane16_swap_b32 v172, v173
  v_max_f32 v148, v148, v149
  v_max_f32 v172, v172, v173
  v_mov_b32 v150, v148
  v_mov_b32 v174, v172
  s_nop 0
  v_permlane32_swap_b32 v148, v150
  v_permlane32_swap_b32 v172, v174
  v_mul_f32_e64 v148, -v148, v204
  v_mul_f32_e64 v172, -v172, v30
  v_mul_f32_e64 v150, -v150, v204
  v_mul_f32_e64 v174, -v174, v30
  v_pk_fma_f32 v[152:153], v[52:53], v[204:205], v[148:149] op_sel_hi:[1,0,0]
  v_pk_fma_f32 v[176:177], v[60:61], v[30:31], v[172:173] op_sel_hi:[1,0,0]
  v_pk_fma_f32 v[160:161], v[52:53], v[204:205], v[150:151] op_sel_hi:[1,0,0] neg_lo:[1,0,0] neg_hi:[1,0,0]
  v_pk_fma_f32 v[184:185], v[60:61], v[30:31], v[174:175] op_sel_hi:[1,0,0] neg_lo:[1,0,0] neg_hi:[1,0,0]
  v_pk_fma_f32 v[154:155], v[54:55], v[204:205], v[148:149] op_sel_hi:[1,0,0]
  v_pk_fma_f32 v[178:179], v[62:63], v[30:31], v[172:173] op_sel_hi:[1,0,0]
  v_pk_fma_f32 v[162:163], v[54:55], v[204:205], v[150:151] op_sel_hi:[1,0,0] neg_lo:[1,0,0] neg_hi:[1,0,0]
  v_pk_fma_f32 v[186:187], v[62:63], v[30:31], v[174:175] op_sel_hi:[1,0,0] neg_lo:[1,0,0] neg_hi:[1,0,0]
  v_pk_fma_f32 v[156:157], v[56:57], v[204:205], v[148:149] op_sel_hi:[1,0,0]
  v_pk_fma_f32 v[180:181], v[64:65], v[30:31], v[172:173] op_sel_hi:[1,0,0]
  v_pk_fma_f32 v[164:165], v[56:57], v[204:205], v[150:151] op_sel_hi:[1,0,0] neg_lo:[1,0,0] neg_hi:[1,0,0]
  v_pk_fma_f32 v[188:189], v[64:65], v[30:31], v[174:175] op_sel_hi:[1,0,0] neg_lo:[1,0,0] neg_hi:[1,0,0]
  v_pk_fma_f32 v[158:159], v[58:59], v[204:205], v[148:149] op_sel_hi:[1,0,0]
  v_pk_fma_f32 v[182:183], v[66:67], v[30:31], v[172:173] op_sel_hi:[1,0,0]
  v_pk_fma_f32 v[166:167], v[58:59], v[204:205], v[150:151] op_sel_hi:[1,0,0] neg_lo:[1,0,0] neg_hi:[1,0,0]
  v_pk_fma_f32 v[190:191], v[66:67], v[30:31], v[174:175] op_sel_hi:[1,0,0] neg_lo:[1,0,0] neg_hi:[1,0,0]
  v_exp_f32 v152, v152
  v_exp_f32 v176, v176
  v_exp_f32 v153, v153
  v_exp_f32 v177, v177
  v_exp_f32 v154, v154
  v_exp_f32 v178, v178
  v_exp_f32 v155, v155
  v_exp_f32 v179, v179
  v_exp_f32 v156, v156
  v_exp_f32 v180, v180
  v_exp_f32 v157, v157
  v_exp_f32 v181, v181
  v_exp_f32 v158, v158
  v_exp_f32 v182, v182
  v_exp_f32 v159, v159
  v_exp_f32 v183, v183
  v_exp_f32 v160, v160
  v_exp_f32 v184, v184
  v_exp_f32 v161, v161
  v_exp_f32 v185, v185
  v_exp_f32 v162, v162
  v_exp_f32 v186, v186
  v_exp_f32 v163, v163
  v_exp_f32 v187, v187
  v_exp_f32 v164, v164
  v_exp_f32 v188, v188
  v_exp_f32 v165, v165
  v_exp_f32 v189, v189
  v_exp_f32 v166, v166
  v_exp_f32 v190, v190
  v_exp_f32 v167, v167
  v_exp_f32 v191, v191
  v_pk_add_f32 v[168:169], v[152:153], v[154:155]
  v_pk_add_f32 v[192:193], v[176:177], v[178:179]
  v_pk_add_f32 v[170:171], v[156:157], v[158:159]
  v_pk_add_f32 v[194:195], v[180:181], v[182:183]
  v_pk_fma_f32 v[168:169], v[170:171], v[22:23], v[168:169] op_sel_hi:[1,0,1]
  v_pk_fma_f32 v[192:193], v[194:195], v[22:23], v[192:193] op_sel_hi:[1,0,1]
  v_add_f32 v148, v168, v169
  v_add_f32 v172, v192, v193
  v_pk_add_f32 v[168:169], v[160:161], v[162:163]
  v_pk_add_f32 v[192:193], v[184:185], v[186:187]
  v_pk_add_f32 v[170:171], v[164:165], v[166:167]
  v_pk_add_f32 v[194:195], v[188:189], v[190:191]
  v_pk_fma_f32 v[168:169], v[170:171], v[22:23], v[168:169] op_sel_hi:[1,0,1]
  v_pk_fma_f32 v[192:193], v[194:195], v[22:23], v[192:193] op_sel_hi:[1,0,1]
  v_add_f32 v150, v168, v169
  v_add_f32 v174, v192, v193
  s_nop 0
  v_permlane32_swap_b32 v148, v150
  v_permlane32_swap_b32 v172, v174
  v_add_f32 v148, v148, v150
  v_add_f32 v172, v172, v174
  v_mov_b32 v149, v148
  v_mov_b32 v173, v172
  s_nop 0
  v_permlane16_swap_b32 v148, v149
  v_permlane16_swap_b32 v172, v173
  v_add_f32 v148, v148, v149
  v_add_f32 v172, v172, v173
  v_mov_b32 v150, v148
  v_mov_b32 v174, v172
  s_nop 0
  v_permlane32_swap_b32 v148, v150
  v_permlane32_swap_b32 v172, v174
  v_rcp_f32 v148, v148
  v_rcp_f32 v172, v172
  v_rcp_f32 v150, v150
  v_rcp_f32 v174, v174
  v_mul_f32 v168, v148, v22
  v_mul_f32 v192, v172, v22
  v_mul_f32 v170, v150, v22
  v_mul_f32 v194, v174, v22
  v_pk_mul_f32 v[152:153], v[152:153], v[148:149] op_sel_hi:[1,0]
  v_pk_mul_f32 v[176:177], v[176:177], v[172:173] op_sel_hi:[1,0]
  v_pk_mul_f32 v[160:161], v[160:161], v[150:151] op_sel_hi:[1,0]
  v_pk_mul_f32 v[184:185], v[184:185], v[174:175] op_sel_hi:[1,0]
  v_pk_mul_f32 v[154:155], v[154:155], v[148:149] op_sel_hi:[1,0]
  v_pk_mul_f32 v[178:179], v[178:179], v[172:173] op_sel_hi:[1,0]
  v_pk_mul_f32 v[162:163], v[162:163], v[150:151] op_sel_hi:[1,0]
  v_pk_mul_f32 v[186:187], v[186:187], v[174:175] op_sel_hi:[1,0]
  v_pk_mul_f32 v[156:157], v[156:157], v[168:169] op_sel_hi:[1,0]
  v_pk_mul_f32 v[180:181], v[180:181], v[192:193] op_sel_hi:[1,0]
  v_pk_mul_f32 v[164:165], v[164:165], v[170:171] op_sel_hi:[1,0]
  v_pk_mul_f32 v[188:189], v[188:189], v[194:195] op_sel_hi:[1,0]
  v_pk_mul_f32 v[158:159], v[158:159], v[168:169] op_sel_hi:[1,0]
  v_pk_mul_f32 v[182:183], v[182:183], v[192:193] op_sel_hi:[1,0]
  v_pk_mul_f32 v[166:167], v[166:167], v[170:171] op_sel_hi:[1,0]
  v_pk_mul_f32 v[190:191], v[190:191], v[194:195] op_sel_hi:[1,0]
  ds_read_b32 v15, v47
  v_cvt_pk_bf16_f32 v132, v152, v153
  v_cvt_pk_bf16_f32 v140, v176, v177
  v_cvt_pk_bf16_f32 v133, v154, v155
  v_cvt_pk_bf16_f32 v141, v178, v179
  v_cvt_pk_bf16_f32 v134, v156, v157
  v_cvt_pk_bf16_f32 v142, v180, v181
  v_cvt_pk_bf16_f32 v135, v158, v159
  v_cvt_pk_bf16_f32 v143, v182, v183
  v_cndmask_b32 v16, 6, 48, s[0:1]
  s_waitcnt lgkmcnt(0)
  v_cmp_gt_u32 vcc, v16, v15
  s_nop 0
  s_cbranch_vccnz Llrf6_116
Lldf6_115:
  v_cvt_pk_bf16_f32 v136, v160, v161
  v_cvt_pk_bf16_f32 v144, v184, v185
  v_cvt_pk_bf16_f32 v137, v162, v163
  v_cvt_pk_bf16_f32 v145, v186, v187
  v_cvt_pk_bf16_f32 v138, v164, v165
  v_cvt_pk_bf16_f32 v146, v188, v189
  v_cvt_pk_bf16_f32 v139, v166, v167
  v_cvt_pk_bf16_f32 v147, v190, v191
  v_mov_b32 v0, 154816
  s_waitcnt lgkmcnt(0)
Lkvw_117:
  ds_read_b32 v15, v0 offset:4
  s_waitcnt lgkmcnt(0)
  v_cmp_gt_u32 vcc, 60, v15
  s_nop 0
  s_cbranch_vccz Lkvd_118
  s_sub_u32 s11, s11, 1
  s_cbranch_scc0 Lkvw_117
  s_mov_b32 s11, 0
Lkvd_118:
  s_setprio 2
  ds_read_b32 v9, v0 offset:8000
  ds_read_b128 v[92:95], v25 offset:0
  ds_read_b128 v[76:79], v24 offset:0
  ds_read_b128 v[80:83], v24 offset:1024
  ds_read_b128 v[96:99], v25 offset:2048
  ds_read_b128 v[84:87], v24 offset:2048
  ds_read_b128 v[88:91], v24 offset:3072
  s_waitcnt lgkmcnt(6)
  v_readfirstlane_b32 s10, v9
  s_waitcnt lgkmcnt(5)
  v_mfma_f32_16x16x32_bf16 v[108:111], v[92:95], v[132:135], 0
  v_mfma_f32_16x16x32_bf16 v[120:123], v[92:95], v[140:143], 0
  s_waitcnt lgkmcnt(4)
  v_mfma_f32_16x16x32_bf16 v[100:103], v[76:79], v[132:135], 0
  v_mfma_f32_16x16x32_bf16 v[112:115], v[76:79], v[140:143], 0
  s_waitcnt lgkmcnt(3)
  v_mfma_f32_16x16x32_bf16 v[104:107], v[80:83], v[132:135], 0
  v_mfma_f32_16x16x32_bf16 v[116:119], v[80:83], v[140:143], 0
  s_waitcnt lgkmcnt(2)
  v_mfma_f32_16x16x32_bf16 v[108:111], v[96:99], v[136:139], v[108:111]
  v_mfma_f32_16x16x32_bf16 v[120:123], v[96:99], v[144:147], v[120:123]
  s_waitcnt lgkmcnt(1)
  v_mfma_f32_16x16x32_bf16 v[100:103], v[84:87], v[136:139], v[100:103]
  v_mfma_f32_16x16x32_bf16 v[112:115], v[84:87], v[144:147], v[112:115]
  s_waitcnt lgkmcnt(0)
  v_mfma_f32_16x16x32_bf16 v[104:107], v[88:91], v[136:139], v[104:107]
  v_mfma_f32_16x16x32_bf16 v[116:119], v[88:91], v[144:147], v[116:119]
  s_nop 0
  v_add_f32 v108, 0x358637bd, v108
  v_add_f32 v120, 0x358637bd, v120
  v_rcp_f32 v108, v108
  v_rcp_f32 v120, v120
  v_pk_mul_f32 v[100:101], v[100:101], v[108:109] op_sel_hi:[1,0]
  v_pk_mul_f32 v[102:103], v[102:103], v[108:109] op_sel_hi:[1,0]
  v_pk_mul_f32 v[104:105], v[104:105], v[108:109] op_sel_hi:[1,0]
  v_pk_mul_f32 v[106:107], v[106:107], v[108:109] op_sel_hi:[1,0]
  v_cvt_pk_bf16_f32 v124, v100, v101
  v_cvt_pk_bf16_f32 v125, v102, v103
  v_cvt_pk_bf16_f32 v126, v104, v105
  v_cvt_pk_bf16_f32 v127, v106, v107
  v_pk_mul_f32 v[112:113], v[112:113], v[120:121] op_sel_hi:[1,0]
  v_pk_mul_f32 v[114:115], v[114:115], v[120:121] op_sel_hi:[1,0]
  v_pk_mul_f32 v[116:117], v[116:117], v[120:121] op_sel_hi:[1,0]
  v_pk_mul_f32 v[118:119], v[118:119], v[120:121] op_sel_hi:[1,0]
  v_cvt_pk_bf16_f32 v128, v112, v113
  v_cvt_pk_bf16_f32 v129, v114, v115
  v_cvt_pk_bf16_f32 v130, v116, v117
  v_cvt_pk_bf16_f32 v131, v118, v119
  v_permlane16_swap_b32 v124, v126
  v_permlane16_swap_b32 v125, v127
  v_permlane16_swap_b32 v128, v130
  v_permlane16_swap_b32 v129, v131
  s_cmp_lg_u32 s10, 0
  s_cbranch_scc1 Lslow_119
  buffer_store_dwordx2 v[124:125], v18, s[76:79], s86 offen
  buffer_store_dwordx2 v[126:127], v19, s[76:79], s86 offen
  buffer_store_dwordx2 v[128:129], v18, s[76:79], s87 offen
  buffer_store_dwordx2 v[130:131], v19, s[76:79], s87 offen
Lback_120:
  v_mov_b32 v16, 64
  ds_write_b32 v17, v16 offset:16
  s_setprio 0
  v_mov_b32 v11, v51
  v_mov_b32 v12, v48
  s_cmp_eq_u32 s7, 7
  s_cbranch_scc1 Lj7
  v_lshrrev_b32 v15, 5, v1
  v_lshlrev_b32 v15, 3, v15
  v_bfe_u32 v17, v1, 2, 2
  v_add_u32 v15, v15, v17
  v_and_b32 v16, 3, v1
  v_and_b32 v8, 1, v3
  v_lshlrev_b32 v8, 5, v8
  v_lshl_add_u32 v8, v16, 3, v8
  v_lshl_add_u32 v8, v15, 7, v8
  v_lshrrev_b32 v17, 1, v17
  v_lshl_add_u32 v8, v17, 6, v8
  s_and_b32 s12, s84, 1
  s_lshl_b32 s12, s12, 6
  v_xor_b32 v8, s12, v8
  s_lshr_b32 s12, s84, 1
  s_lshl_b32 s12, s12, 11
  s_add_u32 s12, s12, 114688
  v_add_u32 v8, s12, v8
  v_bfe_u32 v15, v1, 2, 2
  v_lshl_add_u32 v16, v3, 3, v15
  v_lshlrev_b32 v16, 7, v16
  v_and_b32 v17, 3, v1
  v_lshl_add_u32 v16, v17, 3, v16
  v_lshrrev_b32 v15, 1, v15
  v_and_b32 v17, 1, v3
  v_lshl_add_u32 v15, v17, 1, v15
  v_xor_b32 v15, s84, v15
  v_lshl_add_u32 v6, v15, 5, v16
  v_add_u32 v6, 57344, v6
  v_mov_b32 v244, 0x3f803f80
  v_mov_b32 v245, 0x3f803f80
  v_mov_b32 v246, 0x3f803f80
  v_mov_b32 v247, 0x3f803f80
  v_lshrrev_b32 v15, 2, v2
  v_and_b32 v16, 1, v3
  v_cmp_eq_u32 vcc, v15, v16
  v_mov_b32 v15, 0x3f803f80
  s_nop 0
  v_cndmask_b32 v232, 0, v15, vcc
  v_cndmask_b32 v233, 0, v15, vcc
  v_cndmask_b32 v234, 0, v15, vcc
  v_cndmask_b32 v235, 0, v15, vcc
  s_waitcnt vmcnt(0)
  s_cmp_lg_u32 s10, 0
  s_cbranch_scc1 Lslow_121
  buffer_store_dword v27, v14, s[76:79], 0 offen
Lback_122:
  s_lshl_b32 s12, s8, 2
  s_add_u32 s12, s12, 159744
  v_mov_b32 v220, s12
  v_and_b32 v221, 7, v1
  v_lshlrev_b32 v221, 2, v221
  v_add_u32 v221, 159744, v221
  s_mul_i32 s12, s84, 224
  s_add_u32 s12, s12, 154816
  v_mov_b32 v17, s12
  s_waitcnt vmcnt(0)
  v_mov_b32 v16, 8
  ds_write_b32 v17, v16 offset:0
  ds_read_b32 v15, v47
  v_cndmask_b32 v16, 8, 60, s[0:1]
  s_waitcnt lgkmcnt(0)
  v_cmp_gt_u32 vcc, v16, v15
  s_nop 0
  s_cbranch_vccnz Llrf8_124
Lldf8_123:
  ds_read_b64_tr_b16 v[32:33], v8 offset:0
  ds_read_b64_tr_b16 v[34:35], v8 offset:512
  ds_read_b64_tr_b16 v[36:37], v8 offset:4096
  ds_read_b64_tr_b16 v[38:39], v8 offset:4608
  ds_read_b64_tr_b16 v[40:41], v8 offset:8192
  ds_read_b64_tr_b16 v[42:43], v8 offset:8704
  ds_read_b64_tr_b16 v[44:45], v8 offset:12288
  ds_read_b64_tr_b16 v[46:47], v8 offset:12800
  ds_read_b64_tr_b16 v[48:49], v8 offset:16384
  ds_read_b64_tr_b16 v[50:51], v8 offset:16896
  ds_read_b64_tr_b16 v[52:53], v8 offset:20480
  ds_read_b64_tr_b16 v[54:55], v8 offset:20992
  ds_read_b64_tr_b16 v[56:57], v8 offset:24576
  ds_read_b64_tr_b16 v[58:59], v8 offset:25088
  ds_read_b64_tr_b16 v[60:61], v8 offset:28672
  ds_read_b64_tr_b16 v[62:63], v8 offset:29184
  ds_read_b64_tr_b16 v[64:65], v8 offset:32768
  ds_read_b64_tr_b16 v[66:67], v8 offset:33280
  ds_read_b64_tr_b16 v[144:145], v6 offset:0
  ds_read_b64_tr_b16 v[146:147], v6 offset:512
  ds_read_b64_tr_b16 v[148:149], v6 offset:4096
  ds_read_b64_tr_b16 v[150:151], v6 offset:4608
  ds_read_b64_tr_b16 v[152:153], v6 offset:8192
  ds_read_b64_tr_b16 v[154:155], v6 offset:8704
  ds_read_b64_tr_b16 v[156:157], v6 offset:12288
  ds_read_b64_tr_b16 v[158:159], v6 offset:12800
  ds_read_b64_tr_b16 v[160:161], v6 offset:16384
  ds_read_b64_tr_b16 v[162:163], v6 offset:16896
  ds_read_b64_tr_b16 v[164:165], v6 offset:20480
  ds_read_b64_tr_b16 v[166:167], v6 offset:20992
  ds_read_b64_tr_b16 v[168:169], v6 offset:24576
  ds_read_b64_tr_b16 v[170:171], v6 offset:25088
  ds_read_b64_tr_b16 v[172:173], v6 offset:28672
  ds_read_b64_tr_b16 v[174:175], v6 offset:29184
  ds_read_b64_tr_b16 v[176:177], v6 offset:32768
  ds_read_b64_tr_b16 v[178:179], v6 offset:33280
  ds_read_b64_tr_b16 v[180:181], v6 offset:36864
  ds_read_b64_tr_b16 v[182:183], v6 offset:37376
  ds_read_b64_tr_b16 v[184:185], v6 offset:40960
  ds_read_b64_tr_b16 v[186:187], v6 offset:41472
  ds_read_b64_tr_b16 v[188:189], v6 offset:45056
  ds_read_b64_tr_b16 v[190:191], v6 offset:45568
  ds_read_b64_tr_b16 v[192:193], v6 offset:49152
  ds_read_b64_tr_b16 v[194:195], v6 offset:49664
  ds_read_b64_tr_b16 v[196:197], v6 offset:53248
  ds_read_b64_tr_b16 v[198:199], v6 offset:53760
  s_waitcnt lgkmcnt(15)
  v_mfma_f32_16x16x32_bf16 v[248:251], v[244:247], v[144:147], 0
  s_waitcnt lgkmcnt(15)
  v_mfma_f32_16x16x32_bf16 v[248:251], v[244:247], v[148:151], v[248:251]
  s_waitcnt lgkmcnt(15)
  v_mfma_f32_16x16x32_bf16 v[248:251], v[244:247], v[152:155], v[248:251]
  s_waitcnt lgkmcnt(15)
  v_mfma_f32_16x16x32_bf16 v[248:251], v[244:247], v[156:159], v[248:251]
  s_waitcnt lgkmcnt(15)
  v_mfma_f32_16x16x32_bf16 v[248:251], v[244:247], v[160:163], v[248:251]
  s_waitcnt lgkmcnt(15)
  v_mfma_f32_16x16x32_bf16 v[248:251], v[244:247], v[164:167], v[248:251]
  s_waitcnt lgkmcnt(14)
  v_mfma_f32_16x16x32_bf16 v[248:251], v[244:247], v[168:171], v[248:251]
  s_waitcnt lgkmcnt(12)
  v_mfma_f32_16x16x32_bf16 v[248:251], v[244:247], v[172:175], v[248:251]
  s_waitcnt lgkmcnt(10)
  v_mfma_f32_16x16x32_bf16 v[248:251], v[244:247], v[176:179], v[248:251]
  s_waitcnt lgkmcnt(8)
  v_mfma_f32_16x16x32_bf16 v[248:251], v[244:247], v[180:183], v[248:251]
  s_waitcnt lgkmcnt(6)
  v_mfma_f32_16x16x32_bf16 v[248:251], v[244:247], v[184:187], v[248:251]
  s_waitcnt lgkmcnt(4)
  v_mfma_f32_16x16x32_bf16 v[248:251], v[244:247], v[188:191], v[248:251]
  s_waitcnt lgkmcnt(2)
  v_mfma_f32_16x16x32_bf16 v[248:251], v[244:247], v[192:195], v[248:251]
  s_waitcnt lgkmcnt(0)
  v_mfma_f32_16x16x32_bf16 v[248:251], v[244:247], v[196:199], v[248:251]
  v_mfma_f32_16x16x32_bf16 v[236:239], v[232:235], v[32:35], 0
  v_mfma_f32_16x16x32_bf16 v[236:239], v[232:235], v[36:39], v[236:239]
  v_mfma_f32_16x16x32_bf16 v[236:239], v[232:235], v[40:43], v[236:239]
  v_mfma_f32_16x16x32_bf16 v[236:239], v[232:235], v[44:47], v[236:239]
  v_mfma_f32_16x16x32_bf16 v[236:239], v[232:235], v[48:51], v[236:239]
  v_mfma_f32_16x16x32_bf16 v[236:239], v[232:235], v[52:55], v[236:239]
  v_mfma_f32_16x16x32_bf16 v[236:239], v[232:235], v[56:59], v[236:239]
  v_mfma_f32_16x16x32_bf16 v[236:239], v[232:235], v[60:63], v[236:239]
  v_mfma_f32_16x16x32_bf16 v[236:239], v[232:235], v[64:67], v[236:239]
  s_lshl_b32 s12, s84, 6
  s_add_u32 s12, s12, 163328
  v_lshlrev_b32 v15, 2, v2
  v_add_u32 v15, s12, v15
  ds_write_b32 v15, v248
  v_mov_b32 v222, 1
  ds_write_b32 v220, v222
  v_mov_b32 v225, v12
  s_mul_i32 s12, s84, 14336
  s_add_u32 s12, s12, s80
  s_lshl_b32 s13, s7, 11
  s_add_u32 s12, s12, s13
  v_add_u32 v230, s12, v4
  v_mov_b32 v226, -1
  v_mov_b32 v227, -1
  v_mov_b32 v228, -1
  v_mov_b32 v229, -1
  s_mov_b32 s96, 71680
  s_mov_b32 s97, 0
  ds_read_b32 v223, v221
  v_cndmask_b32 v224, 2, 1, s[0:1]
  s_waitcnt lgkmcnt(0)
  v_cmp_gt_u32 vcc, v224, v223
  s_nop 0
  s_cbranch_vccnz Llrg_126
Lldg_125:
  s_add_u32 m0, s95, 114688
  s_mov_b32 s13, 516096
  buffer_load_dwordx4 v225, s[64:67], s13 offen lds
  s_add_u32 m0, s95, 118784
  s_mov_b32 s13, 573440
  buffer_load_dwordx4 v225, s[64:67], s13 offen lds
  s_add_u32 m0, s95, 122880
  s_mov_b32 s13, 630784
  buffer_load_dwordx4 v225, s[64:67], s13 offen lds
  s_add_u32 m0, s95, 126976
  s_mov_b32 s13, 688128
  buffer_load_dwordx4 v225, s[64:67], s13 offen lds
  s_add_u32 m0, s95, 131072
  s_mov_b32 s13, 745472
  buffer_load_dwordx4 v225, s[64:67], s13 offen lds
  s_add_u32 m0, s95, 135168
  s_mov_b32 s13, 802816
  buffer_load_dwordx4 v225, s[64:67], s13 offen lds
  s_add_u32 m0, s95, 139264
  s_mov_b32 s13, 860160
  buffer_load_dwordx4 v225, s[64:67], s13 offen lds
  s_add_u32 m0, s95, 143360
  s_mov_b32 s13, 917504
  buffer_load_dwordx4 v225, s[64:67], s13 offen lds
  s_add_u32 m0, s95, 147456
  s_mov_b32 s13, 974848
  buffer_load_dwordx4 v225, s[64:67], s13 offen lds
  s_add_u32 m0, s95, 151552
  s_mov_b32 s13, 1032192
  buffer_load_dwordx4 v225, s[64:67], s13 offen lds
  s_add_u32 m0, s95, 155648
  s_mov_b32 s13, 1089536
  buffer_load_dwordx4 v225, s[64:67], s13 offen lds
  s_add_u32 m0, s95, 36864
  s_mov_b32 s13, 1146880
  buffer_load_dwordx4 v225, s[64:67], s13 offen lds
  s_add_u32 m0, s95, 0
  s_mov_b32 s13, 0
  buffer_load_dwordx4 v11, s[60:63], s13 offen lds
  s_add_u32 m0, s95, 4096
  s_mov_b32 s13, 28672
  buffer_load_dwordx4 v11, s[60:63], s13 offen lds
  s_add_u32 m0, s95, 8192
  s_mov_b32 s13, 57344
  buffer_load_dwordx4 v11, s[60:63], s13 offen lds
  s_add_u32 m0, s95, 12288
  s_mov_b32 s13, 86016
  buffer_load_dwordx4 v11, s[60:63], s13 offen lds
  s_waitcnt vmcnt(4)
  v_mov_b32 v222, 2
  ds_write_b32 v220, v222
  ds_read_b32 v223, v221
  v_cndmask_b32 v224, 0, 2, s[0:1]
  s_waitcnt lgkmcnt(0)
  v_cmp_gt_u32 vcc, v224, v223
  s_nop 0
  s_cbranch_vccnz Llrg_128
Lldg_127:
  ds_read_b64_tr_b16 v[68:69], v8 offset:0
  ds_read_b64_tr_b16 v[70:71], v8 offset:512
  ds_read_b64_tr_b16 v[72:73], v8 offset:4096
  ds_read_b64_tr_b16 v[74:75], v8 offset:4608
  ds_read_b64_tr_b16 v[76:77], v8 offset:8192
  ds_read_b64_tr_b16 v[78:79], v8 offset:8704
  ds_read_b64_tr_b16 v[80:81], v8 offset:12288
  ds_read_b64_tr_b16 v[82:83], v8 offset:12800
  ds_read_b64_tr_b16 v[84:85], v8 offset:16384
  ds_read_b64_tr_b16 v[86:87], v8 offset:16896
  ds_read_b64_tr_b16 v[88:89], v8 offset:20480
  ds_read_b64_tr_b16 v[90:91], v8 offset:20992
  ds_read_b64_tr_b16 v[92:93], v8 offset:24576
  ds_read_b64_tr_b16 v[94:95], v8 offset:25088
  ds_read_b64_tr_b16 v[96:97], v8 offset:28672
  ds_read_b64_tr_b16 v[98:99], v8 offset:29184
  ds_read_b64_tr_b16 v[100:101], v8 offset:32768
  ds_read_b64_tr_b16 v[102:103], v8 offset:33280
  ds_read_b64_tr_b16 v[104:105], v8 offset:36864
  ds_read_b64_tr_b16 v[106:107], v8 offset:37376
  ds_read_b64_tr_b16 v[108:109], v8 offset:40960
  ds_read_b64_tr_b16 v[110:111], v8 offset:41472
  v_subrev_u32 v15, 114688, v8
  ds_read_b64_tr_b16 v[112:113], v15 offset:36864
  ds_read_b64_tr_b16 v[114:115], v15 offset:37376
  s_waitcnt lgkmcnt(15)
  v_mfma_f32_16x16x32_bf16 v[236:239], v[232:235], v[68:71], v[236:239]
  s_waitcnt lgkmcnt(15)
  v_mfma_f32_16x16x32_bf16 v[236:239], v[232:235], v[72:75], v[236:239]
  s_waitcnt lgkmcnt(15)
  v_mfma_f32_16x16x32_bf16 v[236:239], v[232:235], v[76:79], v[236:239]
  s_waitcnt lgkmcnt(15)
  v_mfma_f32_16x16x32_bf16 v[236:239], v[232:235], v[80:83], v[236:239]
  s_waitcnt lgkmcnt(14)
  v_mfma_f32_16x16x32_bf16 v[236:239], v[232:235], v[84:87], v[236:239]
  s_waitcnt lgkmcnt(12)
  v_mfma_f32_16x16x32_bf16 v[236:239], v[232:235], v[88:91], v[236:239]
  s_waitcnt lgkmcnt(10)
  v_mfma_f32_16x16x32_bf16 v[236:239], v[232:235], v[92:95], v[236:239]
  s_waitcnt lgkmcnt(8)
  v_mfma_f32_16x16x32_bf16 v[236:239], v[232:235], v[96:99], v[236:239]
  s_waitcnt lgkmcnt(6)
  v_mfma_f32_16x16x32_bf16 v[236:239], v[232:235], v[100:103], v[236:239]
  s_waitcnt lgkmcnt(4)
  v_mfma_f32_16x16x32_bf16 v[236:239], v[232:235], v[104:107], v[236:239]
  s_waitcnt lgkmcnt(2)
  v_mfma_f32_16x16x32_bf16 v[236:239], v[232:235], v[108:111], v[236:239]
  s_waitcnt lgkmcnt(0)
  v_mfma_f32_16x16x32_bf16 v[236:239], v[232:235], v[112:115], v[236:239]
  v_mov_b32 v222, 3
  ds_write_b32 v220, v222
  ds_read_b32 v223, v221
  v_cndmask_b32 v224, 4, 3, s[0:1]
  s_waitcnt lgkmcnt(0)
  v_cmp_gt_u32 vcc, v224, v223
  s_nop 0
  s_cbranch_vccnz Llrg_130
Lldg_129:
  s_add_u32 m0, s95, 16384
  s_mov_b32 s13, 114688
  buffer_load_dwordx4 v11, s[60:63], s13 offen lds
  s_add_u32 m0, s95, 20480
  s_mov_b32 s13, 143360
  buffer_load_dwordx4 v11, s[60:63], s13 offen lds
  s_add_u32 m0, s95, 24576
  s_mov_b32 s13, 172032
  buffer_load_dwordx4 v11, s[60:63], s13 offen lds
  s_add_u32 m0, s95, 28672
  s_mov_b32 s13, 200704
  buffer_load_dwordx4 v11, s[60:63], s13 offen lds
  s_add_u32 m0, s95, 32768
  s_mov_b32 s13, 229376
  buffer_load_dwordx4 v11, s[60:63], s13 offen lds
  s_add_u32 m0, s95, 36864
  s_mov_b32 s13, 258048
  buffer_load_dwordx4 v11, s[60:63], s13 offen lds
  s_add_u32 m0, s95, 40960
  s_mov_b32 s13, 286720
  buffer_load_dwordx4 v11, s[60:63], s13 offen lds
  s_add_u32 m0, s95, 45056
  s_mov_b32 s13, 315392
  buffer_load_dwordx4 v11, s[60:63], s13 offen lds
  s_add_u32 m0, s95, 49152
  s_mov_b32 s13, 344064
  buffer_load_dwordx4 v11, s[60:63], s13 offen lds
  s_add_u32 m0, s95, 53248
  s_mov_b32 s13, 372736
  buffer_load_dwordx4 v11, s[60:63], s13 offen lds
  s_add_u32 m0, s95, 126976
  s_mov_b32 s13, 1204224
  buffer_load_dwordx4 v225, s[64:67], s13 offen lds
  s_add_u32 m0, s95, 131072
  s_mov_b32 s13, 1261568
  buffer_load_dwordx4 v225, s[64:67], s13 offen lds
  s_add_u32 m0, s95, 135168
  s_mov_b32 s13, 1318912
  buffer_load_dwordx4 v225, s[64:67], s13 offen lds
  s_add_u32 m0, s95, 139264
  s_mov_b32 s13, 1376256
  buffer_load_dwordx4 v225, s[64:67], s13 offen lds
  s_waitcnt vmcnt(4)
  v_mov_b32 v222, 4
  ds_write_b32 v220, v222
  s_add_u32 m0, s95, 143360
  s_mov_b32 s13, 1433600
  buffer_load_dwordx4 v225, s[64:67], s13 offen lds
  s_add_u32 m0, s95, 147456
  s_mov_b32 s13, 1490944
  buffer_load_dwordx4 v225, s[64:67], s13 offen lds
  s_add_u32 m0, s95, 151552
  s_mov_b32 s13, 1548288
  buffer_load_dwordx4 v225, s[64:67], s13 offen lds
  s_add_u32 m0, s95, 114688
  s_mov_b32 s13, 256
  buffer_load_dwordx4 v225, s[64:67], s13 offen lds
  s_add_u32 m0, s95, 57344
  s_mov_b32 s13, 172288
  buffer_load_dwordx4 v225, s[64:67], s13 offen lds
  s_add_u32 m0, s95, 61440
  s_mov_b32 s13, 229632
  buffer_load_dwordx4 v225, s[64:67], s13 offen lds
  s_add_u32 m0, s95, 65536
  s_mov_b32 s13, 286976
  buffer_load_dwordx4 v225, s[64:67], s13 offen lds
  s_add_u32 m0, s95, 69632
  s_mov_b32 s13, 344320
  buffer_load_dwordx4 v225, s[64:67], s13 offen lds
  s_add_u32 m0, s95, 73728
  s_mov_b32 s13, 401664
  buffer_load_dwordx4 v225, s[64:67], s13 offen lds
  s_add_u32 m0, s95, 77824
  s_mov_b32 s13, 459008
  buffer_load_dwordx4 v225, s[64:67], s13 offen lds
  s_add_u32 m0, s95, 81920
  s_mov_b32 s13, 516352
  buffer_load_dwordx4 v225, s[64:67], s13 offen lds
  s_add_u32 m0, s95, 86016
  s_mov_b32 s13, 573696
  buffer_load_dwordx4 v225, s[64:67], s13 offen lds
  ds_read_b32 v223, v221
  v_cndmask_b32 v224, 5, 0, s[0:1]
  s_waitcnt lgkmcnt(0)
  v_cmp_gt_u32 vcc, v224, v223
  s_nop 0
  s_cbranch_vccnz Llrg_132
Lldg_131:
  s_add_u32 m0, s95, 0
  s_mov_b32 s13, 975104
  buffer_load_dwordx4 v225, s[64:67], s13 offen lds
  s_add_u32 m0, s95, 4096
  s_mov_b32 s13, 1032448
  buffer_load_dwordx4 v225, s[64:67], s13 offen lds
  s_add_u32 m0, s95, 8192
  s_mov_b32 s13, 1089792
  buffer_load_dwordx4 v225, s[64:67], s13 offen lds
  s_add_u32 m0, s95, 12288
  s_mov_b32 s13, 1147136
  buffer_load_dwordx4 v225, s[64:67], s13 offen lds
  s_add_u32 m0, s95, 16384
  s_mov_b32 s13, 1204480
  buffer_load_dwordx4 v225, s[64:67], s13 offen lds
  s_add_u32 m0, s95, 20480
  s_mov_b32 s13, 1261824
  buffer_load_dwordx4 v225, s[64:67], s13 offen lds
  s_add_u32 m0, s95, 24576
  s_mov_b32 s13, 1319168
  buffer_load_dwordx4 v225, s[64:67], s13 offen lds
  v_mov_b32 v218, 0
  v_mov_b32 v219, 0
  v_mov_b32 v226, v8
  s_lshl_b32 s96, s84, 11
  s_mul_i32 s12, s84, 28672
  s_lshl_b32 s13, s7, 7
  s_add_u32 s12, s12, s13
  v_lshrrev_b32 v15, 3, v1
  v_mul_u32_u24 v7, 896, v15
  v_bfe_u32 v15, v1, 4, 1
  v_lshlrev_b32 v15, 2, v15
  v_and_b32 v16, 7, v1
  v_xor_b32 v15, v15, v16
  v_lshl_add_u32 v7, v15, 4, v7
  v_add_u32 v7, s12, v7
  v_add_u32 v8, 6144, v7
  v_lshrrev_b32 v15, 5, v1
  v_bfe_u32 v16, v1, 2, 2
  v_lshl_add_u32 v15, v15, 2, v16
  v_and_b32 v5, 1, v3
  v_lshlrev_b32 v5, 5, v5
  v_and_b32 v16, 3, v1
  v_lshl_add_u32 v5, v16, 3, v5
  v_lshl_add_u32 v5, v15, 7, v5
  v_bfe_u32 v16, v1, 3, 1
  v_lshl_add_u32 v5, v16, 6, v5
  v_add_u32 v5, s96, v5
  v_add_u32 v5, 57344, v5
  v_xor_b32 v6, 64, v5
  s_and_b32 s12, s84, 1
  s_lshl_b32 s12, s12, 12
  s_lshr_b32 s13, s84, 1
  s_mul_i32 s13, s13, 57344
  s_add_u32 s12, s12, s13
  s_add_u32 s12, s12, s80
  s_add_u32 s12, s12, 215040
  v_add_u32 v9, s12, v4
  s_lshl_b32 s12, s84, 5
  s_add_u32 s12, s12, s80
  s_add_u32 s12, s12, 200960
  v_min_u32 v15, 6, v1
  v_lshlrev_b32 v15, 2, v15
  v_add_u32 v10, s12, v15
  s_lshl_b32 s13, s7, 2
  s_add_u32 s12, s12, s13
  v_add_u32 v11, s12, v21
  s_lshl_b32 s12, s84, 12
  s_add_u32 s12, s12, 57344
  v_and_b32 v253, 7, v1
  v_lshrrev_b32 v254, 5, v1
  v_xor_b32 v253, v253, v254
  v_and_b32 v252, 31, v1
  v_lshlrev_b32 v252, 7, v252
  v_lshl_add_u32 v252, v253, 4, v252
  v_add_u32 v252, s12, v252
  v_xor_b32 v253, 32, v252
  v_xor_b32 v254, 64, v252
  v_xor_b32 v255, 96, v252
  v_mov_b32 v13, s9
  s_lshl_b32 s12, s84, 3
  v_lshrrev_b32 v15, 3, v1
  v_add_u32 v15, s12, v15
  v_and_b32 v16, 7, v15
  v_and_b32 v17, 7, v1
  v_xor_b32 v16, v16, v17
  v_lshlrev_b32 v16, 4, v16
  v_lshl_add_u32 v14, v15, 7, v16
  s_lshl_b32 s12, s6, 6
  v_add_u32 v15, s12, v15
  v_mul_u32_u24 v15, 896, v15
  v_lshl_add_u32 v12, v17, 3, v15
  s_lshl_b32 s98, s7, 7
  s_add_u32 s99, s98, 28672
  v_bfe_u32 v15, v1, 4, 1
  v_mul_u32_u24 v24, 14336, v15
  v_lshl_add_u32 v24, v2, 4, v24
  v_lshrrev_b32 v16, 5, v1
  v_lshl_add_u32 v24, v16, 8, v24
  v_and_b32 v25, 31, v1
  v_lshlrev_b32 v25, 5, v25
  v_add_u32 v25, 160256, v25
  ds_read_b32 v223, v221
  v_cndmask_b32 v224, 6, 0, s[0:1]
  s_waitcnt lgkmcnt(0)
  v_cmp_gt_u32 vcc, v224, v223
  s_nop 0
  s_cbranch_vccnz Llrg_134
Lldg_133:
  s_add_u32 m0, s95, 118784
  s_mov_b32 s13, 57600
  buffer_load_dwordx4 v225, s[64:67], s13 offen lds
  s_add_u32 m0, s95, 122880
  s_mov_b32 s13, 114944
  buffer_load_dwordx4 v225, s[64:67], s13 offen lds
  s_add_u32 m0, s95, 28672
  s_mov_b32 s13, 1376512
  buffer_load_dwordx4 v225, s[64:67], s13 offen lds
  s_add_u32 m0, s95, 32768
  s_mov_b32 s13, 1433856
  buffer_load_dwordx4 v225, s[64:67], s13 offen lds
  s_add_u32 m0, s95, 36864
  s_mov_b32 s13, 1491200
  buffer_load_dwordx4 v225, s[64:67], s13 offen lds
  s_add_u32 m0, s95, 155648
  s_mov_b32 s13, 1548544
  buffer_load_dwordx4 v225, s[64:67], s13 offen lds
  s_add_u32 m0, s95, 90112
  s_mov_b32 s13, 631040
  buffer_load_dwordx4 v225, s[64:67], s13 offen lds
  s_add_u32 m0, s95, 94208
  s_mov_b32 s13, 688384
  buffer_load_dwordx4 v225, s[64:67], s13 offen lds
  s_add_u32 m0, s95, 98304
  s_mov_b32 s13, 745728
  buffer_load_dwordx4 v225, s[64:67], s13 offen lds
  s_add_u32 m0, s95, 102400
  s_mov_b32 s13, 803072
  buffer_load_dwordx4 v225, s[64:67], s13 offen lds
  s_add_u32 m0, s95, 106496
  s_mov_b32 s13, 860416
  buffer_load_dwordx4 v225, s[64:67], s13 offen lds
  s_add_u32 m0, s95, 110592
  s_mov_b32 s13, 917760
  buffer_load_dwordx4 v225, s[64:67], s13 offen lds
  s_waitcnt vmcnt(6)
  s_barrier
  ds_read_b64_tr_b16 v[116:117], v226 offset:12288
  ds_read_b64_tr_b16 v[118:119], v226 offset:12800
  ds_read_b64_tr_b16 v[120:121], v226 offset:16384
  ds_read_b64_tr_b16 v[122:123], v226 offset:16896
  ds_read_b64_tr_b16 v[124:125], v226 offset:20480
  ds_read_b64_tr_b16 v[126:127], v226 offset:20992
  ds_read_b64_tr_b16 v[128:129], v226 offset:24576
  ds_read_b64_tr_b16 v[130:131], v226 offset:25088
  ds_read_b64_tr_b16 v[132:133], v226 offset:28672
  ds_read_b64_tr_b16 v[134:135], v226 offset:29184
  ds_read_b64_tr_b16 v[136:137], v226 offset:32768
  ds_read_b64_tr_b16 v[138:139], v226 offset:33280
  ds_read_b64_tr_b16 v[140:141], v226 offset:36864
  ds_read_b64_tr_b16 v[142:143], v226 offset:37376
  s_mul_i32 s92, s7, 229376
  s_sub_u32 s93, s92, 1605632
  s_lshl_b32 s94, s7, 13
  s_sub_u32 s95, s94, 57344
  s_mul_i32 s12, s84, 7168
  s_add_u32 s12, s12, s80
  v_add_u32 v18, s12, v4
  s_mul_i32 s12, s84, 7168
  v_and_b32 v19, 60, v1
  v_lshl_add_u32 v19, v1, 6, v19
  v_add_u32 v19, s12, v19
  s_setprio 2
  s_waitcnt vmcnt(0) lgkmcnt(0)
  s_barrier
  s_mul_i32 s12, s84, 7168
  s_mov_b32 s13, 0
  s_add_u32 m0, s12, 0
  s_nop 0
  buffer_load_dwordx4 v18, s[76:79], s13 offen offset:0 sc1 lds
  buffer_load_dwordx4 v18, s[76:79], s13 offen offset:1024 sc1 lds
  buffer_load_dwordx4 v18, s[76:79], s13 offen offset:2048 sc1 lds
  buffer_load_dwordx4 v18, s[76:79], s13 offen offset:3072 sc1 lds
  s_mov_b32 s13, 4096
  s_add_u32 m0, s12, 4096
  s_nop 0
  buffer_load_dwordx4 v18, s[76:79], s13 offen offset:0 sc1 lds
  buffer_load_dwordx4 v18, s[76:79], s13 offen offset:1024 sc1 lds
  buffer_load_dwordx4 v18, s[76:79], s13 offen offset:2048 sc1 lds
  v_mfma_f32_16x16x32_bf16 v[236:239], v[232:235], v[116:119], v[236:239]
  v_mfma_f32_16x16x32_bf16 v[236:239], v[232:235], v[120:123], v[236:239]
  v_mfma_f32_16x16x32_bf16 v[236:239], v[232:235], v[124:127], v[236:239]
  v_mfma_f32_16x16x32_bf16 v[236:239], v[232:235], v[128:131], v[236:239]
  v_mfma_f32_16x16x32_bf16 v[236:239], v[232:235], v[132:135], v[236:239]
  v_mfma_f32_16x16x32_bf16 v[236:239], v[232:235], v[136:139], v[236:239]
  v_mfma_f32_16x16x32_bf16 v[236:239], v[232:235], v[140:143], v[236:239]
  s_nop 7
  v_cvt_pk_bf16_f32 v217, v236, v236
  v_and_b32 v237, 0xffff0000, v217
  v_sub_f32 v237, v236, v237
  v_cvt_pk_bf16_f32 v216, v236, v237
  v_or_b32 v15, 3, v13
  s_waitcnt vmcnt(0)
  ds_read_b32 v16, v19 offset:0
  ds_read_b32 v17, v19 offset:3072
  s_waitcnt lgkmcnt(0)
  v_max_u32 v16, v16, v17
  v_cmp_eq_u32 vcc, -1, v16
  s_nop 0
  s_cbranch_vccnz Lxr_136
Lxd_135:
  v_mov_b32 v222, 5
  ds_write_b32 v220, v222
  ds_read_b32 v223, v221
  v_cndmask_b32 v224, 0, 5, s[0:1]
  s_waitcnt lgkmcnt(0)
  v_cmp_gt_u32 vcc, v224, v223
  s_nop 0
  s_cbranch_vccnz Llrg_138
Lldg_137:
  ds_read_b128 v[176:179], v24 offset:0
  ds_read_b128 v[180:183], v24 offset:512
  ds_read_b128 v[184:187], v24 offset:1024
  s_setprio 2
  ds_read_b128 v[188:191], v24 offset:1536
  s_waitcnt lgkmcnt(3)
  v_mfma_f32_32x32x16_bf16 v[144:159], v[32:35], v[176:179], 0
  ds_read_b128 v[176:179], v24 offset:2048
  s_waitcnt lgkmcnt(3)
  v_mfma_f32_32x32x16_bf16 v[144:159], v[36:39], v[180:183], v[144:159]
  ds_read_b128 v[180:183], v24 offset:2560
  s_waitcnt lgkmcnt(3)
  v_mfma_f32_32x32x16_bf16 v[144:159], v[40:43], v[184:187], v[144:159]
  ds_read_b128 v[184:187], v24 offset:3072
  s_waitcnt lgkmcnt(3)
  v_mfma_f32_32x32x16_bf16 v[144:159], v[44:47], v[188:191], v[144:159]
  ds_read_b128 v[188:191], v24 offset:3584
  s_waitcnt lgkmcnt(3)
  v_mfma_f32_32x32x16_bf16 v[144:159], v[48:51], v[176:179], v[144:159]
  ds_read_b128 v[176:179], v24 offset:4096
  s_waitcnt lgkmcnt(3)
  v_mfma_f32_32x32x16_bf16 v[144:159], v[52:55], v[180:183], v[144:159]
  ds_read_b128 v[180:183], v24 offset:4608
  s_waitcnt lgkmcnt(3)
  v_mfma_f32_32x32x16_bf16 v[144:159], v[56:59], v[184:187], v[144:159]
  ds_read_b128 v[184:187], v24 offset:5120
  s_waitcnt lgkmcnt(3)
  v_mfma_f32_32x32x16_bf16 v[144:159], v[60:63], v[188:191], v[144:159]
  ds_read_b128 v[188:191], v24 offset:5632
  s_waitcnt lgkmcnt(3)
  v_mfma_f32_32x32x16_bf16 v[144:159], v[64:67], v[176:179], v[144:159]
  ds_read_b128 v[176:179], v24 offset:6144
  s_waitcnt lgkmcnt(3)
  v_mfma_f32_32x32x16_bf16 v[144:159], v[68:71], v[180:183], v[144:159]
  ds_read_b128 v[180:183], v24 offset:6656
  s_waitcnt lgkmcnt(3)
  v_mfma_f32_32x32x16_bf16 v[144:159], v[72:75], v[184:187], v[144:159]
  ds_read_b128 v[184:187], v24 offset:7168
  s_waitcnt lgkmcnt(3)
  v_mfma_f32_32x32x16_bf16 v[144:159], v[76:79], v[188:191], v[144:159]
  ds_read_b128 v[188:191], v24 offset:7680
  s_waitcnt lgkmcnt(3)
  v_mfma_f32_32x32x16_bf16 v[144:159], v[80:83], v[176:179], v[144:159]
  ds_read_b128 v[176:179], v24 offset:8192
  s_waitcnt lgkmcnt(3)
  v_mfma_f32_32x32x16_bf16 v[144:159], v[84:87], v[180:183], v[144:159]
  ds_read_b128 v[180:183], v24 offset:8704
  s_waitcnt lgkmcnt(3)
  v_mfma_f32_32x32x16_bf16 v[144:159], v[88:91], v[184:187], v[144:159]
  ds_read_b128 v[184:187], v24 offset:9216
  s_waitcnt lgkmcnt(3)
  v_mfma_f32_32x32x16_bf16 v[144:159], v[92:95], v[188:191], v[144:159]
  ds_read_b128 v[188:191], v24 offset:9728
  s_waitcnt lgkmcnt(3)
  v_mfma_f32_32x32x16_bf16 v[144:159], v[96:99], v[176:179], v[144:159]
  ds_read_b128 v[176:179], v24 offset:10240
  s_waitcnt lgkmcnt(3)
  v_mfma_f32_32x32x16_bf16 v[144:159], v[100:103], v[180:183], v[144:159]
  ds_read_b128 v[180:183], v24 offset:10752
  s_waitcnt lgkmcnt(3)
  v_mfma_f32_32x32x16_bf16 v[144:159], v[104:107], v[184:187], v[144:159]
  ds_read_b128 v[184:187], v24 offset:11264
  s_waitcnt lgkmcnt(3)
  v_mfma_f32_32x32x16_bf16 v[144:159], v[108:111], v[188:191], v[144:159]
  ds_read_b128 v[188:191], v24 offset:11776
  s_waitcnt lgkmcnt(3)
  v_mfma_f32_32x32x16_bf16 v[144:159], v[112:115], v[176:179], v[144:159]
  ds_read_b128 v[176:179], v24 offset:12288
  s_waitcnt lgkmcnt(3)
  v_mfma_f32_32x32x16_bf16 v[144:159], v[116:119], v[180:183], v[144:159]
  ds_read_b128 v[180:183], v24 offset:12800
  s_waitcnt lgkmcnt(3)
  v_mfma_f32_32x32x16_bf16 v[144:159], v[120:123], v[184:187], v[144:159]
  ds_read_b32 v223, v221
  ds_read_b128 v[184:187], v24 offset:13312
  s_waitcnt lgkmcnt(4)
  v_mfma_f32_32x32x16_bf16 v[144:159], v[124:127], v[188:191], v[144:159]
  ds_read_b128 v[188:191], v24 offset:13824
  s_waitcnt lgkmcnt(4)
  v_mfma_f32_32x32x16_bf16 v[144:159], v[128:131], v[176:179], v[144:159]
  v_cndmask_b32 v224, 8, 0, s[0:1]
  s_waitcnt lgkmcnt(2)
  v_cmp_gt_u32 vcc, v224, v223
  s_nop 0
  s_cbranch_vccnz Llrg_140
Lldg_139:
  ds_read_b128 v[176:179], v25 offset:0
  v_mfma_f32_32x32x16_bf16 v[144:159], v[132:135], v[180:183], v[144:159]
  s_cmp_lg_u32 s10, 0
  s_cbranch_scc1 Lslow_141
  buffer_store_dword v15, v11, s[76:79], 0 offen
Lback_142:
  ds_read_b128 v[208:211], v25 offset:16
  ds_read_b128 v[212:215], v25 offset:1040
  ds_read_b128 v[180:183], v24 offset:28672
  s_waitcnt lgkmcnt(5)
  v_mfma_f32_32x32x16_bf16 v[144:159], v[136:139], v[184:187], v[144:159]
  ds_read_b128 v[184:187], v24 offset:29184
  s_waitcnt lgkmcnt(5)
  v_mfma_f32_32x32x16_bf16 v[144:159], v[140:143], v[188:191], v[144:159]
  ds_read_b128 v[188:191], v24 offset:29696
  s_waitcnt lgkmcnt(5)
  v_mfma_f32_32x32x16_bf16 v[144:159], v[216:219], v[176:179], v[144:159]
  ds_read_b128 v[176:179], v24 offset:30208
  s_waitcnt lgkmcnt(3)
  v_mfma_f32_32x32x16_bf16 v[160:175], v[32:35], v[180:183], 0
  v_mov_b32 v222, 6
  ds_write_b32 v220, v222
  s_nop 6
  v_mul_f32 v192, v144, v144
  v_mul_f32 v193, v145, v145
  v_mul_f32 v194, v146, v146
  v_mul_f32 v195, v147, v147
  v_mul_f32 v196, v148, v148
  v_mul_f32 v197, v149, v149
  v_mul_f32 v198, v150, v150
  v_mul_f32 v199, v151, v151
  v_fma_f32 v192, v192, v209, v208
  v_fma_f32 v193, v193, v209, v208
  v_fma_f32 v194, v194, v209, v208
  v_fma_f32 v195, v195, v209, v208
  v_fma_f32 v196, v196, v209, v208
  v_fma_f32 v197, v197, v209, v208
  v_fma_f32 v198, v198, v209, v208
  v_fma_f32 v199, v199, v209, v208
  v_mul_f32 v192, v192, v144
  v_mul_f32 v193, v193, v145
  v_mul_f32 v194, v194, v146
  v_mul_f32 v195, v195, v147
  v_mul_f32 v196, v196, v148
  v_mul_f32 v197, v197, v149
  v_mul_f32 v198, v198, v150
  v_mul_f32 v199, v199, v151
  v_exp_f32 v192, v192
  v_exp_f32 v193, v193
  v_exp_f32 v194, v194
  v_exp_f32 v195, v195
  v_exp_f32 v196, v196
  v_exp_f32 v197, v197
  v_exp_f32 v198, v198
  v_exp_f32 v199, v199
  v_fma_f32 v192, v192, v210, v210
  v_fma_f32 v193, v193, v210, v210
  v_fma_f32 v194, v194, v210, v210
  v_fma_f32 v195, v195, v210, v210
  v_fma_f32 v196, v196, v210, v210
  v_fma_f32 v197, v197, v210, v210
  v_fma_f32 v198, v198, v210, v210
  v_fma_f32 v199, v199, v210, v210
  v_rcp_f32 v192, v192
  v_rcp_f32 v193, v193
  v_rcp_f32 v194, v194
  v_rcp_f32 v195, v195
  v_rcp_f32 v196, v196
  v_rcp_f32 v197, v197
  v_rcp_f32 v198, v198
  v_rcp_f32 v199, v199
  v_mul_f32 v144, v144, v192
  v_mul_f32 v145, v145, v193
  v_mul_f32 v146, v146, v194
  v_mul_f32 v147, v147, v195
  v_mul_f32 v148, v148, v196
  v_mul_f32 v149, v149, v197
  v_mul_f32 v150, v150, v198
  v_mul_f32 v151, v151, v199
  v_cvt_pk_bf16_f32 v200, v144, v145
  v_cvt_pk_bf16_f32 v201, v146, v147
  v_cvt_pk_bf16_f32 v202, v148, v149
  v_cvt_pk_bf16_f32 v203, v150, v151
  s_cmp_lg_u32 s10, 0
  s_cbranch_scc1 Lslow_143
  buffer_store_dwordx4 v[200:203], v9, s[76:79], s94 offen offset:0
Lback_144:
  v_mul_f32 v192, v152, v152
  v_mul_f32 v193, v153, v153
  v_mul_f32 v194, v154, v154
  v_mul_f32 v195, v155, v155
  v_mul_f32 v196, v156, v156
  v_mul_f32 v197, v157, v157
  v_mul_f32 v198, v158, v158
  v_mul_f32 v199, v159, v159
  v_fma_f32 v192, v192, v209, v208
  v_fma_f32 v193, v193, v209, v208
  v_fma_f32 v194, v194, v209, v208
  v_fma_f32 v195, v195, v209, v208
  v_fma_f32 v196, v196, v209, v208
  v_fma_f32 v197, v197, v209, v208
  v_fma_f32 v198, v198, v209, v208
  v_fma_f32 v199, v199, v209, v208
  v_mul_f32 v192, v192, v152
  v_mul_f32 v193, v193, v153
  v_mul_f32 v194, v194, v154
  v_mul_f32 v195, v195, v155
  v_mul_f32 v196, v196, v156
  v_mul_f32 v197, v197, v157
  v_mul_f32 v198, v198, v158
  v_mul_f32 v199, v199, v159
  v_exp_f32 v192, v192
  v_exp_f32 v193, v193
  v_exp_f32 v194, v194
  v_exp_f32 v195, v195
  v_exp_f32 v196, v196
  v_exp_f32 v197, v197
  v_exp_f32 v198, v198
  v_exp_f32 v199, v199
  v_fma_f32 v192, v192, v210, v210
  v_fma_f32 v193, v193, v210, v210
  v_fma_f32 v194, v194, v210, v210
  v_fma_f32 v195, v195, v210, v210
  v_fma_f32 v196, v196, v210, v210
  v_fma_f32 v197, v197, v210, v210
  v_fma_f32 v198, v198, v210, v210
  v_fma_f32 v199, v199, v210, v210
  v_rcp_f32 v192, v192
  v_rcp_f32 v193, v193
  v_rcp_f32 v194, v194
  v_rcp_f32 v195, v195
  v_rcp_f32 v196, v196
  v_rcp_f32 v197, v197
  v_rcp_f32 v198, v198
  v_rcp_f32 v199, v199
  v_mul_f32 v152, v152, v192
  v_mul_f32 v153, v153, v193
  v_mul_f32 v154, v154, v194
  v_mul_f32 v155, v155, v195
  v_mul_f32 v156, v156, v196
  v_mul_f32 v157, v157, v197
  v_mul_f32 v158, v158, v198
  v_mul_f32 v159, v159, v199
  v_cvt_pk_bf16_f32 v204, v152, v153
  v_cvt_pk_bf16_f32 v205, v154, v155
  v_cvt_pk_bf16_f32 v206, v156, v157
  ds_read_b32 v223, v221
  v_cvt_pk_bf16_f32 v207, v158, v159
  s_cmp_lg_u32 s10, 0
  s_cbranch_scc1 Lslow_145
  buffer_store_dwordx4 v[204:207], v9, s[76:79], s94 offen offset:1024
Lback_146:
  ds_read_b128 v[180:183], v24 offset:30720
  s_waitcnt lgkmcnt(5)
  v_mfma_f32_32x32x16_bf16 v[160:175], v[36:39], v[184:187], v[160:175]
  v_cndmask_b32 v224, 9, 0, s[0:1]
  s_waitcnt lgkmcnt(1)
  v_cmp_gt_u32 vcc, v224, v223
  s_nop 0
  s_cbranch_vccnz Llrg_148
Lldg_147:
  ds_read_b128 v[184:187], v24 offset:31232
  v_mfma_f32_32x32x16_bf16 v[160:175], v[40:43], v[188:191], v[160:175]
  ds_read_b64_tr_b16 v[16:17], v5 offset:0
  ds_read_b64_tr_b16 v[18:19], v5 offset:1024
  ds_read_b128 v[188:191], v24 offset:31744
  v_mfma_f32_32x32x16_bf16 v[160:175], v[44:47], v[176:179], v[160:175]
  ds_read_b64_tr_b16 v[20:21], v6 offset:0
  ds_read_b64_tr_b16 v[22:23], v6 offset:1024
  ds_read_b128 v[176:179], v24 offset:32256
  s_waitcnt lgkmcnt(7)
  v_mfma_f32_32x32x16_bf16 v[160:175], v[48:51], v[180:183], v[160:175]
  ds_read_b64_tr_b16 v[244:245], v5 offset:8192
  ds_read_b64_tr_b16 v[246:247], v5 offset:9216
  ds_read_b128 v[180:183], v24 offset:32768
  s_waitcnt lgkmcnt(9)
  v_mfma_f32_32x32x16_bf16 v[160:175], v[52:55], v[184:187], v[160:175]
  ds_read_b64_tr_b16 v[248:249], v6 offset:8192
  ds_read_b64_tr_b16 v[250:251], v6 offset:9216
  ds_read_b128 v[184:187], v24 offset:33280
  s_waitcnt lgkmcnt(9)
  v_mfma_f32_32x32x16_bf16 v[160:175], v[56:59], v[188:191], v[160:175]
  s_waitcnt vmcnt(0)
  s_cmp_lg_u32 s10, 0
  s_cbranch_scc1 Lslow_149
  buffer_store_dword v13, v11, s[76:79], 0 offen offset:256
Lback_150:
  ds_read_b128 v[188:191], v24 offset:33792
  s_waitcnt lgkmcnt(7)
  v_mfma_f32_32x32x16_bf16 v[160:175], v[60:63], v[176:179], v[160:175]
  ds_read_b64_tr_b16 v[48:49], v5 offset:16384
  ds_read_b64_tr_b16 v[50:51], v5 offset:17408
  ds_read_b128 v[176:179], v24 offset:34304
  s_waitcnt lgkmcnt(7)
  v_mfma_f32_32x32x16_bf16 v[160:175], v[64:67], v[180:183], v[160:175]
  ds_read_b64_tr_b16 v[52:53], v6 offset:16384
  s_cmp_ge_u32 s7, 4
  s_cselect_b32 s97, s93, s92
  s_add_u32 m0, s96, 57344
  s_add_u32 s97, s97, 702464
  buffer_load_dwordx4 v7, s[68:71], s97 offen lds
  ds_read_b64_tr_b16 v[54:55], v6 offset:17408
  ds_read_b128 v[180:183], v24 offset:34816
  s_waitcnt lgkmcnt(7)
  v_mfma_f32_32x32x16_bf16 v[160:175], v[68:71], v[184:187], v[160:175]
  ds_read_b64_tr_b16 v[56:57], v5 offset:24576
  buffer_load_dwordx4 v8, s[68:71], s97 offen offset:1024 lds
  ds_read_b128 v[184:187], v24 offset:35328
  s_waitcnt lgkmcnt(8)
  v_mfma_f32_32x32x16_bf16 v[160:175], v[72:75], v[188:191], v[160:175]
  ds_read_b64_tr_b16 v[58:59], v5 offset:25600
  ds_read_b64_tr_b16 v[60:61], v6 offset:24576
  ds_read_b128 v[188:191], v24 offset:35840
  s_waitcnt lgkmcnt(8)
  v_mfma_f32_32x32x16_bf16 v[160:175], v[76:79], v[176:179], v[160:175]
  ds_read_b64_tr_b16 v[62:63], v6 offset:25600
  s_cmp_ge_u32 s7, 3
  s_cselect_b32 s97, s93, s92
  s_add_u32 m0, s96, 65536
  s_add_u32 s97, s97, 917504
  buffer_load_dwordx4 v7, s[68:71], s97 offen lds
  ds_read_b128 v[176:179], v24 offset:36352
  s_waitcnt lgkmcnt(7)
  v_mfma_f32_32x32x16_bf16 v[160:175], v[80:83], v[180:183], v[160:175]
  ds_read_b64_tr_b16 v[64:65], v5 offset:32768
  ds_read_b64_tr_b16 v[66:67], v5 offset:33792
  ds_read_b128 v[180:183], v24 offset:36864
  s_waitcnt lgkmcnt(8)
  v_mfma_f32_32x32x16_bf16 v[160:175], v[84:87], v[184:187], v[160:175]
  ds_read_b64_tr_b16 v[68:69], v6 offset:32768
  buffer_load_dwordx4 v8, s[68:71], s97 offen offset:1024 lds
  ds_read_b64_tr_b16 v[70:71], v6 offset:33792
  ds_read_b128 v[184:187], v24 offset:37376
  s_waitcnt lgkmcnt(8)
  v_mfma_f32_32x32x16_bf16 v[160:175], v[88:91], v[188:191], v[160:175]
  ds_read_b64_tr_b16 v[72:73], v5 offset:40960
  ds_read_b128 v[188:191], v24 offset:37888
  s_waitcnt lgkmcnt(8)
  v_mfma_f32_32x32x16_bf16 v[160:175], v[92:95], v[176:179], v[160:175]
  ds_read_b64_tr_b16 v[74:75], v5 offset:41984
  s_cmp_ge_u32 s7, 3
  s_cselect_b32 s97, s93, s92
  s_add_u32 m0, s96, 73728
  s_add_u32 s97, s97, 931840
  buffer_load_dwordx4 v7, s[68:71], s97 offen lds
  ds_read_b64_tr_b16 v[76:77], v6 offset:40960
  ds_read_b128 v[176:179], v24 offset:38400
  s_waitcnt lgkmcnt(8)
  v_mfma_f32_32x32x16_bf16 v[160:175], v[96:99], v[180:183], v[160:175]
  ds_read_b64_tr_b16 v[78:79], v6 offset:41984
  buffer_load_dwordx4 v8, s[68:71], s97 offen offset:1024 lds
  ds_read_b128 v[180:183], v24 offset:38912
  s_waitcnt lgkmcnt(7)
  v_mfma_f32_32x32x16_bf16 v[160:175], v[100:103], v[184:187], v[160:175]
  ds_read_b64_tr_b16 v[80:81], v5 offset:49152
  ds_read_b64_tr_b16 v[82:83], v5 offset:50176
  ds_read_b128 v[184:187], v24 offset:39424
  s_waitcnt lgkmcnt(8)
  v_mfma_f32_32x32x16_bf16 v[160:175], v[104:107], v[188:191], v[160:175]
  ds_read_b64_tr_b16 v[84:85], v6 offset:49152
  ds_read_b64_tr_b16 v[86:87], v6 offset:50176
  s_cmp_ge_u32 s7, 2
  s_cselect_b32 s97, s93, s92
  s_add_u32 m0, s96, 81920
  s_add_u32 s97, s97, 1146880
  buffer_load_dwordx4 v7, s[68:71], s97 offen lds
  ds_read_b128 v[188:191], v24 offset:39936
  s_waitcnt lgkmcnt(8)
  v_mfma_f32_32x32x16_bf16 v[160:175], v[108:111], v[176:179], v[160:175]
  ds_read_b128 v[176:179], v24 offset:40448
  s_waitcnt lgkmcnt(7)
  v_mfma_f32_32x32x16_bf16 v[160:175], v[112:115], v[180:183], v[160:175]
  buffer_load_dwordx4 v8, s[68:71], s97 offen offset:1024 lds
  ds_read_b128 v[180:183], v24 offset:40960
  s_waitcnt lgkmcnt(5)
  v_mfma_f32_32x32x16_bf16 v[160:175], v[116:119], v[184:187], v[160:175]
  ds_read_b128 v[184:187], v24 offset:41472
  s_waitcnt lgkmcnt(3)
  v_mfma_f32_32x32x16_bf16 v[160:175], v[120:123], v[188:191], v[160:175]
  s_cmp_ge_u32 s7, 2
  s_cselect_b32 s97, s93, s92
  s_add_u32 m0, s96, 90112
  s_add_u32 s97, s97, 1161216
  buffer_load_dwordx4 v7, s[68:71], s97 offen lds
  ds_read_b128 v[188:191], v24 offset:41984
  s_waitcnt lgkmcnt(3)
  v_mfma_f32_32x32x16_bf16 v[160:175], v[124:127], v[176:179], v[160:175]
  buffer_load_dword v15, v10, s[76:79], 0 offen offset:256 sc1
  buffer_load_dwordx4 v8, s[68:71], s97 offen offset:1024 lds
  ds_read_b128 v[176:179], v24 offset:42496
  s_waitcnt lgkmcnt(3)
  v_mfma_f32_32x32x16_bf16 v[160:175], v[128:131], v[180:183], v[160:175]
  ds_read_b128 v[180:183], v25 offset:1024
  s_waitcnt lgkmcnt(3)
  v_mfma_f32_32x32x16_bf16 v[160:175], v[132:135], v[184:187], v[160:175]
  s_cmp_ge_u32 s7, 1
  s_cselect_b32 s97, s93, s92
  s_add_u32 m0, s96, 98304
  s_add_u32 s97, s97, 1376256
  buffer_load_dwordx4 v7, s[68:71], s97 offen lds
  s_waitcnt lgkmcnt(2)
  v_mfma_f32_32x32x16_bf16 v[160:175], v[136:139], v[188:191], v[160:175]
  s_waitcnt lgkmcnt(1)
  v_mfma_f32_32x32x16_bf16 v[160:175], v[140:143], v[176:179], v[160:175]
  buffer_load_dwordx4 v8, s[68:71], s97 offen offset:1024 lds
  s_waitcnt lgkmcnt(0)
  v_mfma_f32_32x32x16_bf16 v[160:175], v[216:219], v[180:183], v[160:175]
  s_cmp_ge_u32 s7, 1
  s_cselect_b32 s97, s93, s92
  s_add_u32 m0, s96, 106496
  s_add_u32 s97, s97, 1390592
  buffer_load_dwordx4 v7, s[68:71], s97 offen lds
  buffer_load_dwordx4 v8, s[68:71], s97 offen offset:1024 lds
  v_mov_b32 v222, 7
  ds_write_b32 v220, v222
  s_nop 3
  v_mul_f32 v192, v160, v160
  v_mul_f32 v193, v161, v161
  v_mul_f32 v194, v162, v162
  v_mul_f32 v195, v163, v163
  v_mul_f32 v196, v164, v164
  v_mul_f32 v197, v165, v165
  v_mul_f32 v198, v166, v166
  v_mul_f32 v199, v167, v167
  v_fma_f32 v192, v192, v213, v212
  v_fma_f32 v193, v193, v213, v212
  v_fma_f32 v194, v194, v213, v212
  v_fma_f32 v195, v195, v213, v212
  v_fma_f32 v196, v196, v213, v212
  v_fma_f32 v197, v197, v213, v212
  v_fma_f32 v198, v198, v213, v212
  v_fma_f32 v199, v199, v213, v212
  v_mul_f32 v192, v192, v160
  v_mul_f32 v193, v193, v161
  v_mul_f32 v194, v194, v162
  v_mul_f32 v195, v195, v163
  v_mul_f32 v196, v196, v164
  v_mul_f32 v197, v197, v165
  v_mul_f32 v198, v198, v166
  v_mul_f32 v199, v199, v167
  v_exp_f32 v192, v192
  v_exp_f32 v193, v193
  v_exp_f32 v194, v194
  v_exp_f32 v195, v195
  v_exp_f32 v196, v196
  v_exp_f32 v197, v197
  v_exp_f32 v198, v198
  v_exp_f32 v199, v199
  v_fma_f32 v192, v192, v214, v214
  v_fma_f32 v193, v193, v214, v214
  v_fma_f32 v194, v194, v214, v214
  v_fma_f32 v195, v195, v214, v214
  v_fma_f32 v196, v196, v214, v214
  v_fma_f32 v197, v197, v214, v214
  v_fma_f32 v198, v198, v214, v214
  v_fma_f32 v199, v199, v214, v214
  v_rcp_f32 v192, v192
  v_rcp_f32 v193, v193
  v_rcp_f32 v194, v194
  v_rcp_f32 v195, v195
  v_rcp_f32 v196, v196
  v_rcp_f32 v197, v197
  v_rcp_f32 v198, v198
  v_rcp_f32 v199, v199
  v_mul_f32 v160, v160, v192
  v_mul_f32 v161, v161, v193
  v_mul_f32 v162, v162, v194
  v_mul_f32 v163, v163, v195
  v_mul_f32 v164, v164, v196
  v_mul_f32 v165, v165, v197
  s_waitcnt vmcnt(5)
  v_cmp_ne_u32 vcc, s9, v15
  s_nop 0
  s_cbranch_vccnz Lprd0_152
Lpdd0_151:
  s_cmp_ge_u32 s7, 6
  s_cselect_b32 s13, s95, s94
  s_add_u32 s13, s13, 8192
  buffer_load_dwordx4 v[32:35], v9, s[76:79], s13 offen offset:0 sc1
  v_mul_f32 v166, v166, v198
  v_mul_f32 v167, v167, v199
  v_cvt_pk_bf16_f32 v176, v160, v161
  v_cvt_pk_bf16_f32 v177, v162, v163
  buffer_load_dwordx4 v[36:39], v9, s[76:79], s13 offen offset:1024 sc1
  v_cvt_pk_bf16_f32 v178, v164, v165
  v_cvt_pk_bf16_f32 v179, v166, v167
  s_cmp_lg_u32 s10, 0
  s_cbranch_scc1 Lslow_153
  buffer_store_dwordx4 v[176:179], v9, s[76:79], s94 offen offset:2048
Lback_154:
  v_mul_f32 v192, v168, v168
  s_cmp_ge_u32 s7, 5
  s_cselect_b32 s13, s95, s94
  s_add_u32 s13, s13, 16384
  buffer_load_dwordx4 v[40:43], v9, s[76:79], s13 offen offset:0 sc1
  v_mul_f32 v193, v169, v169
  v_mul_f32 v194, v170, v170
  v_mul_f32 v195, v171, v171
  v_mul_f32 v196, v172, v172
  buffer_load_dwordx4 v[44:47], v9, s[76:79], s13 offen offset:1024 sc1
  v_mul_f32 v197, v173, v173
  v_mul_f32 v198, v174, v174
  v_mul_f32 v199, v175, v175
  v_fma_f32 v192, v192, v213, v212
  s_cmp_ge_u32 s7, 4
  s_cselect_b32 s13, s95, s94
  s_add_u32 s13, s13, 24576
  buffer_load_dwordx4 v[128:131], v9, s[76:79], s13 offen offset:0 sc1
  v_fma_f32 v193, v193, v213, v212
  v_fma_f32 v194, v194, v213, v212
  v_fma_f32 v195, v195, v213, v212
  v_fma_f32 v196, v196, v213, v212
  buffer_load_dwordx4 v[132:135], v9, s[76:79], s13 offen offset:1024 sc1
  v_fma_f32 v197, v197, v213, v212
  v_fma_f32 v198, v198, v213, v212
  v_fma_f32 v199, v199, v213, v212
  v_mul_f32 v192, v192, v168
  s_cmp_ge_u32 s7, 3
  s_cselect_b32 s13, s95, s94
  s_add_u32 s13, s13, 32768
  buffer_load_dwordx4 v[136:139], v9, s[76:79], s13 offen offset:0 sc1
  v_mul_f32 v193, v193, v169
  v_mul_f32 v194, v194, v170
  v_mul_f32 v195, v195, v171
  v_mul_f32 v196, v196, v172
  buffer_load_dwordx4 v[140:143], v9, s[76:79], s13 offen offset:1024 sc1
  v_mul_f32 v197, v197, v173
  v_mul_f32 v198, v198, v174
  v_mul_f32 v199, v199, v175
  v_exp_f32 v192, v192
  s_cmp_ge_u32 s7, 2
  s_cselect_b32 s13, s95, s94
  s_add_u32 s13, s13, 40960
  buffer_load_dwordx4 v[24:27], v9, s[76:79], s13 offen offset:0 sc1
  v_exp_f32 v193, v193
  v_exp_f32 v194, v194
  v_exp_f32 v195, v195
  v_exp_f32 v196, v196
  buffer_load_dwordx4 v[28:31], v9, s[76:79], s13 offen offset:1024 sc1
  v_exp_f32 v197, v197
  v_exp_f32 v198, v198
  v_exp_f32 v199, v199
  v_fma_f32 v192, v192, v214, v214
  s_cmp_ge_u32 s7, 1
  s_cselect_b32 s13, s95, s94
  s_add_u32 s13, s13, 49152
  buffer_load_dwordx4 v[184:187], v9, s[76:79], s13 offen offset:0 sc1
  v_fma_f32 v193, v193, v214, v214
  v_fma_f32 v194, v194, v214, v214
  v_fma_f32 v195, v195, v214, v214
  v_fma_f32 v196, v196, v214, v214
  buffer_load_dwordx4 v[188:191], v9, s[76:79], s13 offen offset:1024 sc1
  v_fma_f32 v197, v197, v214, v214
  v_fma_f32 v198, v198, v214, v214
  v_fma_f32 v199, v199, v214, v214
  v_rcp_f32 v192, v192
  v_rcp_f32 v193, v193
  v_rcp_f32 v194, v194
  v_rcp_f32 v195, v195
  v_rcp_f32 v196, v196
  v_rcp_f32 v197, v197
  v_rcp_f32 v198, v198
  v_rcp_f32 v199, v199
  v_mul_f32 v168, v168, v192
  v_mul_f32 v169, v169, v193
  v_mul_f32 v170, v170, v194
  v_mul_f32 v171, v171, v195
  v_mul_f32 v172, v172, v196
  v_mul_f32 v173, v173, v197
  v_mul_f32 v174, v174, v198
  v_mul_f32 v175, v175, v199
  v_cvt_pk_bf16_f32 v180, v168, v169
  v_cvt_pk_bf16_f32 v181, v170, v171
  v_cvt_pk_bf16_f32 v182, v172, v173
  v_cvt_pk_bf16_f32 v183, v174, v175
  s_cmp_lg_u32 s10, 0
  s_cbranch_scc1 Lslow_155
  buffer_store_dwordx4 v[180:183], v9, s[76:79], s94 offen offset:3072
Lback_156:
  s_setprio 1
  v_mfma_f32_32x32x16_bf16 v[144:159], v[16:19], v[200:203], 0
  ds_read_b64_tr_b16 v[88:89], v5 offset:0
  ds_read_b64_tr_b16 v[90:91], v5 offset:1024
  ds_read_b64_tr_b16 v[92:93], v6 offset:0
  ds_read_b64_tr_b16 v[94:95], v6 offset:1024
  ds_read_b64_tr_b16 v[96:97], v5 offset:8192
  ds_read_b64_tr_b16 v[98:99], v5 offset:9216
  ds_read_b64_tr_b16 v[100:101], v6 offset:8192
  ds_read_b64_tr_b16 v[102:103], v6 offset:9216
  ds_read_b64_tr_b16 v[104:105], v5 offset:16384
  ds_read_b64_tr_b16 v[106:107], v5 offset:17408
  ds_read_b64_tr_b16 v[108:109], v6 offset:16384
  ds_read_b64_tr_b16 v[110:111], v6 offset:17408
  ds_read_b64_tr_b16 v[112:113], v5 offset:24576
  ds_read_b64_tr_b16 v[114:115], v5 offset:25600
  ds_read_b64_tr_b16 v[116:117], v6 offset:24576
  ds_read_b64_tr_b16 v[118:119], v6 offset:25600
  s_waitcnt vmcnt(18)
  ds_read_b64_tr_b16 v[120:121], v5 offset:32768
  ds_read_b64_tr_b16 v[122:123], v5 offset:33792
  ds_read_b64_tr_b16 v[124:125], v6 offset:32768
  ds_read_b64_tr_b16 v[126:127], v6 offset:33792
  v_mfma_f32_32x32x16_bf16 v[228:243], v[20:23], v[200:203], 0
  v_mfma_f32_32x32x16_bf16 v[144:159], v[244:247], v[204:207], v[144:159]
  v_mfma_f32_32x32x16_bf16 v[228:243], v[248:251], v[204:207], v[228:243]
  v_mfma_f32_32x32x16_bf16 v[160:175], v[16:19], v[176:179], 0
  v_mfma_f32_32x32x16_bf16 v[192:207], v[20:23], v[176:179], 0
  v_mfma_f32_32x32x16_bf16 v[160:175], v[244:247], v[180:183], v[160:175]
  v_mfma_f32_32x32x16_bf16 v[192:207], v[248:251], v[180:183], v[192:207]
  s_waitcnt vmcnt(13)
  v_mfma_f32_32x32x16_bf16 v[144:159], v[48:51], v[32:35], v[144:159]
  v_mfma_f32_32x32x16_bf16 v[228:243], v[52:55], v[32:35], v[228:243]
  s_waitcnt vmcnt(12)
  v_mfma_f32_32x32x16_bf16 v[144:159], v[56:59], v[36:39], v[144:159]
  v_mfma_f32_32x32x16_bf16 v[228:243], v[60:63], v[36:39], v[228:243]
  s_waitcnt vmcnt(10)
  v_mfma_f32_32x32x16_bf16 v[144:159], v[64:67], v[40:43], v[144:159]
  s_waitcnt vmcnt(0)
  s_cmp_lg_u32 s10, 0
  s_cbranch_scc1 Lslow_157
  buffer_store_dword v13, v11, s[76:79], 0 offen offset:512
Lback_158:
  v_mfma_f32_32x32x16_bf16 v[228:243], v[68:71], v[40:43], v[228:243]
  v_mfma_f32_32x32x16_bf16 v[144:159], v[72:75], v[44:47], v[144:159]
  v_mfma_f32_32x32x16_bf16 v[228:243], v[76:79], v[44:47], v[228:243]
  v_mfma_f32_32x32x16_bf16 v[144:159], v[80:83], v[128:131], v[144:159]
  v_mfma_f32_32x32x16_bf16 v[228:243], v[84:87], v[128:131], v[228:243]
  s_waitcnt lgkmcnt(15)
  v_mfma_f32_32x32x16_bf16 v[144:159], v[88:91], v[132:135], v[144:159]
  s_waitcnt lgkmcnt(15)
  v_mfma_f32_32x32x16_bf16 v[228:243], v[92:95], v[132:135], v[228:243]
  s_waitcnt lgkmcnt(14)
  v_mfma_f32_32x32x16_bf16 v[144:159], v[96:99], v[136:139], v[144:159]
  s_waitcnt lgkmcnt(12)
  v_mfma_f32_32x32x16_bf16 v[228:243], v[100:103], v[136:139], v[228:243]
  s_waitcnt lgkmcnt(10)
  v_mfma_f32_32x32x16_bf16 v[144:159], v[104:107], v[140:143], v[144:159]
  buffer_load_dword v15, v10, s[76:79], 0 offen offset:512 sc1
  s_waitcnt lgkmcnt(8)
  v_mfma_f32_32x32x16_bf16 v[228:243], v[108:111], v[140:143], v[228:243]
  ds_read_b64_tr_b16 v[128:129], v5 offset:40960
  ds_read_b64_tr_b16 v[130:131], v5 offset:41984
  ds_read_b64_tr_b16 v[132:133], v6 offset:40960
  ds_read_b64_tr_b16 v[134:135], v6 offset:41984
  ds_read_b64_tr_b16 v[136:137], v5 offset:49152
  ds_read_b64_tr_b16 v[138:139], v5 offset:50176
  ds_read_b64_tr_b16 v[140:141], v6 offset:49152
  ds_read_b64_tr_b16 v[142:143], v6 offset:50176
  v_mov_b32 v222, 8
  ds_write_b32 v220, v222
  s_waitcnt lgkmcnt(15)
  v_mfma_f32_32x32x16_bf16 v[144:159], v[112:115], v[24:27], v[144:159]
  s_waitcnt lgkmcnt(13)
  v_mfma_f32_32x32x16_bf16 v[228:243], v[116:119], v[24:27], v[228:243]
  s_waitcnt lgkmcnt(11)
  v_mfma_f32_32x32x16_bf16 v[144:159], v[120:123], v[28:31], v[144:159]
  s_waitcnt lgkmcnt(9)
  v_mfma_f32_32x32x16_bf16 v[228:243], v[124:127], v[28:31], v[228:243]
  s_waitcnt lgkmcnt(7)
  v_mfma_f32_32x32x16_bf16 v[144:159], v[128:131], v[184:187], v[144:159]
  s_waitcnt lgkmcnt(5)
  v_mfma_f32_32x32x16_bf16 v[228:243], v[132:135], v[184:187], v[228:243]
  ds_read_b32 v223, v221
  s_waitcnt lgkmcnt(4)
  v_mfma_f32_32x32x16_bf16 v[144:159], v[136:139], v[188:191], v[144:159]
  s_waitcnt lgkmcnt(2)
  v_mfma_f32_32x32x16_bf16 v[228:243], v[140:143], v[188:191], v[228:243]
  s_waitcnt vmcnt(0)
  v_cmp_ne_u32 vcc, s9, v15
  s_nop 0
  s_cbranch_vccnz Lprd1_160
Lpdd1_159:
  s_cmp_ge_u32 s7, 6
  s_cselect_b32 s13, s95, s94
  s_add_u32 s13, s13, 8192
  buffer_load_dwordx4 v[216:219], v9, s[76:79], s13 offen offset:2048 sc1
  buffer_load_dwordx4 v[208:211], v9, s[76:79], s13 offen offset:3072 sc1
  v_cndmask_b32 v224, 0, 8, s[0:1]
  s_waitcnt lgkmcnt(0)
  v_cmp_gt_u32 vcc, v224, v223
  s_nop 0
  s_cbranch_vccnz Llrg_162
Lldg_161:
  ds_write_b128 v252, v[144:147] offset:0
  s_setprio 3
  s_waitcnt vmcnt(1)
  v_mfma_f32_32x32x16_bf16 v[160:175], v[48:51], v[216:219], v[160:175]
  s_cmp_ge_u32 s7, 5
  s_cselect_b32 s13, s95, s94
  s_add_u32 s13, s13, 16384
  buffer_load_dwordx4 v[212:215], v9, s[76:79], s13 offen offset:2048 sc1
  v_mfma_f32_32x32x16_bf16 v[192:207], v[52:55], v[216:219], v[192:207]
  ds_write_b128 v253, v[148:151] offset:0
  ds_write_b128 v254, v[152:155] offset:0
  buffer_load_dwordx4 v[176:179], v9, s[76:79], s13 offen offset:3072 sc1
  s_waitcnt vmcnt(2)
  v_mfma_f32_32x32x16_bf16 v[160:175], v[56:59], v[208:211], v[160:175]
  ds_write_b128 v255, v[156:159] offset:0
  ds_write_b128 v252, v[228:231] offset:16384
  s_cmp_ge_u32 s7, 4
  s_cselect_b32 s13, s95, s94
  s_add_u32 s13, s13, 24576
  buffer_load_dwordx4 v[16:19], v9, s[76:79], s13 offen offset:2048 sc1
  v_mfma_f32_32x32x16_bf16 v[192:207], v[60:63], v[208:211], v[192:207]
  ds_write_b128 v253, v[232:235] offset:16384
  ds_write_b128 v254, v[236:239] offset:16384
  buffer_load_dwordx4 v[20:23], v9, s[76:79], s13 offen offset:3072 sc1
  s_waitcnt vmcnt(3)
  v_mfma_f32_32x32x16_bf16 v[160:175], v[64:67], v[212:215], v[160:175]
  ds_write_b128 v255, v[240:243] offset:16384
  v_mov_b32 v222, 9
  ds_write_b32 v220, v222
  v_subrev_u32 v252, 57344, v252
  v_subrev_u32 v253, 57344, v253
  v_subrev_u32 v254, 57344, v254
  v_subrev_u32 v255, 57344, v255
  v_add_u32 v5, 57344, v14
  v_add_u32 v6, 90112, v14
  s_cmp_ge_u32 s7, 3
  s_cselect_b32 s13, s95, s94
  s_add_u32 s13, s13, 32768
  buffer_load_dwordx4 v[180:183], v9, s[76:79], s13 offen offset:2048 sc1
  v_mfma_f32_32x32x16_bf16 v[192:207], v[68:71], v[212:215], v[192:207]
  buffer_load_dwordx4 v[244:247], v9, s[76:79], s13 offen offset:3072 sc1
  s_waitcnt vmcnt(4)
  v_mfma_f32_32x32x16_bf16 v[160:175], v[72:75], v[176:179], v[160:175]
  s_cmp_ge_u32 s7, 2
  s_cselect_b32 s13, s95, s94
  s_add_u32 s13, s13, 40960
  buffer_load_dwordx4 v[248:251], v9, s[76:79], s13 offen offset:2048 sc1
  v_mfma_f32_32x32x16_bf16 v[192:207], v[76:79], v[176:179], v[192:207]
  buffer_load_dwordx4 v[32:35], v9, s[76:79], s13 offen offset:3072 sc1
  s_waitcnt vmcnt(5)
  v_mfma_f32_32x32x16_bf16 v[160:175], v[80:83], v[16:19], v[160:175]
  s_cmp_ge_u32 s7, 1
  s_cselect_b32 s13, s95, s94
  s_add_u32 s13, s13, 49152
  buffer_load_dwordx4 v[36:39], v9, s[76:79], s13 offen offset:2048 sc1
  v_mfma_f32_32x32x16_bf16 v[192:207], v[84:87], v[16:19], v[192:207]
  ds_read_b32 v223, v221
  buffer_load_dwordx4 v[40:43], v9, s[76:79], s13 offen offset:3072 sc1
  s_waitcnt vmcnt(6)
  v_mfma_f32_32x32x16_bf16 v[160:175], v[88:91], v[20:23], v[160:175]
  v_mfma_f32_32x32x16_bf16 v[192:207], v[92:95], v[20:23], v[192:207]
  v_cndmask_b32 v224, 11, 9, s[0:1]
  s_waitcnt lgkmcnt(0)
  v_cmp_gt_u32 vcc, v224, v223
  s_nop 0
  s_cbranch_vccnz Llrg_164
Lldg_163:
  ds_read_b128 v[144:147], v14 offset:40960
  ds_read_b128 v[148:151], v14 offset:49152
  ds_read_b128 v[152:155], v14 offset:45056
  ds_read_b128 v[156:159], v14 offset:53248
  ds_read_b128 v[228:231], v5 offset:0
  ds_read_b128 v[232:235], v5 offset:4096
  ds_read_b128 v[236:239], v5 offset:8192
  ds_read_b128 v[240:243], v5 offset:12288
  s_waitcnt vmcnt(5)
  v_mfma_f32_32x32x16_bf16 v[160:175], v[96:99], v[180:183], v[160:175]
  v_mfma_f32_32x32x16_bf16 v[192:207], v[100:103], v[180:183], v[192:207]
  s_waitcnt vmcnt(4)
  v_mfma_f32_32x32x16_bf16 v[160:175], v[104:107], v[244:247], v[160:175]
  s_waitcnt lgkmcnt(2)
  v_add_f32 v228, v228, v232
  v_add_f32 v229, v229, v233
  v_add_f32 v230, v230, v234
  v_add_f32 v231, v231, v235
  s_waitcnt lgkmcnt(0)
  v_add_f32 v236, v236, v240
  v_add_f32 v237, v237, v241
  v_add_f32 v238, v238, v242
  v_add_f32 v239, v239, v243
  v_add_f32 v144, v144, v228
  v_add_f32 v145, v145, v229
  v_add_f32 v146, v146, v230
  v_add_f32 v147, v147, v231
  v_add_f32 v144, v144, v236
  v_add_f32 v145, v145, v237
  v_add_f32 v146, v146, v238
  v_add_f32 v147, v147, v239
  ds_read_b128 v[228:231], v5 offset:16384
  ds_read_b128 v[232:235], v5 offset:20480
  ds_read_b128 v[236:239], v5 offset:24576
  ds_read_b128 v[240:243], v5 offset:28672
  v_mfma_f32_32x32x16_bf16 v[192:207], v[108:111], v[244:247], v[192:207]
  s_waitcnt vmcnt(3)
  v_mfma_f32_32x32x16_bf16 v[160:175], v[112:115], v[248:251], v[160:175]
  v_mfma_f32_32x32x16_bf16 v[192:207], v[116:119], v[248:251], v[192:207]
  s_waitcnt lgkmcnt(2)
  v_add_f32 v228, v228, v232
  v_add_f32 v229, v229, v233
  v_add_f32 v230, v230, v234
  v_add_f32 v231, v231, v235
  s_waitcnt lgkmcnt(0)
  v_add_f32 v236, v236, v240
  v_add_f32 v237, v237, v241
  v_add_f32 v238, v238, v242
  v_add_f32 v239, v239, v243
  v_add_f32 v148, v148, v228
  v_add_f32 v149, v149, v229
  v_add_f32 v150, v150, v230
  v_add_f32 v151, v151, v231
  v_add_f32 v148, v148, v236
  v_add_f32 v149, v149, v237
  v_add_f32 v150, v150, v238
  v_add_f32 v151, v151, v239
  s_waitcnt vmcnt(2)
  v_mfma_f32_32x32x16_bf16 v[160:175], v[120:123], v[32:35], v[160:175]
  v_mfma_f32_32x32x16_bf16 v[192:207], v[124:127], v[32:35], v[192:207]
  s_waitcnt vmcnt(1)
  v_mfma_f32_32x32x16_bf16 v[160:175], v[128:131], v[36:39], v[160:175]
  ds_read_b32 v223, v221
  s_waitcnt vmcnt(0)
  v_mfma_f32_32x32x16_bf16 v[160:175], v[136:139], v[40:43], v[160:175]
  v_mfma_f32_32x32x16_bf16 v[192:207], v[132:135], v[36:39], v[192:207]
  v_mfma_f32_32x32x16_bf16 v[192:207], v[140:143], v[40:43], v[192:207]
  v_cndmask_b32 v224, 12, 0, s[0:1]
  s_waitcnt lgkmcnt(0)
  v_cmp_gt_u32 vcc, v224, v223
  s_nop 0
  s_cbranch_vccnz Llrg_166
Lldg_165:
  s_nop 4
  ds_write_b128 v252, v[160:163] offset:0
  ds_write_b128 v253, v[164:167] offset:0
  ds_write_b128 v254, v[168:171] offset:0
  ds_write_b128 v255, v[172:175] offset:0
  ds_write_b128 v252, v[192:195] offset:16384
  ds_write_b128 v253, v[196:199] offset:16384
  ds_write_b128 v254, v[200:203] offset:16384
  ds_write_b128 v255, v[204:207] offset:16384
  v_mov_b32 v222, 10
  ds_write_b32 v220, v222
  s_setprio 0
  ds_read_b32 v17, v221
  ds_read_b128 v[96:99], v14 offset:0
  ds_read_b128 v[100:103], v14 offset:4096
  ds_read_b128 v[104:107], v14 offset:8192
  ds_read_b128 v[108:111], v14 offset:12288
  ds_read_b128 v[112:115], v14 offset:16384
  ds_read_b128 v[116:119], v14 offset:20480
  ds_read_b128 v[120:123], v14 offset:24576
  ds_read_b128 v[124:127], v14 offset:28672
  v_cndmask_b32 v224, 0, 10, s[0:1]
  s_waitcnt lgkmcnt(8)
  v_cmp_gt_u32 vcc, v224, v17
  s_nop 0
  s_cbranch_vccnz Lsr_168
Lsd_167:
  s_waitcnt lgkmcnt(6)
  v_add_f32 v96, v96, v100
  v_add_f32 v97, v97, v101
  v_add_f32 v98, v98, v102
  v_add_f32 v99, v99, v103
  s_waitcnt lgkmcnt(4)
  v_add_f32 v104, v104, v108
  v_add_f32 v105, v105, v109
  v_add_f32 v106, v106, v110
  v_add_f32 v107, v107, v111
  v_add_f32 v152, v152, v96
  v_add_f32 v153, v153, v97
  v_add_f32 v154, v154, v98
  v_add_f32 v155, v155, v99
  v_add_f32 v152, v152, v104
  v_add_f32 v153, v153, v105
  v_add_f32 v154, v154, v106
  v_add_f32 v155, v155, v107
  ds_read_b32 v16, v221
  ds_read_b128 v[32:35], v6 offset:0
  ds_read_b128 v[36:39], v6 offset:4096
  ds_read_b128 v[40:43], v6 offset:8192
  ds_read_b128 v[44:47], v6 offset:12288
  ds_read_b128 v[48:51], v6 offset:16384
  ds_read_b128 v[52:55], v6 offset:20480
  ds_read_b128 v[56:59], v6 offset:24576
  ds_read_b128 v[60:63], v6 offset:28672
  s_waitcnt lgkmcnt(11)
  v_add_f32 v112, v112, v116
  v_add_f32 v113, v113, v117
  v_add_f32 v114, v114, v118
  v_add_f32 v115, v115, v119
  s_waitcnt lgkmcnt(9)
  v_add_f32 v120, v120, v124
  v_add_f32 v121, v121, v125
  v_add_f32 v122, v122, v126
  v_add_f32 v123, v123, v127
  v_add_f32 v156, v156, v112
  v_add_f32 v157, v157, v113
  v_add_f32 v158, v158, v114
  v_add_f32 v159, v159, v115
  v_add_f32 v156, v156, v120
  v_add_f32 v157, v157, v121
  v_add_f32 v158, v158, v122
  v_add_f32 v159, v159, v123
  v_cndmask_b32 v224, 13, 0, s[0:1]
  s_waitcnt lgkmcnt(8)
  v_cmp_gt_u32 vcc, v224, v16
  s_nop 0
  s_cbranch_vccnz Lsr_171
Lsd_170:
  s_waitcnt lgkmcnt(6)
  v_add_f32 v32, v32, v36
  v_add_f32 v33, v33, v37
  v_add_f32 v34, v34, v38
  v_add_f32 v35, v35, v39
  s_waitcnt lgkmcnt(4)
  v_add_f32 v40, v40, v44
  v_add_f32 v41, v41, v45
  v_add_f32 v42, v42, v46
  v_add_f32 v43, v43, v47
  v_add_f32 v144, v144, v32
  v_add_f32 v145, v145, v33
  v_add_f32 v146, v146, v34
  v_add_f32 v147, v147, v35
  v_add_f32 v144, v144, v40
  v_add_f32 v145, v145, v41
  v_add_f32 v146, v146, v42
  v_add_f32 v147, v147, v43
  v_cvt_pk_bf16_f32 v144, v144, v145
  v_cvt_pk_bf16_f32 v145, v146, v147
  buffer_store_dwordx2 v[144:145], v12, s[72:75], s98 offen offset:0 sc1
  ds_read_b32 v18, v221
  ds_read_b128 v[64:67], v6 offset:32768
  ds_read_b128 v[68:71], v6 offset:36864
  ds_read_b128 v[72:75], v6 offset:40960
  ds_read_b128 v[76:79], v6 offset:45056
  s_waitcnt lgkmcnt(7)
  v_add_f32 v48, v48, v52
  v_add_f32 v49, v49, v53
  v_add_f32 v50, v50, v54
  v_add_f32 v51, v51, v55
  s_waitcnt lgkmcnt(5)
  v_add_f32 v56, v56, v60
  v_add_f32 v57, v57, v61
  v_add_f32 v58, v58, v62
  v_add_f32 v59, v59, v63
  v_add_f32 v148, v148, v48
  v_add_f32 v149, v149, v49
  v_add_f32 v150, v150, v50
  v_add_f32 v151, v151, v51
  v_add_f32 v148, v148, v56
  v_add_f32 v149, v149, v57
  v_add_f32 v150, v150, v58
  v_add_f32 v151, v151, v59
  v_cvt_pk_bf16_f32 v148, v148, v149
  v_cvt_pk_bf16_f32 v149, v150, v151
  buffer_store_dwordx2 v[148:149], v12, s[72:75], s98 offen offset:64 sc1
  v_cndmask_b32 v224, 14, 0, s[0:1]
  s_waitcnt lgkmcnt(4)
  v_cmp_gt_u32 vcc, v224, v18
  s_nop 0
  s_cbranch_vccnz Lsr_174
Lsd_173:
  ds_read_b32 v19, v221
  ds_read_b128 v[80:83], v6 offset:49152
  ds_read_b128 v[84:87], v6 offset:53248
  ds_read_b128 v[88:91], v6 offset:57344
  ds_read_b128 v[92:95], v6 offset:61440
  s_waitcnt lgkmcnt(7)
  v_add_f32 v64, v64, v68
  v_add_f32 v65, v65, v69
  v_add_f32 v66, v66, v70
  v_add_f32 v67, v67, v71
  s_waitcnt lgkmcnt(5)
  v_add_f32 v72, v72, v76
  v_add_f32 v73, v73, v77
  v_add_f32 v74, v74, v78
  v_add_f32 v75, v75, v79
  v_add_f32 v152, v152, v64
  v_add_f32 v153, v153, v65
  v_add_f32 v154, v154, v66
  v_add_f32 v155, v155, v67
  v_add_f32 v152, v152, v72
  v_add_f32 v153, v153, v73
  v_add_f32 v154, v154, v74
  v_add_f32 v155, v155, v75
  v_cvt_pk_bf16_f32 v152, v152, v153
  v_cvt_pk_bf16_f32 v153, v154, v155
  buffer_store_dwordx2 v[152:153], v12, s[72:75], s99 offen offset:0 sc1
  v_cndmask_b32 v224, 15, 0, s[0:1]
  s_waitcnt lgkmcnt(4)
  v_cmp_gt_u32 vcc, v224, v19
  s_nop 0
  s_cbranch_vccnz Lsr_177
Lsd_176:
  s_waitcnt lgkmcnt(2)
  v_pk_add_f32 v[80:81], v[80:81], v[84:85]
  v_pk_add_f32 v[82:83], v[82:83], v[86:87]
  s_waitcnt lgkmcnt(0)
  v_pk_add_f32 v[88:89], v[88:89], v[92:93]
  v_pk_add_f32 v[90:91], v[90:91], v[94:95]
  v_pk_add_f32 v[156:157], v[156:157], v[80:81]
  v_pk_add_f32 v[158:159], v[158:159], v[82:83]
  v_pk_add_f32 v[156:157], v[156:157], v[88:89]
  v_pk_add_f32 v[158:159], v[158:159], v[90:91]
  v_cvt_pk_bf16_f32 v156, v156, v157
  v_cvt_pk_bf16_f32 v157, v158, v159
  buffer_store_dwordx2 v[156:157], v12, s[72:75], s99 offen offset:64 sc1
  s_branch Lend
Lj7:
  s_nop 3
  s_waitcnt vmcnt(0)
  s_cmp_lg_u32 s10, 0
  s_cbranch_scc1 Lslow_179
  buffer_store_dword v27, v14, s[76:79], 0 offen
Lback_180:
Lj7b:
  s_nop 3
  s_waitcnt vmcnt(0) lgkmcnt(0)
  s_barrier
  s_and_b32 s12, s6, 3
  s_lshl_b32 s12, s12, 3
  s_add_u32 s12, s12, s8
  s_mul_i32 s12, s12, 49
  v_add_u32 v15, s12, v1
  v_lshrrev_b32 v16, 1, v15
  v_lshlrev_b32 v16, 9, v16
  v_and_b32 v17, 1, v15
  v_lshl_add_u32 v16, v17, 7, v16
  v_lshrrev_b32 v17, 5, v15
  v_mul_u32_u24 v17, 9363, v17
  v_lshrrev_b32 v17, 16, v17
  v_mul_u32_u24 v17, 200704, v17
  v_lshl_add_u32 v17, v15, 7, v17
  v_cmp_gt_u32 vcc, 49, v1
  s_nop 1
  v_cndmask_b32 v16, v20, v16, vcc
  v_cndmask_b32 v17, v20, v17, vcc
  s_mul_i32 s12, s8, 56
  v_add_u32 v15, s12, v1
  v_lshlrev_b32 v15, 7, v15
  v_cmp_gt_u32 vcc, 56, v1
  s_nop 1
  v_cndmask_b32 v15, v20, v15, vcc
  s_add_u32 s13, s80, 215040
  buffer_load_dword v70, v15, s[76:79], s13 offen sc1
  s_barrier
  s_and_b32 s12, s6, 3
  s_lshl_b32 s12, s12, 3
  s_add_u32 s12, s12, s8
  s_mul_i32 s12, s12, 6272
  v_min_u32 v18, 48, v1
  v_lshlrev_b32 v18, 7, v18
  buffer_load_dword v58, v18, s[60:63], s12 offen
  s_barrier
  s_add_u32 s12, s12, 200704
  buffer_load_dword v59, v18, s[60:63], s12 offen
  s_barrier
  s_add_u32 s13, s80, 71680
  buffer_load_dword v71, v15, s[76:79], s13 offen sc1
  s_barrier
  s_mov_b32 s13, 256
  buffer_load_dword v32, v16, s[64:67], s13 offen
  s_barrier
  s_mov_b32 s13, 401664
  buffer_load_dword v33, v16, s[64:67], s13 offen
  s_barrier
  s_mov_b32 s13, 803072
  buffer_load_dword v34, v16, s[64:67], s13 offen
  s_barrier
  s_mov_b32 s13, 1204480
  buffer_load_dword v35, v16, s[64:67], s13 offen
  s_barrier
  s_add_u32 s13, s80, 0
  buffer_load_dword v73, v15, s[76:79], s13 offen sc1
  s_barrier
  s_lshl_b32 s12, s6, 3
  s_add_u32 s12, s12, s8
  s_mul_i32 s13, s12, 6272
  s_mul_i32 s12, s12, 1664
  v_min_u32 v18, 48, v1
  v_lshlrev_b32 v18, 7, v18
  v_min_u32 v19, 12, v1
  v_lshlrev_b32 v19, 7, v19
  buffer_load_dword v62, v18, s[68:71], s13 offen
  s_barrier
  s_waitcnt vmcnt(0)
Lend:
  s_endpgm
Llrsc_2:
  s_waitcnt lgkmcnt(0)
  ds_read_b64 v[48:49], v28 offset:8
  s_waitcnt lgkmcnt(0)
  v_cmp_eq_u32 vcc, 0, v49
  s_nop 0
  s_cbranch_vccz Lldsc_1
  s_sub_u32 s11, s11, 1
  s_cbranch_scc0 Llrsc_2
  s_mov_b32 s11, 0
  s_branch Lldsc_1
Llrf3_4:
  s_waitcnt lgkmcnt(0)
  ds_read_b32 v15, v47
  s_waitcnt lgkmcnt(0)
  v_cmp_gt_u32 vcc, v16, v15
  s_nop 0
  s_cbranch_vccz Lldf3_3
  s_sub_u32 s11, s11, 1
  s_cbranch_scc0 Llrf3_4
  s_mov_b32 s11, 0
  s_branch Lldf3_3
Lprhello_6:
  s_waitcnt vmcnt(0)
  buffer_load_dword v14, v8, s[76:79], 0 offen sc1
  s_waitcnt vmcnt(0)
  v_and_b32 v16, -16, v14
  v_cmp_ne_u32 vcc, s9, v16
  s_nop 0
  s_cbranch_vccz Lpdhello_5
  s_sub_u32 s11, s11, 1
  s_cbranch_scc0 Lprhello_6
  s_mov_b32 s11, 0
  s_branch Lpdhello_5
Llrf3_10:
  s_waitcnt lgkmcnt(0)
  ds_read_b32 v15, v47
  s_waitcnt lgkmcnt(0)
  v_cmp_gt_u32 vcc, v16, v15
  s_nop 0
  s_cbranch_vccz Lldf3_9
  s_sub_u32 s11, s11, 1
  s_cbranch_scc0 Llrf3_10
  s_mov_b32 s11, 0
  s_branch Lldf3_9
Lprs1_12:
  s_waitcnt vmcnt(0)
  buffer_load_dwordx4 v[76:79], v50, s[76:79], s96 offen sc1
  buffer_load_dwordx4 v[80:83], v50, s[76:79], s97 offen sc1
  buffer_load_dwordx4 v[84:87], v50, s[76:79], s98 offen sc1
  buffer_load_dwordx4 v[88:91], v50, s[76:79], s99 offen sc1
  v_add_u32 v5, 1, v5
  ds_write_b32 v17, v5 offset:16
  s_waitcnt vmcnt(3)
  v_mfma_f32_16x16x32_bf16 v[144:147], v[252:255], v[76:79], 0
  s_waitcnt vmcnt(2)
  v_mfma_f32_16x16x32_bf16 v[144:147], v[252:255], v[80:83], v[144:147]
  s_waitcnt vmcnt(1)
  v_mfma_f32_16x16x32_bf16 v[144:147], v[252:255], v[84:87], v[144:147]
  s_waitcnt vmcnt(0)
  v_mfma_f32_16x16x32_bf16 v[144:147], v[252:255], v[88:91], v[144:147]
  s_nop 7
  v_cmp_u_f32 vcc, v144, v144
  s_nop 0
  s_cbranch_vccz Lpds1_11
  s_sub_u32 s11, s11, 1
  s_cbranch_scc0 Lprs1_12
  s_mov_b32 s11, 0
  s_branch Lpds1_11
Lprs2_14:
  s_waitcnt vmcnt(0)
  buffer_load_dwordx4 v[76:79], v4, s[76:79], s92 offen offset:0 sc1
  buffer_load_dwordx4 v[80:83], v4, s[76:79], s92 offen offset:1024 sc1
  buffer_load_dwordx4 v[84:87], v4, s[76:79], s92 offen offset:2048 sc1
  buffer_load_dwordx4 v[88:91], v4, s[76:79], s92 offen offset:3072 sc1
  v_add_u32 v5, 1, v5
  ds_write_b32 v17, v5 offset:16
  s_waitcnt vmcnt(2)
  v_max3_u32 v144, v76, v78, v80
  s_waitcnt vmcnt(1)
  v_max3_u32 v145, v82, v84, v86
  s_waitcnt vmcnt(0)
  v_max3_u32 v144, v144, v88, v90
  v_max_u32 v144, v144, v145
  v_cmp_eq_u32 vcc, -1, v144
  s_nop 0
  s_cbranch_vccz Lpds2_13
  s_sub_u32 s11, s11, 1
  s_cbranch_scc0 Lprs2_14
  s_mov_b32 s11, 0
  s_branch Lpds2_13
Llrf3_16:
  s_waitcnt lgkmcnt(0)
  ds_read_b32 v15, v47
  s_waitcnt lgkmcnt(0)
  v_cmp_gt_u32 vcc, v16, v15
  s_nop 0
  s_cbranch_vccz Lldf3_15
  s_sub_u32 s11, s11, 1
  s_cbranch_scc0 Llrf3_16
  s_mov_b32 s11, 0
  s_branch Lldf3_15
Llrf6_18:
  s_waitcnt lgkmcnt(0)
  ds_read_b32 v15, v47
  s_waitcnt lgkmcnt(0)
  v_cmp_gt_u32 vcc, 6, v15
  s_nop 0
  s_cbranch_vccz Lldf6_17
  s_sub_u32 s11, s11, 1
  s_cbranch_scc0 Llrf6_18
  s_mov_b32 s11, 0
  s_branch Lldf6_17
Lslow_19:
  buffer_store_dwordx4 v[76:79], v15, s[76:79], s12 offen sc1
  buffer_store_dwordx4 v[76:79], v15, s[76:79], s12 offen offset:1024 sc1
  buffer_store_dwordx4 v[76:79], v16, s[76:79], s12 offen sc1
  buffer_store_dwordx4 v[76:79], v15, s[76:79], s13 offen sc1
  buffer_store_dwordx4 v[76:79], v15, s[76:79], s13 offen offset:1024 sc1
  buffer_store_dwordx4 v[76:79], v16, s[76:79], s13 offen sc1
  buffer_store_dwordx4 v[76:79], v15, s[76:79], s14 offen sc1
  buffer_store_dwordx4 v[76:79], v15, s[76:79], s14 offen offset:1024 sc1
  buffer_store_dwordx4 v[76:79], v16, s[76:79], s14 offen sc1
  s_branch Lback_20
Llrf0_22:
  s_waitcnt lgkmcnt(0)
  ds_read_b32 v15, v47
  s_waitcnt lgkmcnt(0)
  v_cmp_gt_u32 vcc, v16, v15
  s_nop 0
  s_cbranch_vccz Lldf0_21
  s_sub_u32 s11, s11, 1
  s_cbranch_scc0 Llrf0_22
  s_mov_b32 s11, 0
  s_branch Lldf0_21
Llrg_26:
  s_waitcnt lgkmcnt(0)
  ds_read_b32 v24, v253
  s_waitcnt lgkmcnt(0)
  v_cmp_gt_u32 vcc, v25, v24
  s_nop 0
  s_cbranch_vccz Lldg_25
  s_sub_u32 s11, s11, 1
  s_cbranch_scc0 Llrg_26
  s_mov_b32 s11, 0
  s_branch Lldg_25
Llrx_28:
  s_waitcnt lgkmcnt(0)
  ds_read_b32 v24, v7 offset:32
  ds_read_b128 v[116:119], v6 offset:0
  ds_read_b128 v[120:123], v6 offset:1024
  ds_read_b128 v[124:127], v6 offset:2048
  ds_read_b128 v[128:131], v6 offset:3072
  s_waitcnt lgkmcnt(0)
  v_cmp_gt_u32 vcc, 1, v24
  s_nop 0
  s_cbranch_vccz Lldx_27
  s_sub_u32 s11, s11, 1
  s_cbranch_scc0 Llrx_28
  s_mov_b32 s11, 0
  s_branch Lldx_27
Lslow_29:
  buffer_store_dwordx4 v[76:79], v29, s[76:79], s96 offen sc1
  buffer_store_dwordx4 v[80:83], v29, s[76:79], s96 offen offset:1024 sc1
  buffer_store_dword v27, v18, s[76:79], 0 offen offset:128 sc1
  s_branch Lback_30
Lslow_31:
  buffer_store_dwordx3 v[88:90], v9, s[76:79], 0 offen sc1
  s_branch Lback_32
Llrg_34:
  s_waitcnt lgkmcnt(0)
  ds_read_b32 v24, v253
  s_waitcnt lgkmcnt(0)
  v_cmp_gt_u32 vcc, v25, v24
  s_nop 0
  s_cbranch_vccz Lldg_33
  s_sub_u32 s11, s11, 1
  s_cbranch_scc0 Llrg_34
  s_mov_b32 s11, 0
  s_branch Lldg_33
Llrg_38:
  s_waitcnt lgkmcnt(0)
  ds_read_b32 v24, v253
  s_waitcnt lgkmcnt(0)
  v_cmp_gt_u32 vcc, v25, v24
  s_nop 0
  s_cbranch_vccz Lldg_37
  s_sub_u32 s11, s11, 1
  s_cbranch_scc0 Llrg_38
  s_mov_b32 s11, 0
  s_branch Lldg_37
Lnr_40:
  s_nop 15
  s_waitcnt vmcnt(0)
  buffer_load_dwordx4 v[92:95], v28, s[76:79], s92 offen offset:0 sc1
  buffer_load_dwordx4 v[96:99], v28, s[76:79], s92 offen offset:1024 sc1
  buffer_load_dwordx4 v[100:103], v28, s[76:79], s92 offen offset:2048 sc1
  s_waitcnt vmcnt(2)
  v_mfma_f32_16x16x32_bf16 v[116:119], v[132:135], v[92:95], 0
  v_mfma_f32_16x16x32_bf16 v[120:123], v[136:139], v[92:95], 0
  v_mfma_f32_16x16x32_bf16 v[124:127], v[140:143], v[92:95], 0
  v_mfma_f32_16x16x32_bf16 v[128:131], v[144:147], v[92:95], 0
  s_waitcnt vmcnt(1)
  v_mfma_f32_16x16x32_bf16 v[116:119], v[148:151], v[96:99], v[116:119]
  v_mfma_f32_16x16x32_bf16 v[120:123], v[152:155], v[96:99], v[120:123]
  v_mfma_f32_16x16x32_bf16 v[124:127], v[156:159], v[96:99], v[124:127]
  v_mfma_f32_16x16x32_bf16 v[128:131], v[160:163], v[96:99], v[128:131]
  s_waitcnt vmcnt(0)
  v_mfma_f32_16x16x32_bf16 v[116:119], v[164:167], v[100:103], v[116:119]
  v_mfma_f32_16x16x32_bf16 v[120:123], v[168:171], v[100:103], v[120:123]
  v_mfma_f32_16x16x32_bf16 v[124:127], v[172:175], v[100:103], v[124:127]
  v_mfma_f32_16x16x32_bf16 v[128:131], v[176:179], v[100:103], v[128:131]
  s_nop 15
  buffer_load_dwordx4 v[92:95], v28, s[76:79], s92 offen offset:3072 sc1
  buffer_load_dwordx4 v[96:99], v28, s[76:79], s93 offen offset:0 sc1
  buffer_load_dwordx4 v[100:103], v28, s[76:79], s93 offen offset:1024 sc1
  s_waitcnt vmcnt(2)
  v_mfma_f32_16x16x32_bf16 v[116:119], v[180:183], v[92:95], v[116:119]
  v_mfma_f32_16x16x32_bf16 v[120:123], v[184:187], v[92:95], v[120:123]
  v_mfma_f32_16x16x32_bf16 v[124:127], v[188:191], v[92:95], v[124:127]
  v_mfma_f32_16x16x32_bf16 v[128:131], v[192:195], v[92:95], v[128:131]
  s_waitcnt vmcnt(1)
  v_mfma_f32_16x16x32_bf16 v[116:119], v[196:199], v[96:99], v[116:119]
  v_mfma_f32_16x16x32_bf16 v[120:123], v[200:203], v[96:99], v[120:123]
  v_mfma_f32_16x16x32_bf16 v[124:127], v[204:207], v[96:99], v[124:127]
  v_mfma_f32_16x16x32_bf16 v[128:131], v[208:211], v[96:99], v[128:131]
  s_waitcnt vmcnt(0)
  v_mfma_f32_16x16x32_bf16 v[116:119], v[212:215], v[100:103], v[116:119]
  v_mfma_f32_16x16x32_bf16 v[120:123], v[216:219], v[100:103], v[120:123]
  v_mfma_f32_16x16x32_bf16 v[124:127], v[220:223], v[100:103], v[124:127]
  v_mfma_f32_16x16x32_bf16 v[128:131], v[224:227], v[100:103], v[128:131]
  s_nop 15
  buffer_load_dwordx4 v[92:95], v28, s[76:79], s93 offen offset:2048 sc1
  s_waitcnt vmcnt(0)
  v_mfma_f32_16x16x32_bf16 v[116:119], v[228:231], v[92:95], v[116:119]
  v_mfma_f32_16x16x32_bf16 v[120:123], v[232:235], v[92:95], v[120:123]
  v_mfma_f32_16x16x32_bf16 v[124:127], v[236:239], v[92:95], v[124:127]
  v_mfma_f32_16x16x32_bf16 v[128:131], v[240:243], v[92:95], v[128:131]
  s_nop 15
  v_cmp_u_f32 vcc, v116, v116
  s_nop 0
  s_cbranch_vccz Lnd_39
  s_sub_u32 s11, s11, 1
  s_cbranch_scc0 Lnr_40
  s_mov_b32 s11, 0
  s_branch Lnd_39
Lprhs_42:
  s_waitcnt vmcnt(0)
  buffer_load_dwordx3 v[32:34], v30, s[76:79], 0 offen sc1
  buffer_load_dwordx3 v[36:38], v31, s[76:79], 0 offen sc1
  s_waitcnt vmcnt(1)
  v_cmp_ne_u32 vcc, s85, v34
  s_waitcnt vmcnt(0)
  v_cmp_ne_u32 s[14:15], s85, v38
  s_nop 0
  s_or_b64 vcc, vcc, s[14:15]
  s_cbranch_vccz Lpdhs_41
  s_sub_u32 s11, s11, 1
  s_cbranch_scc0 Lprhs_42
  s_mov_b32 s11, 0
  s_branch Lpdhs_41
Llrx_44:
  s_waitcnt lgkmcnt(0)
  ds_read_b32 v24, v7 offset:32
  ds_read_b128 v[116:119], v6 offset:0
  ds_read_b128 v[120:123], v6 offset:1024
  ds_read_b128 v[124:127], v6 offset:2048
  ds_read_b128 v[128:131], v6 offset:3072
  s_waitcnt lgkmcnt(0)
  v_cmp_gt_u32 vcc, 2, v24
  s_nop 0
  s_cbranch_vccz Lldx_43
  s_sub_u32 s11, s11, 1
  s_cbranch_scc0 Llrx_44
  s_mov_b32 s11, 0
  s_branch Lldx_43
Lnr_46:
  s_nop 15
  s_waitcnt vmcnt(0)
  buffer_load_dwordx4 v[76:79], v28, s[76:79], s94 offen offset:0 sc1
  buffer_load_dwordx4 v[80:83], v28, s[76:79], s94 offen offset:1024 sc1
  buffer_load_dwordx4 v[84:87], v28, s[76:79], s94 offen offset:2048 sc1
  buffer_load_dwordx4 v[88:91], v28, s[76:79], s94 offen offset:3072 sc1
  buffer_load_dwordx4 v[108:111], v28, s[76:79], s95 offen offset:0 sc1
  buffer_load_dwordx4 v[112:115], v28, s[76:79], s95 offen offset:1024 sc1
  s_waitcnt vmcnt(5)
  v_mfma_f32_16x16x32_bf16 v[44:47], v[132:135], v[76:79], 0
  v_mfma_f32_16x16x32_bf16 v[48:51], v[136:139], v[76:79], 0
  v_mfma_f32_16x16x32_bf16 v[52:55], v[140:143], v[76:79], 0
  v_mfma_f32_16x16x32_bf16 v[56:59], v[144:147], v[76:79], 0
  s_waitcnt vmcnt(4)
  v_mfma_f32_16x16x32_bf16 v[44:47], v[148:151], v[80:83], v[44:47]
  v_mfma_f32_16x16x32_bf16 v[48:51], v[152:155], v[80:83], v[48:51]
  v_mfma_f32_16x16x32_bf16 v[52:55], v[156:159], v[80:83], v[52:55]
  v_mfma_f32_16x16x32_bf16 v[56:59], v[160:163], v[80:83], v[56:59]
  s_waitcnt vmcnt(3)
  v_mfma_f32_16x16x32_bf16 v[44:47], v[164:167], v[84:87], v[44:47]
  v_mfma_f32_16x16x32_bf16 v[48:51], v[168:171], v[84:87], v[48:51]
  v_mfma_f32_16x16x32_bf16 v[52:55], v[172:175], v[84:87], v[52:55]
  v_mfma_f32_16x16x32_bf16 v[56:59], v[176:179], v[84:87], v[56:59]
  s_waitcnt vmcnt(2)
  v_mfma_f32_16x16x32_bf16 v[44:47], v[180:183], v[88:91], v[44:47]
  v_mfma_f32_16x16x32_bf16 v[48:51], v[184:187], v[88:91], v[48:51]
  v_mfma_f32_16x16x32_bf16 v[52:55], v[188:191], v[88:91], v[52:55]
  v_mfma_f32_16x16x32_bf16 v[56:59], v[192:195], v[88:91], v[56:59]
  s_waitcnt vmcnt(1)
  v_mfma_f32_16x16x32_bf16 v[44:47], v[196:199], v[108:111], v[44:47]
  v_mfma_f32_16x16x32_bf16 v[48:51], v[200:203], v[108:111], v[48:51]
  v_mfma_f32_16x16x32_bf16 v[52:55], v[204:207], v[108:111], v[52:55]
  v_mfma_f32_16x16x32_bf16 v[56:59], v[208:211], v[108:111], v[56:59]
  s_waitcnt vmcnt(0)
  v_mfma_f32_16x16x32_bf16 v[44:47], v[212:215], v[112:115], v[44:47]
  v_mfma_f32_16x16x32_bf16 v[48:51], v[216:219], v[112:115], v[48:51]
  v_mfma_f32_16x16x32_bf16 v[52:55], v[220:223], v[112:115], v[52:55]
  v_mfma_f32_16x16x32_bf16 v[56:59], v[224:227], v[112:115], v[56:59]
  s_nop 15
  buffer_load_dwordx4 v[76:79], v28, s[76:79], s95 offen offset:2048 sc1
  s_waitcnt vmcnt(0)
  v_mfma_f32_16x16x32_bf16 v[44:47], v[228:231], v[76:79], v[44:47]
  v_mfma_f32_16x16x32_bf16 v[48:51], v[232:235], v[76:79], v[48:51]
  v_mfma_f32_16x16x32_bf16 v[52:55], v[236:239], v[76:79], v[52:55]
  v_mfma_f32_16x16x32_bf16 v[56:59], v[240:243], v[76:79], v[56:59]
  s_nop 15
  v_cmp_u_f32 vcc, v44, v44
  s_nop 0
  s_cbranch_vccz Lnd_45
  s_sub_u32 s11, s11, 1
  s_cbranch_scc0 Lnr_46
  s_mov_b32 s11, 0
  s_branch Lnd_45
Lslow_47:
  buffer_store_dwordx4 v[92:95], v29, s[76:79], s96 offen offset:0 sc1
  s_branch Lback_48
Lslow_49:
  buffer_store_dwordx4 v[96:99], v29, s[76:79], s96 offen offset:1024 sc1
  buffer_store_dword v27, v18, s[76:79], 0 offen sc1
  s_branch Lback_50
Llrg_52:
  s_waitcnt lgkmcnt(0)
  ds_read_b32 v24, v253
  s_waitcnt lgkmcnt(0)
  v_cmp_gt_u32 vcc, v25, v24
  s_nop 0
  s_cbranch_vccz Lldg_51
  s_sub_u32 s11, s11, 1
  s_cbranch_scc0 Llrg_52
  s_mov_b32 s11, 0
  s_branch Lldg_51
Lprhl_56:
  s_waitcnt vmcnt(0)
  buffer_load_dword v17, v19, s[76:79], 0 offen sc1
  s_waitcnt vmcnt(0)
  v_cmp_eq_u32 vcc, -1, v17
  s_nop 0
  s_cbranch_vccz Lpdhl_55
  s_sub_u32 s11, s11, 1
  s_cbranch_scc0 Lprhl_56
  s_mov_b32 s11, 0
  s_branch Lpdhl_55
Llrg_58:
  s_waitcnt lgkmcnt(0)
  ds_read_b32 v24, v253
  s_waitcnt lgkmcnt(0)
  v_cmp_gt_u32 vcc, v25, v24
  s_nop 0
  s_cbranch_vccz Lldg_57
  s_sub_u32 s11, s11, 1
  s_cbranch_scc0 Llrg_58
  s_mov_b32 s11, 0
  s_branch Lldg_57
Lnr_60:
  s_nop 15
  s_waitcnt vmcnt(0)
  buffer_load_dwordx4 v[92:95], v244, s[76:79], s92 offen offset:0 sc1
  buffer_load_dwordx4 v[96:99], v244, s[76:79], s92 offen offset:1024 sc1
  buffer_load_dwordx4 v[100:103], v244, s[76:79], s92 offen offset:2048 sc1
  s_waitcnt vmcnt(2)
  v_mfma_f32_16x16x32_bf16 v[116:119], v[132:135], v[92:95], 0
  v_mfma_f32_16x16x32_bf16 v[120:123], v[136:139], v[92:95], 0
  v_mfma_f32_16x16x32_bf16 v[124:127], v[140:143], v[92:95], 0
  v_mfma_f32_16x16x32_bf16 v[128:131], v[144:147], v[92:95], 0
  s_waitcnt vmcnt(1)
  v_mfma_f32_16x16x32_bf16 v[116:119], v[148:151], v[96:99], v[116:119]
  v_mfma_f32_16x16x32_bf16 v[120:123], v[152:155], v[96:99], v[120:123]
  v_mfma_f32_16x16x32_bf16 v[124:127], v[156:159], v[96:99], v[124:127]
  v_mfma_f32_16x16x32_bf16 v[128:131], v[160:163], v[96:99], v[128:131]
  s_waitcnt vmcnt(0)
  v_mfma_f32_16x16x32_bf16 v[116:119], v[164:167], v[100:103], v[116:119]
  v_mfma_f32_16x16x32_bf16 v[120:123], v[168:171], v[100:103], v[120:123]
  v_mfma_f32_16x16x32_bf16 v[124:127], v[172:175], v[100:103], v[124:127]
  v_mfma_f32_16x16x32_bf16 v[128:131], v[176:179], v[100:103], v[128:131]
  s_nop 15
  buffer_load_dwordx4 v[92:95], v245, s[76:79], s93 offen offset:0 sc1
  buffer_load_dwordx4 v[96:99], v245, s[76:79], s93 offen offset:1024 sc1
  buffer_load_dwordx4 v[100:103], v245, s[76:79], s93 offen offset:2048 sc1
  s_waitcnt vmcnt(2)
  v_mfma_f32_16x16x32_bf16 v[116:119], v[180:183], v[92:95], v[116:119]
  v_mfma_f32_16x16x32_bf16 v[120:123], v[184:187], v[92:95], v[120:123]
  v_mfma_f32_16x16x32_bf16 v[124:127], v[188:191], v[92:95], v[124:127]
  v_mfma_f32_16x16x32_bf16 v[128:131], v[192:195], v[92:95], v[128:131]
  s_waitcnt vmcnt(1)
  v_mfma_f32_16x16x32_bf16 v[116:119], v[196:199], v[96:99], v[116:119]
  v_mfma_f32_16x16x32_bf16 v[120:123], v[200:203], v[96:99], v[120:123]
  v_mfma_f32_16x16x32_bf16 v[124:127], v[204:207], v[96:99], v[124:127]
  v_mfma_f32_16x16x32_bf16 v[128:131], v[208:211], v[96:99], v[128:131]
  s_waitcnt vmcnt(0)
  v_mfma_f32_16x16x32_bf16 v[116:119], v[212:215], v[100:103], v[116:119]
  v_mfma_f32_16x16x32_bf16 v[120:123], v[216:219], v[100:103], v[120:123]
  v_mfma_f32_16x16x32_bf16 v[124:127], v[220:223], v[100:103], v[124:127]
  v_mfma_f32_16x16x32_bf16 v[128:131], v[224:227], v[100:103], v[128:131]
  s_nop 15
  buffer_load_dwordx4 v[92:95], v246, s[76:79], s92 offen offset:0 sc1
  s_waitcnt vmcnt(0)
  v_mfma_f32_16x16x32_bf16 v[116:119], v[228:231], v[92:95], v[116:119]
  v_mfma_f32_16x16x32_bf16 v[120:123], v[232:235], v[92:95], v[120:123]
  v_mfma_f32_16x16x32_bf16 v[124:127], v[236:239], v[92:95], v[124:127]
  v_mfma_f32_16x16x32_bf16 v[128:131], v[240:243], v[92:95], v[128:131]
  s_nop 15
  v_cmp_u_f32 vcc, v116, v116
  s_nop 0
  s_cbranch_vccz Lnd_59
  s_sub_u32 s11, s11, 1
  s_cbranch_scc0 Lnr_60
  s_mov_b32 s11, 0
  s_branch Lnd_59
Llrx_62:
  s_waitcnt lgkmcnt(0)
  ds_read_b32 v24, v7 offset:32
  ds_read_b128 v[116:119], v6 offset:0
  ds_read_b128 v[120:123], v6 offset:1024
  ds_read_b128 v[124:127], v6 offset:2048
  ds_read_b128 v[128:131], v6 offset:3072
  s_waitcnt lgkmcnt(0)
  v_cmp_gt_u32 vcc, 3, v24
  s_nop 0
  s_cbranch_vccz Lldx_61
  s_sub_u32 s11, s11, 1
  s_cbranch_scc0 Llrx_62
  s_mov_b32 s11, 0
  s_branch Lldx_61
Lnr_64:
  s_nop 15
  s_waitcnt vmcnt(0)
  v_pk_fma_f32 v[44:45], v[60:61], v[36:37], v[12:13] op_sel_hi:[1,0,0]
  v_pk_fma_f32 v[46:47], v[62:63], v[36:37], v[12:13] op_sel_hi:[1,0,0]
  v_pk_fma_f32 v[48:49], v[64:65], v[36:37], v[12:13] op_sel_hi:[1,0,0]
  v_pk_fma_f32 v[50:51], v[66:67], v[36:37], v[12:13] op_sel_hi:[1,0,0]
  v_pk_fma_f32 v[52:53], v[68:69], v[36:37], v[12:13] op_sel_hi:[1,0,0]
  v_pk_fma_f32 v[54:55], v[70:71], v[36:37], v[12:13] op_sel_hi:[1,0,0]
  v_pk_fma_f32 v[56:57], v[72:73], v[36:37], v[12:13] op_sel_hi:[1,0,0]
  v_pk_fma_f32 v[58:59], v[74:75], v[36:37], v[12:13] op_sel_hi:[1,0,0]
  buffer_load_dwordx4 v[76:79], v247, s[76:79], s92 offen offset:0 sc1
  buffer_load_dwordx4 v[80:83], v247, s[76:79], s92 offen offset:1024 sc1
  buffer_load_dwordx4 v[84:87], v247, s[76:79], s92 offen offset:2048 sc1
  buffer_load_dwordx4 v[88:91], v248, s[76:79], s93 offen offset:0 sc1
  buffer_load_dwordx4 v[108:111], v248, s[76:79], s93 offen offset:1024 sc1
  buffer_load_dwordx4 v[112:115], v248, s[76:79], s93 offen offset:2048 sc1
  s_waitcnt vmcnt(5)
  v_mfma_f32_16x16x32_bf16 v[44:47], v[132:135], v[76:79], v[44:47]
  v_mfma_f32_16x16x32_bf16 v[48:51], v[136:139], v[76:79], v[48:51]
  v_mfma_f32_16x16x32_bf16 v[52:55], v[140:143], v[76:79], v[52:55]
  v_mfma_f32_16x16x32_bf16 v[56:59], v[144:147], v[76:79], v[56:59]
  s_waitcnt vmcnt(4)
  v_mfma_f32_16x16x32_bf16 v[44:47], v[148:151], v[80:83], v[44:47]
  v_mfma_f32_16x16x32_bf16 v[48:51], v[152:155], v[80:83], v[48:51]
  v_mfma_f32_16x16x32_bf16 v[52:55], v[156:159], v[80:83], v[52:55]
  v_mfma_f32_16x16x32_bf16 v[56:59], v[160:163], v[80:83], v[56:59]
  s_waitcnt vmcnt(3)
  v_mfma_f32_16x16x32_bf16 v[44:47], v[164:167], v[84:87], v[44:47]
  v_mfma_f32_16x16x32_bf16 v[48:51], v[168:171], v[84:87], v[48:51]
  v_mfma_f32_16x16x32_bf16 v[52:55], v[172:175], v[84:87], v[52:55]
  v_mfma_f32_16x16x32_bf16 v[56:59], v[176:179], v[84:87], v[56:59]
  s_waitcnt vmcnt(2)
  v_mfma_f32_16x16x32_bf16 v[44:47], v[180:183], v[88:91], v[44:47]
  v_mfma_f32_16x16x32_bf16 v[48:51], v[184:187], v[88:91], v[48:51]
  v_mfma_f32_16x16x32_bf16 v[52:55], v[188:191], v[88:91], v[52:55]
  v_mfma_f32_16x16x32_bf16 v[56:59], v[192:195], v[88:91], v[56:59]
  s_waitcnt vmcnt(1)
  v_mfma_f32_16x16x32_bf16 v[44:47], v[196:199], v[108:111], v[44:47]
  v_mfma_f32_16x16x32_bf16 v[48:51], v[200:203], v[108:111], v[48:51]
  v_mfma_f32_16x16x32_bf16 v[52:55], v[204:207], v[108:111], v[52:55]
  v_mfma_f32_16x16x32_bf16 v[56:59], v[208:211], v[108:111], v[56:59]
  s_waitcnt vmcnt(0)
  v_mfma_f32_16x16x32_bf16 v[44:47], v[212:215], v[112:115], v[44:47]
  v_mfma_f32_16x16x32_bf16 v[48:51], v[216:219], v[112:115], v[48:51]
  v_mfma_f32_16x16x32_bf16 v[52:55], v[220:223], v[112:115], v[52:55]
  v_mfma_f32_16x16x32_bf16 v[56:59], v[224:227], v[112:115], v[56:59]
  s_nop 15
  buffer_load_dwordx4 v[76:79], v249, s[76:79], s92 offen offset:0 sc1
  s_waitcnt vmcnt(0)
  v_mfma_f32_16x16x32_bf16 v[44:47], v[228:231], v[76:79], v[44:47]
  v_mfma_f32_16x16x32_bf16 v[48:51], v[232:235], v[76:79], v[48:51]
  v_mfma_f32_16x16x32_bf16 v[52:55], v[236:239], v[76:79], v[52:55]
  v_mfma_f32_16x16x32_bf16 v[56:59], v[240:243], v[76:79], v[56:59]
  s_nop 15
  v_cmp_u_f32 vcc, v44, v44
  s_nop 0
  s_cbranch_vccz Lnd_63
  s_sub_u32 s11, s11, 1
  s_cbranch_scc0 Lnr_64
  s_mov_b32 s11, 0
  s_branch Lnd_63
Lslow_65:
  buffer_store_dwordx4 v[76:79], v29, s[76:79], s96 offen sc1
  buffer_store_dwordx4 v[80:83], v29, s[76:79], s96 offen offset:1024 sc1
  s_branch Lback_66
Lslow_67:
  buffer_store_dwordx3 v[88:90], v9, s[76:79], 0 offen sc1
  s_branch Lback_68
Llrg_70:
  s_waitcnt lgkmcnt(0)
  ds_read_b32 v24, v26
  s_waitcnt lgkmcnt(0)
  v_cmp_gt_u32 vcc, v25, v24
  s_nop 0
  s_cbranch_vccz Lldg_69
  s_sub_u32 s11, s11, 1
  s_cbranch_scc0 Llrg_70
  s_mov_b32 s11, 0
  s_branch Lldg_69
Lprxs_72:
  s_waitcnt vmcnt(0)
  buffer_load_dwordx3 v[60:62], v30, s[76:79], 0 offen sc1
  buffer_load_dwordx3 v[64:66], v31, s[76:79], 0 offen sc1
  s_waitcnt vmcnt(1)
  v_cmp_ne_u32 vcc, s85, v62
  s_waitcnt vmcnt(0)
  v_cmp_ne_u32 s[14:15], s85, v66
  s_nop 0
  s_or_b64 vcc, vcc, s[14:15]
  s_cbranch_vccz Lpdxs_71
  s_sub_u32 s11, s11, 1
  s_cbranch_scc0 Lprxs_72
  s_mov_b32 s11, 0
  s_branch Lpdxs_71
Lxr_74:
  s_mul_i32 s12, s84, 7168
  s_mov_b32 s13, 28672
  s_add_u32 m0, s12, 28672
  s_nop 0
  buffer_load_dwordx4 v28, s[76:79], s13 offen offset:0 sc1 lds
  buffer_load_dwordx4 v28, s[76:79], s13 offen offset:1024 sc1 lds
  buffer_load_dwordx4 v28, s[76:79], s13 offen offset:2048 sc1 lds
  buffer_load_dwordx4 v28, s[76:79], s13 offen offset:3072 sc1 lds
  s_mov_b32 s13, 32768
  s_add_u32 m0, s12, 32768
  s_nop 0
  buffer_load_dwordx4 v28, s[76:79], s13 offen offset:0 sc1 lds
  buffer_load_dwordx4 v28, s[76:79], s13 offen offset:1024 sc1 lds
  buffer_load_dwordx4 v28, s[76:79], s13 offen offset:2048 sc1 lds
  s_waitcnt vmcnt(0)
  ds_read_b32 v40, v17 offset:28672
  ds_read_b32 v41, v17 offset:31744
  s_waitcnt lgkmcnt(0)
  v_max_u32 v40, v40, v41
  v_cmp_eq_u32 vcc, -1, v40
  s_nop 0
  s_cbranch_vccz Lxd_73
  s_sub_u32 s11, s11, 1
  s_cbranch_scc0 Lxr_74
  s_mov_b32 s11, 0
  s_branch Lxd_73
Llrg_76:
  s_waitcnt lgkmcnt(0)
  ds_read_b32 v24, v26
  s_waitcnt lgkmcnt(0)
  v_cmp_gt_u32 vcc, v25, v24
  s_nop 0
  s_cbranch_vccz Lldg_75
  s_sub_u32 s11, s11, 1
  s_cbranch_scc0 Llrg_76
  s_mov_b32 s11, 0
  s_branch Lldg_75
Llrg_78:
  s_waitcnt lgkmcnt(0)
  ds_read_b32 v24, v26
  s_waitcnt lgkmcnt(0)
  v_cmp_gt_u32 vcc, v25, v24
  s_nop 0
  s_cbranch_vccz Lldg_77
  s_sub_u32 s11, s11, 1
  s_cbranch_scc0 Llrg_78
  s_mov_b32 s11, 0
  s_branch Lldg_77
Llrg_80:
  s_waitcnt lgkmcnt(0)
  ds_read_b32 v24, v26
  s_waitcnt lgkmcnt(0)
  v_cmp_gt_u32 vcc, v25, v24
  s_nop 0
  s_cbranch_vccz Lldg_79
  s_sub_u32 s11, s11, 1
  s_cbranch_scc0 Llrg_80
  s_mov_b32 s11, 0
  s_branch Lldg_79
Lprxd_82:
  s_waitcnt vmcnt(0)
  buffer_load_dword v8, v12, s[76:79], 0 offen sc1
  s_waitcnt vmcnt(0)
  v_cmp_ne_u32 vcc, s85, v8
  s_nop 0
  s_cbranch_vccz Lpdxd_81
  s_sub_u32 s11, s11, 1
  s_cbranch_scc0 Lprxd_82
  s_mov_b32 s11, 0
  s_branch Lpdxd_81
Lslow_83:
  buffer_store_dwordx4 v[100:103], v7, s[76:79], s94 offen offset:0 sc1
  s_branch Lback_84
Lslow_85:
  buffer_store_dwordx4 v[104:107], v7, s[76:79], s94 offen offset:1024 sc1
  s_branch Lback_86
Lslow_87:
  buffer_store_dword v27, v9, s[76:79], 0 offen offset:384 sc1
  s_branch Lback_88
Lprn0_90:
  s_waitcnt vmcnt(0)
  buffer_load_dword v16, v12, s[76:79], 0 offen offset:384 sc1
  s_waitcnt vmcnt(0)
  v_cmp_ne_u32 vcc, s9, v16
  s_nop 0
  s_cbranch_vccz Lpdn0_89
  s_sub_u32 s11, s11, 1
  s_cbranch_scc0 Lprn0_90
  s_mov_b32 s11, 0
  s_branch Lpdn0_89
Lslow_91:
  buffer_store_dwordx4 v[76:79], v7, s[76:79], s94 offen offset:2048 sc1
  s_branch Lback_92
Lslow_93:
  buffer_store_dwordx4 v[80:83], v7, s[76:79], s94 offen offset:3072 sc1
  s_branch Lback_94
Llrg_96:
  s_waitcnt lgkmcnt(0)
  ds_read_b32 v24, v26
  s_waitcnt lgkmcnt(0)
  v_cmp_gt_u32 vcc, v25, v24
  s_nop 0
  s_cbranch_vccz Lldg_95
  s_sub_u32 s11, s11, 1
  s_cbranch_scc0 Llrg_96
  s_mov_b32 s11, 0
  s_branch Lldg_95
Lslow_97:
  buffer_store_dword v27, v9, s[76:79], 0 offen offset:640 sc1
  s_branch Lback_98
Lprn1_100:
  s_waitcnt vmcnt(0)
  buffer_load_dword v16, v12, s[76:79], 0 offen offset:640 sc1
  s_waitcnt vmcnt(0)
  v_cmp_ne_u32 vcc, s9, v16
  s_nop 0
  s_cbranch_vccz Lpdn1_99
  s_sub_u32 s11, s11, 1
  s_cbranch_scc0 Lprn1_100
  s_mov_b32 s11, 0
  s_branch Lpdn1_99
Llrg_102:
  s_waitcnt lgkmcnt(0)
  ds_read_b32 v24, v26
  s_waitcnt lgkmcnt(0)
  v_cmp_gt_u32 vcc, v25, v24
  s_nop 0
  s_cbranch_vccz Lldg_101
  s_sub_u32 s11, s11, 1
  s_cbranch_scc0 Llrg_102
  s_mov_b32 s11, 0
  s_branch Lldg_101
Ltr_104:
  s_waitcnt vmcnt(0) lgkmcnt(0)
  s_add_u32 m0, s95, 28672
  s_lshl_b32 s93, s92, 5
  buffer_load_dwordx4 v48, s[76:79], s93 offen sc1 lds
  s_add_u32 s92, s92, 128
  s_cmp_eq_u32 s92, 896
  s_cselect_b32 s92, 0, s92
  s_add_u32 m0, s95, 32768
  s_lshl_b32 s93, s92, 5
  buffer_load_dwordx4 v48, s[76:79], s93 offen sc1 lds
  s_add_u32 s92, s92, 128
  s_cmp_eq_u32 s92, 896
  s_cselect_b32 s92, 0, s92
  s_add_u32 m0, s95, 36864
  s_lshl_b32 s93, s92, 5
  buffer_load_dwordx4 v48, s[76:79], s93 offen sc1 lds
  s_add_u32 s92, s92, 128
  s_cmp_eq_u32 s92, 896
  s_cselect_b32 s92, 0, s92
  s_add_u32 m0, s95, 40960
  s_lshl_b32 s93, s92, 5
  buffer_load_dwordx4 v48, s[76:79], s93 offen sc1 lds
  s_add_u32 s92, s92, 128
  s_cmp_eq_u32 s92, 896
  s_cselect_b32 s92, 0, s92
  s_add_u32 m0, s95, 45056
  s_lshl_b32 s93, s92, 5
  buffer_load_dwordx4 v48, s[76:79], s93 offen sc1 lds
  s_add_u32 s92, s92, 128
  s_cmp_eq_u32 s92, 896
  s_cselect_b32 s92, 0, s92
  s_add_u32 m0, s95, 49152
  s_lshl_b32 s93, s92, 5
  buffer_load_dwordx4 v48, s[76:79], s93 offen sc1 lds
  s_add_u32 s92, s92, 128
  s_cmp_eq_u32 s92, 896
  s_cselect_b32 s92, 0, s92
  s_add_u32 m0, s95, 53248
  s_lshl_b32 s93, s92, 5
  buffer_load_dwordx4 v48, s[76:79], s93 offen sc1 lds
  s_add_u32 s92, s92, 128
  s_cmp_eq_u32 s92, 896
  s_cselect_b32 s92, 0, s92
  s_waitcnt vmcnt(0)
  ds_read_b32 v44, v49 offset:0
  ds_read_b32 v45, v49 offset:12288
  s_waitcnt lgkmcnt(0)
  v_cmp_ne_u32 vcc, s85, v44
  v_cmp_ne_u32 s[14:15], s85, v45
  s_nop 0
  s_or_b64 vcc, vcc, s[14:15]
  s_cbranch_vccz Ltd_103
  s_sub_u32 s11, s11, 1
  s_cbranch_scc0 Ltr_104
  s_mov_b32 s11, 0
  s_branch Ltd_103
Llrf1_106:
  s_waitcnt lgkmcnt(0)
  ds_read_b32 v15, v47
  s_waitcnt lgkmcnt(0)
  v_cmp_gt_u32 vcc, 1, v15
  s_nop 0
  s_cbranch_vccz Lldf1_105
  s_sub_u32 s11, s11, 1
  s_cbranch_scc0 Llrf1_106
  s_mov_b32 s11, 0
  s_branch Lldf1_105
Llrf2_108:
  s_waitcnt lgkmcnt(0)
  ds_read_b32 v15, v47
  ds_read_b64 v[208:209], v8 offset:0
  ds_read_b64 v[212:213], v8 offset:128
  s_waitcnt lgkmcnt(0)
  v_cmp_gt_u32 vcc, 2, v15
  s_nop 0
  s_cbranch_vccz Lldf2_107
  s_sub_u32 s11, s11, 1
  s_cbranch_scc0 Llrf2_108
  s_mov_b32 s11, 0
  s_branch Lldf2_107
Ltr_110:
  s_waitcnt vmcnt(0) lgkmcnt(0)
  s_add_u32 m0, s97, 0
  s_lshl_b32 s93, s92, 5
  s_add_u32 s93, s93, 458752
  buffer_load_dwordx4 v48, s[76:79], s93 offen sc1 lds
  s_add_u32 s92, s92, 128
  s_cmp_eq_u32 s92, 896
  s_cselect_b32 s92, 0, s92
  s_add_u32 m0, s97, 1024
  s_lshl_b32 s93, s92, 5
  s_add_u32 s93, s93, 458752
  buffer_load_dwordx4 v48, s[76:79], s93 offen sc1 lds
  s_add_u32 s92, s92, 128
  s_cmp_eq_u32 s92, 896
  s_cselect_b32 s92, 0, s92
  s_add_u32 m0, s97, 2048
  s_lshl_b32 s93, s92, 5
  s_add_u32 s93, s93, 458752
  buffer_load_dwordx4 v48, s[76:79], s93 offen sc1 lds
  s_add_u32 s92, s92, 128
  s_cmp_eq_u32 s92, 896
  s_cselect_b32 s92, 0, s92
  s_add_u32 m0, s97, 3072
  s_lshl_b32 s93, s92, 5
  s_add_u32 s93, s93, 458752
  buffer_load_dwordx4 v48, s[76:79], s93 offen sc1 lds
  s_add_u32 s92, s92, 128
  s_cmp_eq_u32 s92, 896
  s_cselect_b32 s92, 0, s92
  s_add_u32 m0, s97, 4096
  s_lshl_b32 s93, s92, 5
  s_add_u32 s93, s93, 458752
  buffer_load_dwordx4 v48, s[76:79], s93 offen sc1 lds
  s_add_u32 s92, s92, 128
  s_cmp_eq_u32 s92, 896
  s_cselect_b32 s92, 0, s92
  s_add_u32 m0, s97, 5120
  s_lshl_b32 s93, s92, 5
  s_add_u32 s93, s93, 458752
  buffer_load_dwordx4 v48, s[76:79], s93 offen sc1 lds
  s_add_u32 s92, s92, 128
  s_cmp_eq_u32 s92, 896
  s_cselect_b32 s92, 0, s92
  s_add_u32 m0, s97, 6144
  s_lshl_b32 s93, s92, 5
  s_add_u32 s93, s93, 458752
  buffer_load_dwordx4 v48, s[76:79], s93 offen sc1 lds
  s_add_u32 s92, s92, 128
  s_cmp_eq_u32 s92, 896
  s_cselect_b32 s92, 0, s92
  s_waitcnt vmcnt(0)
  ds_read_b32 v44, v50 offset:0
  ds_read_b32 v45, v50 offset:3072
  s_waitcnt lgkmcnt(0)
  v_cmp_ne_u32 vcc, s85, v44
  v_cmp_ne_u32 s[14:15], s85, v45
  s_nop 0
  s_or_b64 vcc, vcc, s[14:15]
  s_cbranch_vccz Ltd_109
  s_sub_u32 s11, s11, 1
  s_cbranch_scc0 Ltr_110
  s_mov_b32 s11, 0
  s_branch Ltd_109
Llrf4_112:
  s_waitcnt lgkmcnt(0)
  ds_read_b32 v15, v47
  s_waitcnt lgkmcnt(0)
  v_cmp_gt_u32 vcc, 4, v15
  s_nop 0
  s_cbranch_vccz Lldf4_111
  s_sub_u32 s11, s11, 1
  s_cbranch_scc0 Llrf4_112
  s_mov_b32 s11, 0
  s_branch Lldf4_111
Llrf5_114:
  s_waitcnt lgkmcnt(0)
  ds_read_b32 v15, v47
  ds_read_b64 v[208:209], v8 offset:512
  ds_read_b64 v[212:213], v8 offset:640
  s_waitcnt lgkmcnt(0)
  v_cmp_gt_u32 vcc, 5, v15
  s_nop 0
  s_cbranch_vccz Lldf5_113
  s_sub_u32 s11, s11, 1
  s_cbranch_scc0 Llrf5_114
  s_mov_b32 s11, 0
  s_branch Lldf5_113
Llrf6_116:
  s_waitcnt lgkmcnt(0)
  ds_read_b32 v15, v47
  s_waitcnt lgkmcnt(0)
  v_cmp_gt_u32 vcc, v16, v15
  s_nop 0
  s_cbranch_vccz Lldf6_115
  s_sub_u32 s11, s11, 1
  s_cbranch_scc0 Llrf6_116
  s_mov_b32 s11, 0
  s_branch Lldf6_115
Lslow_119:
  buffer_store_dwordx2 v[124:125], v18, s[76:79], s86 offen sc1
  buffer_store_dwordx2 v[126:127], v19, s[76:79], s86 offen sc1
  buffer_store_dwordx2 v[128:129], v18, s[76:79], s87 offen sc1
  buffer_store_dwordx2 v[130:131], v19, s[76:79], s87 offen sc1
  s_branch Lback_120
Lslow_121:
  buffer_store_dword v27, v14, s[76:79], 0 offen sc1
  s_branch Lback_122
Llrf8_124:
  s_waitcnt lgkmcnt(0)
  ds_read_b32 v15, v47
  s_waitcnt lgkmcnt(0)
  v_cmp_gt_u32 vcc, v16, v15
  s_nop 0
  s_cbranch_vccz Lldf8_123
  s_sub_u32 s11, s11, 1
  s_cbranch_scc0 Llrf8_124
  s_mov_b32 s11, 0
  s_branch Lldf8_123
Llrg_126:
  s_waitcnt lgkmcnt(0)
  ds_read_b32 v223, v221
  s_waitcnt lgkmcnt(0)
  v_cmp_gt_u32 vcc, v224, v223
  s_nop 0
  s_cbranch_vccz Lldg_125
  s_sub_u32 s11, s11, 1
  s_cbranch_scc0 Llrg_126
  s_mov_b32 s11, 0
  s_branch Lldg_125
Llrg_128:
  s_waitcnt lgkmcnt(0)
  ds_read_b32 v223, v221
  s_waitcnt lgkmcnt(0)
  v_cmp_gt_u32 vcc, v224, v223
  s_nop 0
  s_cbranch_vccz Lldg_127
  s_sub_u32 s11, s11, 1
  s_cbranch_scc0 Llrg_128
  s_mov_b32 s11, 0
  s_branch Lldg_127
Llrg_130:
  s_waitcnt lgkmcnt(0)
  ds_read_b32 v223, v221
  s_waitcnt lgkmcnt(0)
  v_cmp_gt_u32 vcc, v224, v223
  s_nop 0
  s_cbranch_vccz Lldg_129
  s_sub_u32 s11, s11, 1
  s_cbranch_scc0 Llrg_130
  s_mov_b32 s11, 0
  s_branch Lldg_129
Llrg_132:
  s_waitcnt lgkmcnt(0)
  ds_read_b32 v223, v221
  s_waitcnt lgkmcnt(0)
  v_cmp_gt_u32 vcc, v224, v223
  s_nop 0
  s_cbranch_vccz Lldg_131
  s_sub_u32 s11, s11, 1
  s_cbranch_scc0 Llrg_132
  s_mov_b32 s11, 0
  s_branch Lldg_131
Llrg_134:
  s_waitcnt lgkmcnt(0)
  ds_read_b32 v223, v221
  s_waitcnt lgkmcnt(0)
  v_cmp_gt_u32 vcc, v224, v223
  s_nop 0
  s_cbranch_vccz Lldg_133
  s_sub_u32 s11, s11, 1
  s_cbranch_scc0 Llrg_134
  s_mov_b32 s11, 0
  s_branch Lldg_133
Lxr_136:
  s_mul_i32 s12, s84, 7168
  s_mov_b32 s13, 0
  s_add_u32 m0, s12, 0
  s_nop 0
  buffer_load_dwordx4 v18, s[76:79], s13 offen offset:0 sc1 lds
  buffer_load_dwordx4 v18, s[76:79], s13 offen offset:1024 sc1 lds
  buffer_load_dwordx4 v18, s[76:79], s13 offen offset:2048 sc1 lds
  buffer_load_dwordx4 v18, s[76:79], s13 offen offset:3072 sc1 lds
  s_mov_b32 s13, 4096
  s_add_u32 m0, s12, 4096
  s_nop 0
  buffer_load_dwordx4 v18, s[76:79], s13 offen offset:0 sc1 lds
  buffer_load_dwordx4 v18, s[76:79], s13 offen offset:1024 sc1 lds
  buffer_load_dwordx4 v18, s[76:79], s13 offen offset:2048 sc1 lds
  s_waitcnt vmcnt(0)
  ds_read_b32 v16, v19 offset:0
  ds_read_b32 v17, v19 offset:3072
  s_waitcnt lgkmcnt(0)
  v_max_u32 v16, v16, v17
  v_cmp_eq_u32 vcc, -1, v16
  s_nop 0
  s_cbranch_vccz Lxd_135
  s_sub_u32 s11, s11, 1
  s_cbranch_scc0 Lxr_136
  s_mov_b32 s11, 0
  s_branch Lxd_135
Llrg_138:
  s_waitcnt lgkmcnt(0)
  ds_read_b32 v223, v221
  s_waitcnt lgkmcnt(0)
  v_cmp_gt_u32 vcc, v224, v223
  s_nop 0
  s_cbranch_vccz Lldg_137
  s_sub_u32 s11, s11, 1
  s_cbranch_scc0 Llrg_138
  s_mov_b32 s11, 0
  s_branch Lldg_137
Llrg_140:
  s_waitcnt lgkmcnt(0)
  ds_read_b32 v223, v221
  s_waitcnt lgkmcnt(0)
  v_cmp_gt_u32 vcc, v224, v223
  s_nop 0
  s_cbranch_vccz Lldg_139
  s_sub_u32 s11, s11, 1
  s_cbranch_scc0 Llrg_140
  s_mov_b32 s11, 0
  s_branch Lldg_139
Lslow_141:
  buffer_store_dword v15, v11, s[76:79], 0 offen sc1
  s_branch Lback_142
Lslow_143:
  buffer_store_dwordx4 v[200:203], v9, s[76:79], s94 offen offset:0 sc1
  s_branch Lback_144
Lslow_145:
  buffer_store_dwordx4 v[204:207], v9, s[76:79], s94 offen offset:1024 sc1
  s_branch Lback_146
Llrg_148:
  s_waitcnt lgkmcnt(0)
  ds_read_b32 v223, v221
  s_waitcnt lgkmcnt(0)
  v_cmp_gt_u32 vcc, v224, v223
  s_nop 0
  s_cbranch_vccz Lldg_147
  s_sub_u32 s11, s11, 1
  s_cbranch_scc0 Llrg_148
  s_mov_b32 s11, 0
  s_branch Lldg_147
Lslow_149:
  buffer_store_dword v13, v11, s[76:79], 0 offen offset:256 sc1
  s_branch Lback_150
Lprd0_152:
  s_waitcnt vmcnt(0)
  buffer_load_dword v15, v10, s[76:79], 0 offen offset:256 sc1
  s_waitcnt vmcnt(0)
  v_cmp_ne_u32 vcc, s9, v15
  s_nop 0
  s_cbranch_vccz Lpdd0_151
  s_sub_u32 s11, s11, 1
  s_cbranch_scc0 Lprd0_152
  s_mov_b32 s11, 0
  s_branch Lpdd0_151
Lslow_153:
  buffer_store_dwordx4 v[176:179], v9, s[76:79], s94 offen offset:2048 sc1
  s_branch Lback_154
Lslow_155:
  buffer_store_dwordx4 v[180:183], v9, s[76:79], s94 offen offset:3072 sc1
  s_branch Lback_156
Lslow_157:
  buffer_store_dword v13, v11, s[76:79], 0 offen offset:512 sc1
  s_branch Lback_158
Lprd1_160:
  s_waitcnt vmcnt(0)
  buffer_load_dword v15, v10, s[76:79], 0 offen offset:512 sc1
  s_waitcnt vmcnt(0)
  v_cmp_ne_u32 vcc, s9, v15
  s_nop 0
  s_cbranch_vccz Lpdd1_159
  s_sub_u32 s11, s11, 1
  s_cbranch_scc0 Lprd1_160
  s_mov_b32 s11, 0
  s_branch Lpdd1_159
Llrg_162:
  s_waitcnt lgkmcnt(0)
  ds_read_b32 v223, v221
  s_waitcnt lgkmcnt(0)
  v_cmp_gt_u32 vcc, v224, v223
  s_nop 0
  s_cbranch_vccz Lldg_161
  s_sub_u32 s11, s11, 1
  s_cbranch_scc0 Llrg_162
  s_mov_b32 s11, 0
  s_branch Lldg_161
Llrg_164:
  s_waitcnt lgkmcnt(0)
  ds_read_b32 v223, v221
  s_waitcnt lgkmcnt(0)
  v_cmp_gt_u32 vcc, v224, v223
  s_nop 0
  s_cbranch_vccz Lldg_163
  s_sub_u32 s11, s11, 1
  s_cbranch_scc0 Llrg_164
  s_mov_b32 s11, 0
  s_branch Lldg_163
Llrg_166:
  s_waitcnt lgkmcnt(0)
  ds_read_b32 v223, v221
  s_waitcnt lgkmcnt(0)
  v_cmp_gt_u32 vcc, v224, v223
  s_nop 0
  s_cbranch_vccz Lldg_165
  s_sub_u32 s11, s11, 1
  s_cbranch_scc0 Llrg_166
  s_mov_b32 s11, 0
  s_branch Lldg_165
Lsr_168:
  s_waitcnt lgkmcnt(0)
  ds_read_b32 v17, v221
  s_waitcnt lgkmcnt(0)
  v_cmp_gt_u32 vcc, v224, v17
  s_nop 0
  s_cbranch_vccz Lso_169
  s_sub_u32 s11, s11, 1
  s_cbranch_scc0 Lsr_168
  s_mov_b32 s11, 0
  s_branch Lso_169
Lso_169:
  ds_read_b128 v[96:99], v14 offset:0
  ds_read_b128 v[100:103], v14 offset:4096
  ds_read_b128 v[104:107], v14 offset:8192
  ds_read_b128 v[108:111], v14 offset:12288
  ds_read_b128 v[112:115], v14 offset:16384
  ds_read_b128 v[116:119], v14 offset:20480
  ds_read_b128 v[120:123], v14 offset:24576
  ds_read_b128 v[124:127], v14 offset:28672
  s_waitcnt lgkmcnt(0)
  s_branch Lsd_167
Lsr_171:
  s_waitcnt lgkmcnt(0)
  ds_read_b32 v16, v221
  s_waitcnt lgkmcnt(0)
  v_cmp_gt_u32 vcc, v224, v16
  s_nop 0
  s_cbranch_vccz Lso_172
  s_sub_u32 s11, s11, 1
  s_cbranch_scc0 Lsr_171
  s_mov_b32 s11, 0
  s_branch Lso_172
Lso_172:
  ds_read_b128 v[32:35], v6 offset:0
  ds_read_b128 v[36:39], v6 offset:4096
  ds_read_b128 v[40:43], v6 offset:8192
  ds_read_b128 v[44:47], v6 offset:12288
  ds_read_b128 v[48:51], v6 offset:16384
  ds_read_b128 v[52:55], v6 offset:20480
  ds_read_b128 v[56:59], v6 offset:24576
  ds_read_b128 v[60:63], v6 offset:28672
  s_waitcnt lgkmcnt(0)
  s_branch Lsd_170
Lsr_174:
  s_waitcnt lgkmcnt(0)
  ds_read_b32 v18, v221
  s_waitcnt lgkmcnt(0)
  v_cmp_gt_u32 vcc, v224, v18
  s_nop 0
  s_cbranch_vccz Lso_175
  s_sub_u32 s11, s11, 1
  s_cbranch_scc0 Lsr_174
  s_mov_b32 s11, 0
  s_branch Lso_175
Lso_175:
  ds_read_b128 v[64:67], v6 offset:32768
  ds_read_b128 v[68:71], v6 offset:36864
  ds_read_b128 v[72:75], v6 offset:40960
  ds_read_b128 v[76:79], v6 offset:45056
  s_waitcnt lgkmcnt(0)
  s_branch Lsd_173
Lsr_177:
  s_waitcnt lgkmcnt(0)
  ds_read_b32 v19, v221
  s_waitcnt lgkmcnt(0)
  v_cmp_gt_u32 vcc, v224, v19
  s_nop 0
  s_cbranch_vccz Lso_178
  s_sub_u32 s11, s11, 1
  s_cbranch_scc0 Lsr_177
  s_mov_b32 s11, 0
  s_branch Lso_178
Lso_178:
  ds_read_b128 v[80:83], v6 offset:49152
  ds_read_b128 v[84:87], v6 offset:53248
  ds_read_b128 v[88:91], v6 offset:57344
  ds_read_b128 v[92:95], v6 offset:61440
  s_waitcnt lgkmcnt(0)
  s_branch Lsd_176
Lslow_179:
  buffer_store_dword v27, v14, s[76:79], 0 offen sc1
  s_branch Lback_180

  s_endpgm
Lcodeend:
.fill 64, 4, 0xbf800000
.section .rodata,"a"
.p2align 6
.amdhsa_kernel sequential_preLN__linear_kernel_hedgehog__mixer_s_mlp__prompt_kernel
  .amdhsa_next_free_vgpr 256
  .amdhsa_next_free_sgpr 102
  .amdhsa_accum_offset 256
  .amdhsa_group_segment_fixed_size 0
  .amdhsa_kernarg_size 96
  .amdhsa_user_sgpr_count 2
  .amdhsa_user_sgpr_kernarg_segment_ptr 1
  .amdhsa_system_sgpr_workgroup_id_x 1
.end_amdhsa_kernel
```
